```python
import torch

def _softmax(x, axis=-1):
    return torch.softmax(x, dim=axis)
def _gelu(x):
    return torch.nn.functional.gelu(x, approximate="tanh")
def _silu(x):
    return torch.nn.functional.silu(x)
def _sigmoid(x):
    return torch.sigmoid(x)
def _layernorm(x, axis=-1, eps=1e-5):
    m = x.mean(dim=axis, keepdim=True)
    v = x.var(dim=axis, keepdim=True, unbiased=False)
    return (x - m) / torch.sqrt(v + eps)
def _scatter_add(tgt, idx, src, axis=0):
    return tgt.clone().index_add_(axis, idx, src)
def _segment_sum(src, seg, n):
    out = torch.zeros((n,) + src.shape[1:], dtype=src.dtype)
    return out.index_add_(0, seg, src)
def _pad(x, pw):
    flat = tuple(v for pair in reversed(pw) for v in pair)
    return torch.nn.functional.pad(x, flat)

kernel_name = 'sequential_preLN__sliding_block__mixer_token_mlp__prompt'

def setup_inputs():

    _w = (lambda a: (lambda t: t.to(torch.bfloat16) if t.is_floating_point() else t)(torch.as_tensor(a)))
    def _A_setup():
        B, S, D = 1, 2048, 640
        return {
            "x": _w((lambda *s: torch.randn(*s, dtype=torch.bfloat16) * 0.05)(B, S, D)),
            "wqkv": _w((lambda *s: torch.randn(*s, dtype=torch.bfloat16) * 0.05)(D, 3 * D)),
            "wo": _w((lambda *s: torch.randn(*s, dtype=torch.bfloat16) * 0.05)(D, D)),
        }
    _A_in = _A_setup()

    def _B_setup():
        B, S, D, F = 1, 2048, 640, 1728
        return {
            "x": _w((lambda *s: torch.randn(*s, dtype=torch.bfloat16) * 0.05)(B, S, D)),
            "w1": _w((lambda *s: torch.randn(*s, dtype=torch.bfloat16) * 1.6)(S, F) * (S ** -0.5)),
            "b1": _w((lambda *s: torch.randn(*s, dtype=torch.bfloat16) * 12.8)(F) * 0.02),
            "w2": _w((lambda *s: torch.randn(*s, dtype=torch.bfloat16) * 0.8)(F, S) * (F ** -0.5)),
            "b2": _w((lambda *s: torch.randn(*s, dtype=torch.bfloat16) * 12.8)(S) * 0.02),
        }
    _B_in = _B_setup()

    return {
        "A_x": _A_in["x"],
        "A_wqkv": _A_in["wqkv"],
        "A_wo": _A_in["wo"],
        "B_x": _B_in["x"],
        "B_w1": _B_in["w1"],
        "B_b1": _B_in["b1"],
        "B_w2": _B_in["w2"],
        "B_b2": _B_in["b2"],
    }

def reference(A_x, A_wqkv, A_wo, B_x, B_w1, B_b1, B_w2, B_b2):
    def _A_ref(x, wqkv, wo):
        B, S, D = x.shape
        H = 32; Dh = D // H; W = 256
        qkv = (lambda x, *d: x.permute(*d))((x @ wqkv).reshape(B, S, 3, H, Dh), 2, 0, 3, 1, 4)
        q, k, v = qkv[0], qkv[1], qkv[2]
        scores = torch.einsum("bhqd,bhkd->bhqk", q, k) * (Dh ** -0.5)
        idx = torch.arange(S)
        mask = (idx[:, None] - idx[None, :] >= 0) & (idx[:, None] - idx[None, :] < W)
        scores = torch.where(mask[None, None], scores, -1e9)
        p = _softmax(scores, axis=-1)
        o = torch.einsum("bhqk,bhkd->bhqd", p, v)
        return (lambda x, *d: x.permute(*d))(o, 0, 2, 1, 3).reshape(B, S, D) @ wo

    def _B_ref(x, w1, b1, w2, b2):
        B, S, D = x.shape
        h = _layernorm(x, axis=-1)
        u = torch.einsum("bsd,sf->bdf", h, w1) + b1
        u = _gelu(u)
        y = torch.einsum("bdf,fs->bds", u, w2) + b2
        return (lambda x, *d: x.permute(*d))(y, 0, 2, 1)

    x = A_x
    h = x + _A_ref(_layernorm(x, axis=-1), A_wqkv, A_wo)
    h2 = h + _B_ref(_layernorm(h, axis=-1), B_w1, B_b1, B_w2, B_b2)
    return h2
```

```asm
; @launch kernel=sequential_preLN__sliding_block__mixer_token_mlp__prompt_kernel grid=(256,1,1) block=(256,1,1) lds=163840
.amdgcn_target "amdgcn-amd-amdhsa--gfx950"
.text
.globl sequential_preLN__sliding_block__mixer_token_mlp__prompt_kernel
.p2align 8
.type sequential_preLN__sliding_block__mixer_token_mlp__prompt_kernel,@function
sequential_preLN__sliding_block__mixer_token_mlp__prompt_kernel:
    s_cmp_ge_u32 s2, 256
    s_cbranch_scc1 K_exit
    s_load_dwordx4 s[36:39], s[0:1], 0
    s_load_dwordx2 s[86:87], s[0:1], 80
    s_load_dwordx2 s[24:25], s[0:1], 72
    s_load_dwordx2 s[40:41], s[0:1], 16
    s_load_dwordx2 s[88:89], s[0:1], 32
    s_load_dwordx2 s[20:21], s[0:1], 48
    v_lshrrev_b32 v10, 6, v0
    v_and_b32 v1, 63, v0
    v_readfirstlane_b32 s3, v10
    s_getpc_b64 s[44:45]
    v_lshlrev_b32 v11, 7, v0
    v_min_u32 v11, 23680, v11
    global_load_dword v14, v11, s[44:45]
    s_and_b32 s84, s2, 7
    s_lshr_b32 s85, s2, 3
    v_lshlrev_b32 v2, 4, v1
    v_mov_b32 v4, 1
    s_cmp_ge_u32 s85, 30
    s_cbranch_scc1 A_prep
    s_and_b32 s28, s84, 1
    s_mul_i32 s28, s28, 30
    s_add_u32 s35, s85, s28
    s_lshr_b32 s29, s35, 2
    s_and_b32 s28, s35, 3
    s_lshr_b32 s34, s84, 1
    s_lshl2_add_u32 s28, s34, s28
    s_lshl2_add_u32 s34, s28, s3
    s_mul_i32 s34, s34, 40960
    v_lshrrev_b32 v10, 3, v1
    v_mul_u32_u24 v10, 1280, v10
    v_add_u32 v10, s34, v10
    v_lshrrev_b32 v11, 4, v1
    v_and_b32 v13, 7, v1
    v_xor_b32 v13, v13, v11
    v_lshl_add_u32 v15, v13, 4, v10
    v_xor_b32 v13, 4, v13
    v_lshl_add_u32 v16, v13, 4, v10
    v_add_u32 v16, 9216, v16
    v_add_u32 v17, 18432, v15
    v_add_u32 v18, 18432, v16
    s_mul_i32 s34, s3, 61440
    s_lshl_b32 s35, s29, 8
    s_add_u32 s34, s34, s35
    v_mul_u32_u24 v10, 3840, v11
    v_add_u32 v10, s34, v10
    v_lshlrev_b32 v13, 2, v11
    v_xor_b32 v13, v13, v1
    v_and_b32 v13, 15, v13
    v_lshl_add_u32 v19, v13, 4, v10
    v_add_u32 v20, 14336, v19
    v_add_u32 v21, 28672, v19
    v_add_u32 v22, 43008, v19
    v_xor_b32 v21, 32, v21
    v_xor_b32 v22, 32, v22
    s_lshl_b32 s32, s3, 12
    s_add_u32 s33, s32, 0x10000
    s_mul_i32 s34, s28, 3
    s_mul_i32 s35, s29, 1
    s_add_u32 s34, s34, s35
    s_mul_i32 s35, s34, 6554
    s_lshr_b32 s35, s35, 16
    s_mul_i32 s35, s35, 10
    s_sub_u32 s34, s34, s35
    s_lshl_b32 s30, s34, 7
    s_mul_i32 s31, s34, 245760
    s_waitcnt lgkmcnt(0)
    s_mov_b32 s4, s36
    s_mov_b32 s5, s37
    s_mov_b32 s6, 0x280000
    s_mov_b32 s7, 0x20000
    s_mov_b32 s8, s38
    s_mov_b32 s9, s39
    s_mov_b32 s10, 0x258000
    s_mov_b32 s11, 0x20000
    s_add_u32 m0, s32, 0
    s_nop 0
    buffer_load_dwordx4 v15, s[4:7], s30 offen offset:0 lds
    buffer_load_dwordx4 v16, s[4:7], s30 offen offset:1024 lds
    buffer_load_dwordx4 v17, s[4:7], s30 offen offset:2048 lds
    buffer_load_dwordx4 v18, s[4:7], s30 offen offset:3072 lds
    s_add_u32 m0, s33, 0
    s_nop 0
    buffer_load_dwordx4 v19, s[8:11], s31 offen offset:0 lds
    buffer_load_dwordx4 v20, s[8:11], s31 offen offset:1024 lds
    buffer_load_dwordx4 v21, s[8:11], s31 offen offset:2048 lds
    buffer_load_dwordx4 v22, s[8:11], s31 offen offset:3072 lds
    s_add_u32 s30, s30, 128
    s_add_u32 s31, s31, 245760
    s_cmp_eq_u32 s30, 1280
    s_cselect_b32 s30, 0, s30
    s_cselect_b32 s31, 0, s31
    s_cmp_ge_u32 s29, 10
    s_cselect_b32 s34, 12, 0
    s_cselect_b32 s35, 0, 3
    v_lshrrev_b32 v10, 1, v1
    v_xor_b32 v10, v10, v1
    v_bfe_i32 v12, v10, 2, 1
    v_bfe_i32 v10, v10, 0, 1
    v_and_b32 v12, s34, v12
    v_xor_b32 v44, v12, v1
    v_and_b32 v10, s35, v10
    v_xor_b32 v45, v10, v1
    v_and_b32 v10, 15, v44
    v_lshrrev_b32 v12, 1, v10
    v_xor_b32 v12, v12, v11
    s_and_b32 s34, s3, 1
    s_lshl_b32 s35, s34, 2
    v_xor_b32 v12, s35, v12
    v_lshlrev_b32 v10, 7, v10
    v_lshl_add_u32 v10, v12, 4, v10
    v_add_u32 v23, s32, v10
    v_xor_b32 v24, 64, v23
    v_bfe_u32 v10, v1, 2, 2
    v_lshl_add_u32 v12, v11, 3, v10
    v_lshlrev_b32 v12, 8, v12
    v_lshl_add_u32 v12, v10, 6, v12
    v_and_b32 v10, 1, v11
    v_lshl_add_u32 v12, v10, 5, v12
    v_and_b32 v10, 3, v45
    v_lshl_add_u32 v12, v10, 3, v12
    s_lshl_b32 s34, s34, 13
    s_add_u32 s34, s34, 0x10000
    v_add_u32 v12, s34, v12
    v_lshrrev_b32 v13, 5, v1
    v_xor_b32 v27, 0, v12
    v_xor_b32 v28, 32, v12
    v_xor_b32 v29, 64, v12
    v_xor_b32 v30, 96, v12
    v_xor_b32 v31, 128, v12
    v_xor_b32 v32, 160, v12
    v_xor_b32 v33, 192, v12
    v_xor_b32 v34, 224, v12
    v_xor_b32 v35, 8192, v12
    v_xor_b32 v36, 8224, v12
    v_xor_b32 v37, 8256, v12
    v_xor_b32 v38, 8288, v12
    v_xor_b32 v39, 8320, v12
    v_xor_b32 v40, 8352, v12
    v_xor_b32 v41, 8384, v12
    v_xor_b32 v42, 8416, v12
    v_mov_b32 v174, 0x3f803f80
    v_mov_b32 v178, 0
    v_mov_b32 v179, 0
    v_mov_b32 v182, 0
    v_mov_b32 v183, 0
    v_mov_b32 v186, 0
    v_mov_b32 v187, 0
    v_mov_b32 v188, 0
    v_mov_b32 v189, 0
    s_mov_b32 s12, s86
    s_mov_b32 s13, s87
    s_mov_b32 s14, 0x780000
    s_mov_b32 s15, 0x20000
    s_mov_b32 s26, 0x100
    s_mov_b32 s27, 0x20000
    s_mov_b32 s90, 0x6c0000
    s_mov_b32 s91, 0x20000
    s_mov_b32 s22, 0x6c0000
    s_mov_b32 s23, 0x20000
    s_add_u32 s80, s86, 0x1200000
    s_addc_u32 s81, s87, 0
    s_mov_b32 s82, 0x40000
    s_mov_b32 s83, 0x20000
    s_add_u32 s16, s86, 0x1280000
    s_addc_u32 s17, s87, 0
    s_mov_b32 s18, 0x3ac00
    s_mov_b32 s19, 0x20000
    s_lshl2_add_u32 s45, s28, s3
    s_mul_i32 s45, s45, 2560
    s_lshl_b32 s41, s29, 8
    s_add_u32 s41, s41, s45
    s_cmp_lt_u32 s29, 10
    s_cselect_b32 s41, s41, 805306368
    s_mul_i32 s101, s29, 5120
    s_add_u32 s101, s101, 163840
    s_lshl_b32 s44, s28, 9
    s_add_u32 s44, s44, s101
    s_lshl4_add_u32 s34, s3, s28
    s_cmp_lt_u32 s34, 10
    s_cselect_b32 s44, s44, 805306368
    s_lshl_b32 s34, s3, 9
    s_add_u32 s101, s101, s34
    v_lshlrev_b32 v44, 2, v44
    v_lshlrev_b32 v45, 3, v1
    v_min_u32 v10, 19, v1
    s_lshl_b32 s34, s28, 4
    s_add_u32 s34, s34, 768
    v_add_u32 v43, s34, v10
    s_add_u32 s40, s34, s29
    s_lshl_b32 s40, s40, 7
    s_add_u32 s34, s29, 608
    v_lshl_add_u32 v12, v10, 4, s34
    v_cmp_gt_u32 vcc, 10, v10
    s_nop 1
    v_cndmask_b32 v43, v12, v43, vcc
    v_lshlrev_b32 v43, 7, v43
    s_cmp_eq_u32 s3, 0
    s_cselect_b32 s40, s40, 805306368
    s_cselect_b32 s38, 0, 805306368
    s_cselect_b32 s39, 16, 0
    s_and_b32 s34, s84, 0
    s_lshl_b32 s34, s34, 3
    s_lshr_b32 s35, s84, 0
    s_and_b32 s95, s85, 7
    s_add_u32 s95, s95, s34
    s_lshl_b32 s94, s35, 5
    s_add_u32 s94, s94, s85
    s_lshr_b32 s94, s94, 3
    s_mul_i32 s99, s35, 27
    s_add_u32 s99, s99, s85
    s_and_b32 s98, s99, 7
    s_add_u32 s98, s98, s34
    s_lshr_b32 s99, s99, 3
    s_lshl_b32 s93, s3, 12
    v_min_u32 v251, 26, v1
    s_mul_i32 s34, s2, 216
    v_add_u32 v251, s34, v251
    s_mul_i32 s34, s3, 27
    v_add_lshl_u32 v251, v251, s34, 7
    v_add_u32 v242, 0x20000, v2
    v_and_b32 v10, 31, v1
    v_lshl_add_u32 v245, v13, 30, v2
    v_mul_u32_u24 v244, 245760, v13
    v_lshl_add_u32 v244, v10, 3, v244
    s_lshl2_add_u32 s42, s28, s3
    s_lshl4_add_u32 s47, s28, s29
    s_lshl_b32 s47, s47, 7
    s_cmp_eq_u32 s3, 0
    s_cselect_b32 s47, s47, 805306368
    v_mov_b32 v12, 0x3f803f80
    v_accvgpr_write_b32 a0, v12
    v_accvgpr_write_b32 a1, v12
    v_accvgpr_write_b32 a2, v12
    v_accvgpr_write_b32 a3, v12
    v_accvgpr_write_b32 a4, v12
    v_accvgpr_write_b32 a5, v12
    v_accvgpr_write_b32 a6, v12
    v_accvgpr_write_b32 a7, v12
    v_accvgpr_write_b32 a8, v12
    v_accvgpr_write_b32 a9, v12
    v_accvgpr_write_b32 a10, v12
    v_accvgpr_write_b32 a11, v12
    v_accvgpr_write_b32 a12, v12
    v_accvgpr_write_b32 a13, v12
    v_accvgpr_write_b32 a14, v12
    v_accvgpr_write_b32 a15, v12
    v_accvgpr_write_b32 a16, v12
    v_accvgpr_write_b32 a17, v12
    v_accvgpr_write_b32 a18, v12
    v_accvgpr_write_b32 a19, v12
    v_accvgpr_write_b32 a20, v12
    v_accvgpr_write_b32 a21, v12
    v_accvgpr_write_b32 a22, v12
    v_accvgpr_write_b32 a23, v12
    v_accvgpr_write_b32 a24, v12
    v_accvgpr_write_b32 a25, v12
    v_accvgpr_write_b32 a26, v12
    v_accvgpr_write_b32 a27, v12
    v_accvgpr_write_b32 a28, v12
    v_accvgpr_write_b32 a29, v12
    v_accvgpr_write_b32 a30, v12
    v_accvgpr_write_b32 a31, v12
    v_accvgpr_write_b32 a32, v12
    v_accvgpr_write_b32 a33, v12
    v_accvgpr_write_b32 a34, v12
    v_accvgpr_write_b32 a35, v12
    v_accvgpr_write_b32 a36, v12
    v_accvgpr_write_b32 a37, v12
    v_accvgpr_write_b32 a38, v12
    v_accvgpr_write_b32 a39, v12
    v_accvgpr_write_b32 a40, v12
    v_accvgpr_write_b32 a41, v12
    v_accvgpr_write_b32 a42, v12
    v_accvgpr_write_b32 a43, v12
    v_accvgpr_write_b32 a44, v12
    v_accvgpr_write_b32 a45, v12
    v_accvgpr_write_b32 a46, v12
    v_accvgpr_write_b32 a47, v12
    v_accvgpr_write_b32 a48, v12
    v_accvgpr_write_b32 a49, v12
    v_accvgpr_write_b32 a50, v12
    v_accvgpr_write_b32 a51, v12
    v_accvgpr_write_b32 a52, v12
    v_accvgpr_write_b32 a53, v12
    v_accvgpr_write_b32 a54, v12
    v_accvgpr_write_b32 a55, v12
    v_accvgpr_write_b32 a56, v12
    v_accvgpr_write_b32 a57, v12
    v_accvgpr_write_b32 a58, v12
    v_accvgpr_write_b32 a59, v12
    v_accvgpr_write_b32 a60, v12
    v_accvgpr_write_b32 a61, v12
    v_accvgpr_write_b32 a62, v12
    v_accvgpr_write_b32 a63, v12
    v_accvgpr_write_b32 a64, v12
    v_accvgpr_write_b32 a65, v12
    v_accvgpr_write_b32 a66, v12
    v_accvgpr_write_b32 a67, v12
    v_accvgpr_write_b32 a68, v12
    v_accvgpr_write_b32 a69, v12
    v_accvgpr_write_b32 a70, v12
    v_accvgpr_write_b32 a71, v12
    v_accvgpr_write_b32 a72, v12
    v_accvgpr_write_b32 a73, v12
    v_accvgpr_write_b32 a74, v12
    v_accvgpr_write_b32 a75, v12
    v_accvgpr_write_b32 a76, v12
    v_accvgpr_write_b32 a77, v12
    v_accvgpr_write_b32 a78, v12
    v_accvgpr_write_b32 a79, v12
    v_accvgpr_write_b32 a106, 0
    v_accvgpr_write_b32 a151, 0
    v_accvgpr_write_b32 a139, 0
    v_accvgpr_write_b32 a127, 0
    v_accvgpr_write_b32 a115, 0
    v_accvgpr_write_b32 a107, 0
    v_mov_b32 v12, 0x3f80
    v_accvgpr_write_b32 a170, v12
    v_accvgpr_write_b32 a171, 0
    v_accvgpr_write_b32 a174, v12
    v_accvgpr_write_b32 a175, 0
    v_accvgpr_write_b32 a98, v12
    v_accvgpr_write_b32 a99, 0
    v_accvgpr_write_b32 a102, v12
    v_accvgpr_write_b32 a103, 0
    v_mov_b32 v12, 0xbf00bf00
    v_accvgpr_write_b32 a80, v12
    v_accvgpr_write_b32 a81, v12
    s_mov_b32 s48, 0xffffffff
    s_mov_b32 s49, 0xfffffff0
    s_mov_b32 s50, 0xfffffffe
    s_mov_b32 s51, 0xffffffe0
    s_mov_b32 s52, 0xfffffffc
    s_mov_b32 s53, 0xffffffc0
    s_mov_b32 s54, 0xfffffff8
    s_mov_b32 s55, 0xffffff80
    s_mov_b32 s56, 0xffffff00
    s_mov_b32 s57, 0xfffff000
    s_mov_b32 s58, 0xfffffe00
    s_mov_b32 s59, 0xffffe000
    s_mov_b32 s60, 0xfffffc00
    s_mov_b32 s61, 0xffffc000
    s_mov_b32 s62, 0xfffff800
    s_mov_b32 s63, 0xffff8000
    s_mov_b32 s64, 0xffff0000
    s_mov_b32 s65, 0xfff00000
    s_mov_b32 s66, 0xfffe0000
    s_mov_b32 s67, 0xffe00000
    s_mov_b32 s68, 0xfffc0000
    s_mov_b32 s69, 0xffc00000
    s_mov_b32 s70, 0xfff80000
    s_mov_b32 s71, 0xff800000
    s_mov_b32 s72, 0xff000000
    s_mov_b32 s73, 0xf0000000
    s_mov_b32 s74, 0xfe000000
    s_mov_b32 s75, 0xe0000000
    s_mov_b32 s76, 0xfc000000
    s_mov_b32 s77, 0xc0000000
    s_mov_b32 s78, 0xf8000000
    s_mov_b32 s79, 0x80000000
    s_barrier
    s_add_u32 m0, s32, 16384
    s_nop 0
    buffer_load_dwordx4 v15, s[4:7], s30 offen offset:0 lds
    buffer_load_dwordx4 v16, s[4:7], s30 offen offset:1024 lds
    buffer_load_dwordx4 v17, s[4:7], s30 offen offset:2048 lds
    buffer_load_dwordx4 v18, s[4:7], s30 offen offset:3072 lds
    s_add_u32 m0, s33, 16384
    s_nop 0
    buffer_load_dwordx4 v19, s[8:11], s31 offen offset:0 lds
    buffer_load_dwordx4 v20, s[8:11], s31 offen offset:1024 lds
    buffer_load_dwordx4 v21, s[8:11], s31 offen offset:2048 lds
    buffer_load_dwordx4 v22, s[8:11], s31 offen offset:3072 lds
    s_add_u32 s30, s30, 128
    s_add_u32 s31, s31, 245760
    s_cmp_eq_u32 s30, 1280
    s_cselect_b32 s30, 0, s30
    s_cselect_b32 s31, 0, s31
    s_cmp_ge_u32 s29, 10
    s_cbranch_scc1 A_v
    s_cmp_ge_u32 s29, 5
    s_cselect_b32 s34, 5, 0
    s_sub_u32 s34, s29, s34
    s_cmp_eq_u32 s34, 1
    s_cbranch_scc1 W_qk1
    s_cmp_eq_u32 s34, 2
    s_cbranch_scc1 W_qk2
    s_cmp_eq_u32 s34, 3
    s_cbranch_scc1 W_qk3
    s_cmp_eq_u32 s34, 4
    s_cbranch_scc1 W_qk4
W_b1:
    s_cmp_ge_u32 s29, 5
    s_cselect_b32 s46, 1.0, 0x3ea52b5c
    s_waitcnt vmcnt(8)
    s_barrier
    ds_read_b128 v[110:113], v23 offset:0
    ds_read_b128 v[114:117], v23 offset:2048
    ds_read_b64_tr_b16 v[126:127], v27 offset:0
    ds_read_b64_tr_b16 v[128:129], v27 offset:1024
    ds_read_b64_tr_b16 v[130:131], v28 offset:0
    ds_read_b64_tr_b16 v[132:133], v28 offset:1024
    ds_read_b64_tr_b16 v[134:135], v29 offset:0
    ds_read_b64_tr_b16 v[136:137], v29 offset:1024
    ds_read_b64_tr_b16 v[138:139], v30 offset:0
    ds_read_b64_tr_b16 v[140:141], v30 offset:1024
    ds_read_b64_tr_b16 v[142:143], v31 offset:0
    ds_read_b64_tr_b16 v[144:145], v31 offset:1024
    ds_read_b64_tr_b16 v[146:147], v32 offset:0
    ds_read_b64_tr_b16 v[148:149], v32 offset:1024
    ds_read_b64_tr_b16 v[150:151], v33 offset:0
    ds_read_b64_tr_b16 v[152:153], v33 offset:1024
    ds_read_b64_tr_b16 v[154:155], v34 offset:0
    ds_read_b64_tr_b16 v[156:157], v34 offset:1024
    s_waitcnt lgkmcnt(14)
    v_mfma_f32_16x16x32_bf16 v[46:49], v[126:129], v[110:113], 0
    ds_read_b128 v[118:121], v24 offset:0
    s_add_u32 m0, s32, 32768
    v_mfma_f32_16x16x32_bf16 v[50:53], v[126:129], v[114:117], 0
    ds_read_b128 v[122:125], v24 offset:2048
    ds_read_b64_tr_b16 v[158:159], v35 offset:0
    s_waitcnt lgkmcnt(15)
    v_mfma_f32_16x16x32_bf16 v[54:57], v[130:133], v[110:113], 0
    buffer_load_dwordx4 v15, s[4:7], s30 offen offset:0 lds
    ds_read_b64_tr_b16 v[160:161], v35 offset:1024
    v_mfma_f32_16x16x32_bf16 v[58:61], v[130:133], v[114:117], 0
    ds_read_b64_tr_b16 v[162:163], v36 offset:0
    s_waitcnt lgkmcnt(15)
    v_mfma_f32_16x16x32_bf16 v[62:65], v[134:137], v[110:113], 0
    ds_read_b64_tr_b16 v[164:165], v36 offset:1024
    buffer_load_dwordx4 v16, s[4:7], s30 offen offset:1024 lds
    v_mfma_f32_16x16x32_bf16 v[66:69], v[134:137], v[114:117], 0
    ds_read_b64_tr_b16 v[166:167], v37 offset:0
    ds_read_b64_tr_b16 v[168:169], v37 offset:1024
    s_waitcnt lgkmcnt(15)
    v_mfma_f32_16x16x32_bf16 v[70:73], v[138:141], v[110:113], 0
    buffer_load_dwordx4 v17, s[4:7], s30 offen offset:2048 lds
    ds_read_b64_tr_b16 v[170:171], v38 offset:0
    v_mfma_f32_16x16x32_bf16 v[74:77], v[138:141], v[114:117], 0
    ds_read_b64_tr_b16 v[172:173], v38 offset:1024
    v_dot2_f32_bf16 v178, v110, v174, v178
    v_dot2_f32_bf16 v182, v110, v110, v182
    v_dot2_f32_bf16 v178, v111, v174, v178
    v_dot2_f32_bf16 v182, v111, v111, v182
    v_dot2_f32_bf16 v178, v112, v174, v178
    v_dot2_f32_bf16 v182, v112, v112, v182
    v_dot2_f32_bf16 v178, v113, v174, v178
    v_dot2_f32_bf16 v182, v113, v113, v182
    s_cmp_ge_u32 s3, 2
    s_cbranch_scc1 A_s00
    v_dot2_f32_bf16 v186, v126, v174, v186
    v_dot2_f32_bf16 v187, v130, v174, v187
    v_dot2_f32_bf16 v188, v134, v174, v188
    v_dot2_f32_bf16 v189, v138, v174, v189
    v_dot2_f32_bf16 v186, v127, v174, v186
    v_dot2_f32_bf16 v187, v131, v174, v187
    v_dot2_f32_bf16 v188, v135, v174, v188
    v_dot2_f32_bf16 v189, v139, v174, v189
    v_dot2_f32_bf16 v186, v128, v174, v186
    v_dot2_f32_bf16 v187, v132, v174, v187
    v_dot2_f32_bf16 v188, v136, v174, v188
    v_dot2_f32_bf16 v189, v140, v174, v189
    v_dot2_f32_bf16 v186, v129, v174, v186
    v_dot2_f32_bf16 v187, v133, v174, v187
    v_dot2_f32_bf16 v188, v137, v174, v188
    v_dot2_f32_bf16 v189, v141, v174, v189
A_s00:
    s_waitcnt lgkmcnt(15)
    v_mfma_f32_16x16x32_bf16 v[78:81], v[142:145], v[110:113], 0
    ds_read_b64_tr_b16 v[126:127], v39 offset:0
    buffer_load_dwordx4 v18, s[4:7], s30 offen offset:3072 lds
    v_mfma_f32_16x16x32_bf16 v[82:85], v[142:145], v[114:117], 0
    ds_read_b64_tr_b16 v[128:129], v39 offset:1024
    s_waitcnt lgkmcnt(15)
    v_mfma_f32_16x16x32_bf16 v[86:89], v[146:149], v[110:113], 0
    ds_read_b64_tr_b16 v[130:131], v40 offset:0
    s_add_u32 m0, s33, 32768
    v_mfma_f32_16x16x32_bf16 v[90:93], v[146:149], v[114:117], 0
    ds_read_b64_tr_b16 v[132:133], v40 offset:1024
    s_waitcnt lgkmcnt(15)
    v_mfma_f32_16x16x32_bf16 v[94:97], v[150:153], v[110:113], 0
    ds_read_b64_tr_b16 v[134:135], v41 offset:0
    buffer_load_dwordx4 v19, s[8:11], s31 offen offset:0 lds
    v_mfma_f32_16x16x32_bf16 v[98:101], v[150:153], v[114:117], 0
    ds_read_b64_tr_b16 v[136:137], v41 offset:1024
    s_waitcnt lgkmcnt(15)
    v_mfma_f32_16x16x32_bf16 v[102:105], v[154:157], v[110:113], 0
    ds_read_b64_tr_b16 v[138:139], v42 offset:0
    buffer_load_dwordx4 v20, s[8:11], s31 offen offset:1024 lds
    v_mfma_f32_16x16x32_bf16 v[106:109], v[154:157], v[114:117], 0
    ds_read_b64_tr_b16 v[140:141], v42 offset:1024
    v_dot2_f32_bf16 v179, v114, v174, v179
    v_dot2_f32_bf16 v183, v114, v114, v183
    v_dot2_f32_bf16 v179, v115, v174, v179
    v_dot2_f32_bf16 v183, v115, v115, v183
    v_dot2_f32_bf16 v179, v116, v174, v179
    v_dot2_f32_bf16 v183, v116, v116, v183
    v_dot2_f32_bf16 v179, v117, v174, v179
    v_dot2_f32_bf16 v183, v117, v117, v183
    s_cmp_ge_u32 s3, 2
    s_cbranch_scc0 A_s10
    v_dot2_f32_bf16 v186, v142, v174, v186
    v_dot2_f32_bf16 v187, v146, v174, v187
    v_dot2_f32_bf16 v188, v150, v174, v188
    v_dot2_f32_bf16 v189, v154, v174, v189
    v_dot2_f32_bf16 v186, v143, v174, v186
    v_dot2_f32_bf16 v187, v147, v174, v187
    v_dot2_f32_bf16 v188, v151, v174, v188
    v_dot2_f32_bf16 v189, v155, v174, v189
    v_dot2_f32_bf16 v186, v144, v174, v186
    v_dot2_f32_bf16 v187, v148, v174, v187
    v_dot2_f32_bf16 v188, v152, v174, v188
    v_dot2_f32_bf16 v189, v156, v174, v189
    v_dot2_f32_bf16 v186, v145, v174, v186
    v_dot2_f32_bf16 v187, v149, v174, v187
    v_dot2_f32_bf16 v188, v153, v174, v188
    v_dot2_f32_bf16 v189, v157, v174, v189
A_s10:
    s_lshl_b32 s34, s3, 10
    v_add_u32 v203, s34, v242
    v_permlane16_swap_b32 v186, v187
    v_permlane16_swap_b32 v188, v189
    v_add_f32 v186, v186, v187
    v_add_f32 v188, v188, v189
    s_nop 1
    v_permlane32_swap_b32 v186, v188
    v_add_f32 v186, v186, v188
    ds_write_b32 v203, v186
    s_waitcnt lgkmcnt(0)
    s_waitcnt vmcnt(6)
    s_barrier
    v_mfma_f32_16x16x32_bf16 v[46:49], v[158:161], v[118:121], v[46:49]
    ds_read_b32 v204, v242 offset:0
    ds_read_b32 v206, v242 offset:1024
    ds_read_b32 v205, v242 offset:2048
    v_mfma_f32_16x16x32_bf16 v[50:53], v[158:161], v[122:125], v[50:53]
    ds_read_b32 v207, v242 offset:3072
    ds_read_b128 v[110:113], v23 offset:16384
    v_mfma_f32_16x16x32_bf16 v[54:57], v[162:165], v[118:121], v[54:57]
    buffer_load_dwordx4 v21, s[8:11], s31 offen offset:2048 lds
    ds_read_b128 v[114:117], v23 offset:18432
    ds_read_b64_tr_b16 v[142:143], v27 offset:16384
    v_mfma_f32_16x16x32_bf16 v[58:61], v[162:165], v[122:125], v[58:61]
    buffer_load_dwordx4 v22, s[8:11], s31 offen offset:3072 lds
    ds_read_b64_tr_b16 v[144:145], v27 offset:17408
    v_mfma_f32_16x16x32_bf16 v[62:65], v[166:169], v[118:121], v[62:65]
    ds_read_b64_tr_b16 v[146:147], v28 offset:16384
    s_add_u32 s30, s30, 128
    s_add_u32 s31, s31, 245760
    s_cmp_eq_u32 s30, 1280
    s_cselect_b32 s30, 0, s30
    s_cselect_b32 s31, 0, s31
    v_mfma_f32_16x16x32_bf16 v[66:69], v[166:169], v[122:125], v[66:69]
    ds_read_b64_tr_b16 v[148:149], v28 offset:17408
    ds_read_b64_tr_b16 v[150:151], v29 offset:16384
    s_add_u32 m0, s32, 49152
    v_mfma_f32_16x16x32_bf16 v[70:73], v[170:173], v[118:121], v[70:73]
    ds_read_b64_tr_b16 v[152:153], v29 offset:17408
    ds_read_b64_tr_b16 v[154:155], v30 offset:16384
    v_mfma_f32_16x16x32_bf16 v[74:77], v[170:173], v[122:125], v[74:77]
    buffer_load_dwordx4 v15, s[4:7], s30 offen offset:0 lds
    ds_read_b64_tr_b16 v[156:157], v30 offset:17408
    v_dot2_f32_bf16 v178, v118, v174, v178
    v_dot2_f32_bf16 v182, v118, v118, v182
    v_dot2_f32_bf16 v178, v119, v174, v178
    v_dot2_f32_bf16 v182, v119, v119, v182
    v_dot2_f32_bf16 v178, v120, v174, v178
    v_dot2_f32_bf16 v182, v120, v120, v182
    v_dot2_f32_bf16 v178, v121, v174, v178
    v_dot2_f32_bf16 v182, v121, v121, v182
    v_mfma_f32_16x16x32_bf16 v[78:81], v[126:129], v[118:121], v[78:81]
    s_waitcnt lgkmcnt(12)
    v_add_f32 v204, v204, v206
    s_waitcnt lgkmcnt(10)
    v_add_f32 v205, v205, v207
    v_mfma_f32_16x16x32_bf16 v[82:85], v[126:129], v[122:125], v[82:85]
    buffer_store_dwordx2 v[204:205], v45, s[16:19], s44 offen sc1
    ds_read_b64_tr_b16 v[158:159], v31 offset:16384
    v_mfma_f32_16x16x32_bf16 v[86:89], v[130:133], v[118:121], v[86:89]
    buffer_load_dwordx4 v16, s[4:7], s30 offen offset:1024 lds
    ds_read_b64_tr_b16 v[160:161], v31 offset:17408
    v_mfma_f32_16x16x32_bf16 v[90:93], v[130:133], v[122:125], v[90:93]
    ds_read_b64_tr_b16 v[162:163], v32 offset:16384
    v_mfma_f32_16x16x32_bf16 v[94:97], v[134:137], v[118:121], v[94:97]
    buffer_load_dwordx4 v17, s[4:7], s30 offen offset:2048 lds
    ds_read_b64_tr_b16 v[164:165], v32 offset:17408
    v_mfma_f32_16x16x32_bf16 v[98:101], v[134:137], v[122:125], v[98:101]
    ds_read_b64_tr_b16 v[166:167], v33 offset:16384
    ds_read_b64_tr_b16 v[168:169], v33 offset:17408
    v_mfma_f32_16x16x32_bf16 v[102:105], v[138:141], v[118:121], v[102:105]
    buffer_load_dwordx4 v18, s[4:7], s30 offen offset:3072 lds
    ds_read_b64_tr_b16 v[170:171], v34 offset:16384
    v_mfma_f32_16x16x32_bf16 v[106:109], v[138:141], v[122:125], v[106:109]
    ds_read_b64_tr_b16 v[172:173], v34 offset:17408
    v_dot2_f32_bf16 v179, v122, v174, v179
    v_dot2_f32_bf16 v183, v122, v122, v183
    v_dot2_f32_bf16 v179, v123, v174, v179
    v_dot2_f32_bf16 v183, v123, v123, v183
    v_dot2_f32_bf16 v179, v124, v174, v179
    v_dot2_f32_bf16 v183, v124, v124, v183
    v_dot2_f32_bf16 v179, v125, v174, v179
    v_dot2_f32_bf16 v183, v125, v125, v183
    s_waitcnt lgkmcnt(14)
    v_mfma_f32_16x16x32_bf16 v[46:49], v[142:145], v[110:113], v[46:49]
    ds_read_b128 v[118:121], v24 offset:16384
    v_permlane16_swap_b32 v178, v179
    s_add_u32 m0, s33, 49152
    v_mfma_f32_16x16x32_bf16 v[50:53], v[142:145], v[114:117], v[50:53]
    v_permlane16_swap_b32 v182, v183
    ds_read_b128 v[122:125], v24 offset:18432
    s_waitcnt lgkmcnt(14)
    v_mfma_f32_16x16x32_bf16 v[54:57], v[146:149], v[110:113], v[54:57]
    v_add_f32 v178, v178, v179
    ds_read_b64_tr_b16 v[126:127], v35 offset:16384
    v_add_f32 v182, v182, v183
    v_mfma_f32_16x16x32_bf16 v[58:61], v[146:149], v[114:117], v[58:61]
    ds_read_b64_tr_b16 v[128:129], v35 offset:17408
    v_permlane32_swap_b32 v178, v182
    s_waitcnt lgkmcnt(14)
    v_mfma_f32_16x16x32_bf16 v[62:65], v[150:153], v[110:113], v[62:65]
    buffer_load_dwordx4 v19, s[8:11], s31 offen offset:0 lds
    v_add_f32 v178, v178, v182
    buffer_store_dword v178, v44, s[16:19], s41 offen sc1
    v_mfma_f32_16x16x32_bf16 v[66:69], v[150:153], v[114:117], v[66:69]
    ds_read_b64_tr_b16 v[130:131], v36 offset:16384
    ds_read_b64_tr_b16 v[132:133], v36 offset:17408
    s_waitcnt lgkmcnt(14)
    v_mfma_f32_16x16x32_bf16 v[70:73], v[154:157], v[110:113], v[70:73]
    ds_read_b64_tr_b16 v[134:135], v37 offset:16384
    buffer_load_dwordx4 v20, s[8:11], s31 offen offset:1024 lds
    ds_read_b64_tr_b16 v[136:137], v37 offset:17408
    v_mfma_f32_16x16x32_bf16 v[74:77], v[154:157], v[114:117], v[74:77]
    ds_read_b64_tr_b16 v[138:139], v38 offset:16384
    ds_read_b64_tr_b16 v[140:141], v38 offset:17408
    s_waitcnt lgkmcnt(15)
    v_mfma_f32_16x16x32_bf16 v[78:81], v[158:161], v[110:113], v[78:81]
    ds_read_b64_tr_b16 v[142:143], v39 offset:16384
    buffer_load_dwordx4 v21, s[8:11], s31 offen offset:2048 lds
    v_mfma_f32_16x16x32_bf16 v[82:85], v[158:161], v[114:117], v[82:85]
    ds_read_b64_tr_b16 v[144:145], v39 offset:17408
    s_waitcnt lgkmcnt(15)
    v_mfma_f32_16x16x32_bf16 v[86:89], v[162:165], v[110:113], v[86:89]
    ds_read_b64_tr_b16 v[146:147], v40 offset:16384
    buffer_load_dwordx4 v22, s[8:11], s31 offen offset:3072 lds
    v_mfma_f32_16x16x32_bf16 v[90:93], v[162:165], v[114:117], v[90:93]
    ds_read_b64_tr_b16 v[148:149], v40 offset:17408
    s_waitcnt lgkmcnt(15)
    v_mfma_f32_16x16x32_bf16 v[94:97], v[166:169], v[110:113], v[94:97]
    ds_read_b64_tr_b16 v[150:151], v41 offset:16384
    v_mfma_f32_16x16x32_bf16 v[98:101], v[166:169], v[114:117], v[98:101]
    ds_read_b64_tr_b16 v[152:153], v41 offset:17408
    s_add_u32 s30, s30, 128
    s_add_u32 s31, s31, 245760
    s_cmp_eq_u32 s30, 1280
    s_cselect_b32 s30, 0, s30
    s_cselect_b32 s31, 0, s31
    s_waitcnt lgkmcnt(15)
    v_mfma_f32_16x16x32_bf16 v[102:105], v[170:173], v[110:113], v[102:105]
    ds_read_b64_tr_b16 v[154:155], v42 offset:16384
    v_mfma_f32_16x16x32_bf16 v[106:109], v[170:173], v[114:117], v[106:109]
    ds_read_b64_tr_b16 v[156:157], v42 offset:17408
    s_waitcnt lgkmcnt(0)
    s_waitcnt vmcnt(10)
    s_barrier
    v_mfma_f32_16x16x32_bf16 v[46:49], v[126:129], v[118:121], v[46:49]
    buffer_load_dword v5, off, s[24:27], s38 offset:128 sc1
    ds_read_b128 v[110:113], v23 offset:32768
    v_mfma_f32_16x16x32_bf16 v[50:53], v[126:129], v[122:125], v[50:53]
    s_add_u32 m0, s32, 0
    ds_read_b128 v[114:117], v23 offset:34816
    v_mfma_f32_16x16x32_bf16 v[54:57], v[130:133], v[118:121], v[54:57]
    ds_read_b64_tr_b16 v[158:159], v27 offset:32768
    ds_read_b64_tr_b16 v[160:161], v27 offset:33792
    v_mfma_f32_16x16x32_bf16 v[58:61], v[130:133], v[122:125], v[58:61]
    buffer_load_dwordx4 v15, s[4:7], s30 offen offset:0 lds
    v_mfma_f32_16x16x32_bf16 v[62:65], v[134:137], v[118:121], v[62:65]
    ds_read_b64_tr_b16 v[162:163], v28 offset:32768
    ds_read_b64_tr_b16 v[164:165], v28 offset:33792
    v_mfma_f32_16x16x32_bf16 v[66:69], v[134:137], v[122:125], v[66:69]
    ds_read_b64_tr_b16 v[166:167], v29 offset:32768
    buffer_load_dwordx4 v16, s[4:7], s30 offen offset:1024 lds
    v_mfma_f32_16x16x32_bf16 v[70:73], v[138:141], v[118:121], v[70:73]
    ds_read_b64_tr_b16 v[168:169], v29 offset:33792
    ds_read_b64_tr_b16 v[170:171], v30 offset:32768
    v_mfma_f32_16x16x32_bf16 v[74:77], v[138:141], v[122:125], v[74:77]
    ds_read_b64_tr_b16 v[172:173], v30 offset:33792
    v_mfma_f32_16x16x32_bf16 v[78:81], v[142:145], v[118:121], v[78:81]
    ds_read_b64_tr_b16 v[126:127], v31 offset:32768
    buffer_load_dwordx4 v17, s[4:7], s30 offen offset:2048 lds
    v_mfma_f32_16x16x32_bf16 v[82:85], v[142:145], v[122:125], v[82:85]
    ds_read_b64_tr_b16 v[128:129], v31 offset:33792
    v_mfma_f32_16x16x32_bf16 v[86:89], v[146:149], v[118:121], v[86:89]
    ds_read_b64_tr_b16 v[130:131], v32 offset:32768
    v_mfma_f32_16x16x32_bf16 v[90:93], v[146:149], v[122:125], v[90:93]
    ds_read_b64_tr_b16 v[132:133], v32 offset:33792
    v_mfma_f32_16x16x32_bf16 v[94:97], v[150:153], v[118:121], v[94:97]
    ds_read_b64_tr_b16 v[134:135], v33 offset:32768
    buffer_load_dwordx4 v18, s[4:7], s30 offen offset:3072 lds
    v_mfma_f32_16x16x32_bf16 v[98:101], v[150:153], v[122:125], v[98:101]
    ds_read_b64_tr_b16 v[136:137], v33 offset:33792
    v_mfma_f32_16x16x32_bf16 v[102:105], v[154:157], v[118:121], v[102:105]
    ds_read_b64_tr_b16 v[138:139], v34 offset:32768
    v_mfma_f32_16x16x32_bf16 v[106:109], v[154:157], v[122:125], v[106:109]
    ds_read_b64_tr_b16 v[140:141], v34 offset:33792
    s_waitcnt lgkmcnt(14)
    v_mfma_f32_16x16x32_bf16 v[46:49], v[158:161], v[110:113], v[46:49]
    ds_read_b128 v[118:121], v24 offset:32768
    s_add_u32 m0, s33, 0
    v_mfma_f32_16x16x32_bf16 v[50:53], v[158:161], v[114:117], v[50:53]
    ds_read_b128 v[122:125], v24 offset:34816
    ds_read_b64_tr_b16 v[142:143], v35 offset:32768
    s_waitcnt lgkmcnt(15)
    v_mfma_f32_16x16x32_bf16 v[54:57], v[162:165], v[110:113], v[54:57]
    buffer_load_dwordx4 v19, s[8:11], s31 offen offset:0 lds
    ds_read_b64_tr_b16 v[144:145], v35 offset:33792
    v_mfma_f32_16x16x32_bf16 v[58:61], v[162:165], v[114:117], v[58:61]
    ds_read_b64_tr_b16 v[146:147], v36 offset:32768
    s_waitcnt lgkmcnt(15)
    v_mfma_f32_16x16x32_bf16 v[62:65], v[166:169], v[110:113], v[62:65]
    ds_read_b64_tr_b16 v[148:149], v36 offset:33792
    buffer_load_dwordx4 v20, s[8:11], s31 offen offset:1024 lds
    v_mfma_f32_16x16x32_bf16 v[66:69], v[166:169], v[114:117], v[66:69]
    ds_read_b64_tr_b16 v[150:151], v37 offset:32768
    ds_read_b64_tr_b16 v[152:153], v37 offset:33792
    s_waitcnt lgkmcnt(15)
    v_mfma_f32_16x16x32_bf16 v[70:73], v[170:173], v[110:113], v[70:73]
    buffer_load_dwordx4 v21, s[8:11], s31 offen offset:2048 lds
    ds_read_b64_tr_b16 v[154:155], v38 offset:32768
    v_mfma_f32_16x16x32_bf16 v[74:77], v[170:173], v[114:117], v[74:77]
    ds_read_b64_tr_b16 v[156:157], v38 offset:33792
    s_waitcnt lgkmcnt(15)
    v_mfma_f32_16x16x32_bf16 v[78:81], v[126:129], v[110:113], v[78:81]
    ds_read_b64_tr_b16 v[158:159], v39 offset:32768
    buffer_load_dwordx4 v22, s[8:11], s31 offen offset:3072 lds
    v_mfma_f32_16x16x32_bf16 v[82:85], v[126:129], v[114:117], v[82:85]
    ds_read_b64_tr_b16 v[160:161], v39 offset:33792
    s_add_u32 s30, s30, 128
    s_add_u32 s31, s31, 245760
    s_cmp_eq_u32 s30, 1280
    s_cselect_b32 s30, 0, s30
    s_cselect_b32 s31, 0, s31
    s_waitcnt lgkmcnt(15)
    v_mfma_f32_16x16x32_bf16 v[86:89], v[130:133], v[110:113], v[86:89]
    ds_read_b64_tr_b16 v[162:163], v40 offset:32768
    v_mfma_f32_16x16x32_bf16 v[90:93], v[130:133], v[114:117], v[90:93]
    ds_read_b64_tr_b16 v[164:165], v40 offset:33792
    s_add_u32 m0, s32, 16384
    s_waitcnt lgkmcnt(15)
    v_mfma_f32_16x16x32_bf16 v[94:97], v[134:137], v[110:113], v[94:97]
    ds_read_b64_tr_b16 v[166:167], v41 offset:32768
    buffer_load_dwordx4 v15, s[4:7], s30 offen offset:0 lds
    v_mfma_f32_16x16x32_bf16 v[98:101], v[134:137], v[114:117], v[98:101]
    ds_read_b64_tr_b16 v[168:169], v41 offset:33792
    s_waitcnt lgkmcnt(15)
    v_mfma_f32_16x16x32_bf16 v[102:105], v[138:141], v[110:113], v[102:105]
    ds_read_b64_tr_b16 v[170:171], v42 offset:32768
    buffer_load_dwordx4 v16, s[4:7], s30 offen offset:1024 lds
    v_mfma_f32_16x16x32_bf16 v[106:109], v[138:141], v[114:117], v[106:109]
    ds_read_b64_tr_b16 v[172:173], v42 offset:33792
    s_waitcnt lgkmcnt(0)
    s_waitcnt vmcnt(11)
    s_barrier
    v_mfma_f32_16x16x32_bf16 v[46:49], v[142:145], v[118:121], v[46:49]
    s_waitcnt vmcnt(10)
    v_cmp_gt_u32 vcc, s39, v5
    s_cbranch_vccz A_c0x
    s_mov_b32 s34, 0x40000
A_c0:
    buffer_load_dword v5, off, s[24:27], s38 offset:128 sc1
    s_sub_u32 s34, s34, 1
    s_waitcnt vmcnt(0)
    v_cmp_gt_u32 vcc, s39, v5
    s_cbranch_scc1 A_c0x
    s_cbranch_vccnz A_c0
A_c0x:
    s_mov_b64 exec, 1
    buffer_store_dword v4, off, s[80:83], s40 sc1
    s_mov_b64 exec, -1
    v_mfma_f32_16x16x32_bf16 v[50:53], v[142:145], v[122:125], v[50:53]
    ds_read_b128 v[110:113], v23 offset:49152
    buffer_load_dwordx4 v17, s[4:7], s30 offen offset:2048 lds
    v_mfma_f32_16x16x32_bf16 v[54:57], v[146:149], v[118:121], v[54:57]
    ds_read_b128 v[114:117], v23 offset:51200
    ds_read_b64_tr_b16 v[126:127], v27 offset:49152
    v_mfma_f32_16x16x32_bf16 v[58:61], v[146:149], v[122:125], v[58:61]
    ds_read_b64_tr_b16 v[128:129], v27 offset:50176
    v_mfma_f32_16x16x32_bf16 v[62:65], v[150:153], v[118:121], v[62:65]
    ds_read_b64_tr_b16 v[130:131], v28 offset:49152
    ds_read_b64_tr_b16 v[132:133], v28 offset:50176
    v_mfma_f32_16x16x32_bf16 v[66:69], v[150:153], v[122:125], v[66:69]
    buffer_load_dwordx4 v18, s[4:7], s30 offen offset:3072 lds
    ds_read_b64_tr_b16 v[134:135], v29 offset:49152
    v_mfma_f32_16x16x32_bf16 v[70:73], v[154:157], v[118:121], v[70:73]
    ds_read_b64_tr_b16 v[136:137], v29 offset:50176
    ds_read_b64_tr_b16 v[138:139], v30 offset:49152
    v_mfma_f32_16x16x32_bf16 v[74:77], v[154:157], v[122:125], v[74:77]
    ds_read_b64_tr_b16 v[140:141], v30 offset:50176
    v_mfma_f32_16x16x32_bf16 v[78:81], v[158:161], v[118:121], v[78:81]
    ds_read_b64_tr_b16 v[142:143], v31 offset:49152
    s_add_u32 m0, s33, 16384
    v_mfma_f32_16x16x32_bf16 v[82:85], v[158:161], v[122:125], v[82:85]
    ds_read_b64_tr_b16 v[144:145], v31 offset:50176
    v_mfma_f32_16x16x32_bf16 v[86:89], v[162:165], v[118:121], v[86:89]
    ds_read_b64_tr_b16 v[146:147], v32 offset:49152
    buffer_load_dwordx4 v19, s[8:11], s31 offen offset:0 lds
    v_mfma_f32_16x16x32_bf16 v[90:93], v[162:165], v[122:125], v[90:93]
    ds_read_b64_tr_b16 v[148:149], v32 offset:50176
    v_mfma_f32_16x16x32_bf16 v[94:97], v[166:169], v[118:121], v[94:97]
    ds_read_b64_tr_b16 v[150:151], v33 offset:49152
    v_mfma_f32_16x16x32_bf16 v[98:101], v[166:169], v[122:125], v[98:101]
    ds_read_b64_tr_b16 v[152:153], v33 offset:50176
    buffer_load_dwordx4 v20, s[8:11], s31 offen offset:1024 lds
    v_mfma_f32_16x16x32_bf16 v[102:105], v[170:173], v[118:121], v[102:105]
    ds_read_b64_tr_b16 v[154:155], v34 offset:49152
    v_mfma_f32_16x16x32_bf16 v[106:109], v[170:173], v[122:125], v[106:109]
    ds_read_b64_tr_b16 v[156:157], v34 offset:50176
    s_waitcnt lgkmcnt(14)
    v_mfma_f32_16x16x32_bf16 v[46:49], v[126:129], v[110:113], v[46:49]
    ds_read_b128 v[118:121], v24 offset:49152
    buffer_load_dwordx4 v21, s[8:11], s31 offen offset:2048 lds
    v_mfma_f32_16x16x32_bf16 v[50:53], v[126:129], v[114:117], v[50:53]
    ds_read_b128 v[122:125], v24 offset:51200
    ds_read_b64_tr_b16 v[158:159], v35 offset:49152
    s_waitcnt lgkmcnt(15)
    v_mfma_f32_16x16x32_bf16 v[54:57], v[130:133], v[110:113], v[54:57]
    buffer_load_dwordx4 v22, s[8:11], s31 offen offset:3072 lds
    ds_read_b64_tr_b16 v[160:161], v35 offset:50176
    v_mfma_f32_16x16x32_bf16 v[58:61], v[130:133], v[114:117], v[58:61]
    ds_read_b64_tr_b16 v[162:163], v36 offset:49152
    s_add_u32 s30, s30, 128
    s_add_u32 s31, s31, 245760
    s_cmp_eq_u32 s30, 1280
    s_cselect_b32 s30, 0, s30
    s_cselect_b32 s31, 0, s31
    s_waitcnt lgkmcnt(15)
    v_mfma_f32_16x16x32_bf16 v[62:65], v[134:137], v[110:113], v[62:65]
    ds_read_b64_tr_b16 v[164:165], v36 offset:50176
    ds_read_b64_tr_b16 v[166:167], v37 offset:49152
    v_mfma_f32_16x16x32_bf16 v[66:69], v[134:137], v[114:117], v[66:69]
    s_add_u32 m0, s32, 32768
    ds_read_b64_tr_b16 v[168:169], v37 offset:50176
    s_waitcnt lgkmcnt(15)
    v_mfma_f32_16x16x32_bf16 v[70:73], v[138:141], v[110:113], v[70:73]
    ds_read_b64_tr_b16 v[170:171], v38 offset:49152
    buffer_load_dwordx4 v15, s[4:7], s30 offen offset:0 lds
    v_mfma_f32_16x16x32_bf16 v[74:77], v[138:141], v[114:117], v[74:77]
    ds_read_b64_tr_b16 v[172:173], v38 offset:50176
    s_waitcnt lgkmcnt(15)
    v_mfma_f32_16x16x32_bf16 v[78:81], v[142:145], v[110:113], v[78:81]
    ds_read_b64_tr_b16 v[126:127], v39 offset:49152
    buffer_load_dwordx4 v16, s[4:7], s30 offen offset:1024 lds
    v_mfma_f32_16x16x32_bf16 v[82:85], v[142:145], v[114:117], v[82:85]
    ds_read_b64_tr_b16 v[128:129], v39 offset:50176
    s_waitcnt lgkmcnt(15)
    v_mfma_f32_16x16x32_bf16 v[86:89], v[146:149], v[110:113], v[86:89]
    ds_read_b64_tr_b16 v[130:131], v40 offset:49152
    buffer_load_dwordx4 v17, s[4:7], s30 offen offset:2048 lds
    v_mfma_f32_16x16x32_bf16 v[90:93], v[146:149], v[114:117], v[90:93]
    ds_read_b64_tr_b16 v[132:133], v40 offset:50176
    s_waitcnt lgkmcnt(15)
    v_mfma_f32_16x16x32_bf16 v[94:97], v[150:153], v[110:113], v[94:97]
    ds_read_b64_tr_b16 v[134:135], v41 offset:49152
    v_mfma_f32_16x16x32_bf16 v[98:101], v[150:153], v[114:117], v[98:101]
    ds_read_b64_tr_b16 v[136:137], v41 offset:50176
    buffer_load_dwordx4 v18, s[4:7], s30 offen offset:3072 lds
    s_waitcnt lgkmcnt(15)
    v_mfma_f32_16x16x32_bf16 v[102:105], v[154:157], v[110:113], v[102:105]
    ds_read_b64_tr_b16 v[138:139], v42 offset:49152
    v_mfma_f32_16x16x32_bf16 v[106:109], v[154:157], v[114:117], v[106:109]
    ds_read_b64_tr_b16 v[140:141], v42 offset:50176
    s_waitcnt lgkmcnt(0)
    s_waitcnt vmcnt(13)
    s_barrier
    v_mfma_f32_16x16x32_bf16 v[46:49], v[158:161], v[118:121], v[46:49]
    ds_read_b128 v[110:113], v23 offset:0
    s_add_u32 m0, s33, 32768
    v_mfma_f32_16x16x32_bf16 v[50:53], v[158:161], v[122:125], v[50:53]
    ds_read_b128 v[114:117], v23 offset:2048
    ds_read_b64_tr_b16 v[142:143], v27 offset:0
    v_mfma_f32_16x16x32_bf16 v[54:57], v[162:165], v[118:121], v[54:57]
    ds_read_b64_tr_b16 v[144:145], v27 offset:1024
    v_mfma_f32_16x16x32_bf16 v[58:61], v[162:165], v[122:125], v[58:61]
    buffer_load_dwordx4 v19, s[8:11], s31 offen offset:0 lds
    ds_read_b64_tr_b16 v[146:147], v28 offset:0
    v_mfma_f32_16x16x32_bf16 v[62:65], v[166:169], v[118:121], v[62:65]
    ds_read_b64_tr_b16 v[148:149], v28 offset:1024
    ds_read_b64_tr_b16 v[150:151], v29 offset:0
    v_mfma_f32_16x16x32_bf16 v[66:69], v[166:169], v[122:125], v[66:69]
    buffer_load_dwordx4 v20, s[8:11], s31 offen offset:1024 lds
    v_mfma_f32_16x16x32_bf16 v[70:73], v[170:173], v[118:121], v[70:73]
    ds_read_b64_tr_b16 v[152:153], v29 offset:1024
    ds_read_b64_tr_b16 v[154:155], v30 offset:0
    v_mfma_f32_16x16x32_bf16 v[74:77], v[170:173], v[122:125], v[74:77]
    ds_read_b64_tr_b16 v[156:157], v30 offset:1024
    v_mfma_f32_16x16x32_bf16 v[78:81], v[126:129], v[118:121], v[78:81]
    ds_read_b64_tr_b16 v[158:159], v31 offset:0
    buffer_load_dwordx4 v21, s[8:11], s31 offen offset:2048 lds
    v_mfma_f32_16x16x32_bf16 v[82:85], v[126:129], v[122:125], v[82:85]
    ds_read_b64_tr_b16 v[160:161], v31 offset:1024
    v_mfma_f32_16x16x32_bf16 v[86:89], v[130:133], v[118:121], v[86:89]
    ds_read_b64_tr_b16 v[162:163], v32 offset:0
    buffer_load_dwordx4 v22, s[8:11], s31 offen offset:3072 lds
    v_mfma_f32_16x16x32_bf16 v[90:93], v[130:133], v[122:125], v[90:93]
    ds_read_b64_tr_b16 v[164:165], v32 offset:1024
    v_mfma_f32_16x16x32_bf16 v[94:97], v[134:137], v[118:121], v[94:97]
    ds_read_b64_tr_b16 v[166:167], v33 offset:0
    v_mfma_f32_16x16x32_bf16 v[98:101], v[134:137], v[122:125], v[98:101]
    ds_read_b64_tr_b16 v[168:169], v33 offset:1024
    s_add_u32 s30, s30, 128
    s_add_u32 s31, s31, 245760
    s_cmp_eq_u32 s30, 1280
    s_cselect_b32 s30, 0, s30
    s_cselect_b32 s31, 0, s31
    v_mfma_f32_16x16x32_bf16 v[102:105], v[138:141], v[118:121], v[102:105]
    ds_read_b64_tr_b16 v[170:171], v34 offset:0
    v_mfma_f32_16x16x32_bf16 v[106:109], v[138:141], v[122:125], v[106:109]
    ds_read_b64_tr_b16 v[172:173], v34 offset:1024
    s_waitcnt lgkmcnt(14)
    v_mfma_f32_16x16x32_bf16 v[46:49], v[142:145], v[110:113], v[46:49]
    ds_read_b128 v[118:121], v24 offset:0
    s_add_u32 m0, s32, 49152
    v_mfma_f32_16x16x32_bf16 v[50:53], v[142:145], v[114:117], v[50:53]
    ds_read_b128 v[122:125], v24 offset:2048
    ds_read_b64_tr_b16 v[126:127], v35 offset:0
    s_waitcnt lgkmcnt(15)
    v_mfma_f32_16x16x32_bf16 v[54:57], v[146:149], v[110:113], v[54:57]
    buffer_load_dwordx4 v15, s[4:7], s30 offen offset:0 lds
    ds_read_b64_tr_b16 v[128:129], v35 offset:1024
    v_mfma_f32_16x16x32_bf16 v[58:61], v[146:149], v[114:117], v[58:61]
    ds_read_b64_tr_b16 v[130:131], v36 offset:0
    s_waitcnt lgkmcnt(15)
    v_mfma_f32_16x16x32_bf16 v[62:65], v[150:153], v[110:113], v[62:65]
    ds_read_b64_tr_b16 v[132:133], v36 offset:1024
    buffer_load_dwordx4 v16, s[4:7], s30 offen offset:1024 lds
    v_mfma_f32_16x16x32_bf16 v[66:69], v[150:153], v[114:117], v[66:69]
    ds_read_b64_tr_b16 v[134:135], v37 offset:0
    ds_read_b64_tr_b16 v[136:137], v37 offset:1024
    s_waitcnt lgkmcnt(15)
    v_mfma_f32_16x16x32_bf16 v[70:73], v[154:157], v[110:113], v[70:73]
    buffer_load_dwordx4 v17, s[4:7], s30 offen offset:2048 lds
    ds_read_b64_tr_b16 v[138:139], v38 offset:0
    v_mfma_f32_16x16x32_bf16 v[74:77], v[154:157], v[114:117], v[74:77]
    ds_read_b64_tr_b16 v[140:141], v38 offset:1024
    s_waitcnt lgkmcnt(15)
    v_mfma_f32_16x16x32_bf16 v[78:81], v[158:161], v[110:113], v[78:81]
    ds_read_b64_tr_b16 v[142:143], v39 offset:0
    buffer_load_dwordx4 v18, s[4:7], s30 offen offset:3072 lds
    v_mfma_f32_16x16x32_bf16 v[82:85], v[158:161], v[114:117], v[82:85]
    ds_read_b64_tr_b16 v[144:145], v39 offset:1024
    s_waitcnt lgkmcnt(15)
    v_mfma_f32_16x16x32_bf16 v[86:89], v[162:165], v[110:113], v[86:89]
    ds_read_b64_tr_b16 v[146:147], v40 offset:0
    s_add_u32 m0, s33, 49152
    v_mfma_f32_16x16x32_bf16 v[90:93], v[162:165], v[114:117], v[90:93]
    ds_read_b64_tr_b16 v[148:149], v40 offset:1024
    s_waitcnt lgkmcnt(15)
    v_mfma_f32_16x16x32_bf16 v[94:97], v[166:169], v[110:113], v[94:97]
    ds_read_b64_tr_b16 v[150:151], v41 offset:0
    buffer_load_dwordx4 v19, s[8:11], s31 offen offset:0 lds
    v_mfma_f32_16x16x32_bf16 v[98:101], v[166:169], v[114:117], v[98:101]
    ds_read_b64_tr_b16 v[152:153], v41 offset:1024
    s_waitcnt lgkmcnt(15)
    v_mfma_f32_16x16x32_bf16 v[102:105], v[170:173], v[110:113], v[102:105]
    ds_read_b64_tr_b16 v[154:155], v42 offset:0
    buffer_load_dwordx4 v20, s[8:11], s31 offen offset:1024 lds
    v_mfma_f32_16x16x32_bf16 v[106:109], v[170:173], v[114:117], v[106:109]
    ds_read_b64_tr_b16 v[156:157], v42 offset:1024
    s_waitcnt lgkmcnt(0)
    s_waitcnt vmcnt(14)
    s_barrier
    v_mfma_f32_16x16x32_bf16 v[46:49], v[126:129], v[118:121], v[46:49]
    ds_read_b128 v[110:113], v23 offset:16384
    buffer_load_dwordx4 v21, s[8:11], s31 offen offset:2048 lds
    v_mfma_f32_16x16x32_bf16 v[50:53], v[126:129], v[122:125], v[50:53]
    ds_read_b128 v[114:117], v23 offset:18432
    ds_read_b64_tr_b16 v[158:159], v27 offset:16384
    v_mfma_f32_16x16x32_bf16 v[54:57], v[130:133], v[118:121], v[54:57]
    ds_read_b64_tr_b16 v[160:161], v27 offset:17408
    v_mfma_f32_16x16x32_bf16 v[58:61], v[130:133], v[122:125], v[58:61]
    buffer_load_dwordx4 v22, s[8:11], s31 offen offset:3072 lds
    ds_read_b64_tr_b16 v[162:163], v28 offset:16384
    v_mfma_f32_16x16x32_bf16 v[62:65], v[134:137], v[118:121], v[62:65]
    ds_read_b64_tr_b16 v[164:165], v28 offset:17408
    ds_read_b64_tr_b16 v[166:167], v29 offset:16384
    v_mfma_f32_16x16x32_bf16 v[66:69], v[134:137], v[122:125], v[66:69]
    s_add_u32 s30, s30, 128
    s_add_u32 s31, s31, 245760
    s_cmp_eq_u32 s30, 1280
    s_cselect_b32 s30, 0, s30
    s_cselect_b32 s31, 0, s31
    v_mfma_f32_16x16x32_bf16 v[70:73], v[138:141], v[118:121], v[70:73]
    ds_read_b64_tr_b16 v[168:169], v29 offset:17408
    ds_read_b64_tr_b16 v[170:171], v30 offset:16384
    v_mfma_f32_16x16x32_bf16 v[74:77], v[138:141], v[122:125], v[74:77]
    ds_read_b64_tr_b16 v[172:173], v30 offset:17408
    v_mfma_f32_16x16x32_bf16 v[78:81], v[142:145], v[118:121], v[78:81]
    ds_read_b64_tr_b16 v[126:127], v31 offset:16384
    s_add_u32 m0, s32, 0
    v_mfma_f32_16x16x32_bf16 v[82:85], v[142:145], v[122:125], v[82:85]
    ds_read_b64_tr_b16 v[128:129], v31 offset:17408
    v_mfma_f32_16x16x32_bf16 v[86:89], v[146:149], v[118:121], v[86:89]
    ds_read_b64_tr_b16 v[130:131], v32 offset:16384
    buffer_load_dwordx4 v15, s[4:7], s30 offen offset:0 lds
    v_mfma_f32_16x16x32_bf16 v[90:93], v[146:149], v[122:125], v[90:93]
    ds_read_b64_tr_b16 v[132:133], v32 offset:17408
    v_mfma_f32_16x16x32_bf16 v[94:97], v[150:153], v[118:121], v[94:97]
    ds_read_b64_tr_b16 v[134:135], v33 offset:16384
    v_mfma_f32_16x16x32_bf16 v[98:101], v[150:153], v[122:125], v[98:101]
    ds_read_b64_tr_b16 v[136:137], v33 offset:17408
    buffer_load_dwordx4 v16, s[4:7], s30 offen offset:1024 lds
    v_mfma_f32_16x16x32_bf16 v[102:105], v[154:157], v[118:121], v[102:105]
    ds_read_b64_tr_b16 v[138:139], v34 offset:16384
    v_mfma_f32_16x16x32_bf16 v[106:109], v[154:157], v[122:125], v[106:109]
    ds_read_b64_tr_b16 v[140:141], v34 offset:17408
    s_waitcnt lgkmcnt(14)
    v_mfma_f32_16x16x32_bf16 v[46:49], v[158:161], v[110:113], v[46:49]
    ds_read_b128 v[118:121], v24 offset:16384
    buffer_load_dwordx4 v17, s[4:7], s30 offen offset:2048 lds
    v_mfma_f32_16x16x32_bf16 v[50:53], v[158:161], v[114:117], v[50:53]
    ds_read_b128 v[122:125], v24 offset:18432
    ds_read_b64_tr_b16 v[142:143], v35 offset:16384
    s_waitcnt lgkmcnt(15)
    v_mfma_f32_16x16x32_bf16 v[54:57], v[162:165], v[110:113], v[54:57]
    buffer_load_dwordx4 v18, s[4:7], s30 offen offset:3072 lds
    ds_read_b64_tr_b16 v[144:145], v35 offset:17408
    v_mfma_f32_16x16x32_bf16 v[58:61], v[162:165], v[114:117], v[58:61]
    ds_read_b64_tr_b16 v[146:147], v36 offset:16384
    s_waitcnt lgkmcnt(15)
    v_mfma_f32_16x16x32_bf16 v[62:65], v[166:169], v[110:113], v[62:65]
    ds_read_b64_tr_b16 v[148:149], v36 offset:17408
    s_add_u32 m0, s33, 0
    v_mfma_f32_16x16x32_bf16 v[66:69], v[166:169], v[114:117], v[66:69]
    ds_read_b64_tr_b16 v[150:151], v37 offset:16384
    ds_read_b64_tr_b16 v[152:153], v37 offset:17408
    s_waitcnt lgkmcnt(15)
    v_mfma_f32_16x16x32_bf16 v[70:73], v[170:173], v[110:113], v[70:73]
    buffer_load_dwordx4 v19, s[8:11], s31 offen offset:0 lds
    ds_read_b64_tr_b16 v[154:155], v38 offset:16384
    v_mfma_f32_16x16x32_bf16 v[74:77], v[170:173], v[114:117], v[74:77]
    ds_read_b64_tr_b16 v[156:157], v38 offset:17408
    s_waitcnt lgkmcnt(15)
    v_mfma_f32_16x16x32_bf16 v[78:81], v[126:129], v[110:113], v[78:81]
    buffer_load_dword v5, v43, s[80:83], 0 offen sc1
    ds_read_b64_tr_b16 v[158:159], v39 offset:16384
    v_mfma_f32_16x16x32_bf16 v[82:85], v[126:129], v[114:117], v[82:85]
    buffer_load_dwordx4 v20, s[8:11], s31 offen offset:1024 lds
    ds_read_b64_tr_b16 v[160:161], v39 offset:17408
    s_waitcnt lgkmcnt(15)
    v_mfma_f32_16x16x32_bf16 v[86:89], v[130:133], v[110:113], v[86:89]
    ds_read_b64_tr_b16 v[162:163], v40 offset:16384
    v_mfma_f32_16x16x32_bf16 v[90:93], v[130:133], v[114:117], v[90:93]
    buffer_load_dwordx4 v21, s[8:11], s31 offen offset:2048 lds
    ds_read_b64_tr_b16 v[164:165], v40 offset:17408
    s_waitcnt lgkmcnt(15)
    v_mfma_f32_16x16x32_bf16 v[94:97], v[134:137], v[110:113], v[94:97]
    ds_read_b64_tr_b16 v[166:167], v41 offset:16384
    buffer_load_dwordx4 v22, s[8:11], s31 offen offset:3072 lds
    v_mfma_f32_16x16x32_bf16 v[98:101], v[134:137], v[114:117], v[98:101]
    ds_read_b64_tr_b16 v[168:169], v41 offset:17408
    s_waitcnt lgkmcnt(15)
    v_mfma_f32_16x16x32_bf16 v[102:105], v[138:141], v[110:113], v[102:105]
    ds_read_b64_tr_b16 v[170:171], v42 offset:16384
    s_add_u32 s30, s30, 128
    s_add_u32 s31, s31, 245760
    s_cmp_eq_u32 s30, 1280
    s_cselect_b32 s30, 0, s30
    s_cselect_b32 s31, 0, s31
    v_mfma_f32_16x16x32_bf16 v[106:109], v[138:141], v[114:117], v[106:109]
    ds_read_b64_tr_b16 v[172:173], v42 offset:17408
    s_waitcnt lgkmcnt(0)
    s_waitcnt vmcnt(17)
    s_barrier
    v_mfma_f32_16x16x32_bf16 v[46:49], v[142:145], v[118:121], v[46:49]
    ds_read_b128 v[110:113], v23 offset:32768
    s_add_u32 m0, s32, 16384
    v_mfma_f32_16x16x32_bf16 v[50:53], v[142:145], v[122:125], v[50:53]
    ds_read_b128 v[114:117], v23 offset:34816
    ds_read_b64_tr_b16 v[126:127], v27 offset:32768
    v_mfma_f32_16x16x32_bf16 v[54:57], v[146:149], v[118:121], v[54:57]
    ds_read_b64_tr_b16 v[128:129], v27 offset:33792
    v_mfma_f32_16x16x32_bf16 v[58:61], v[146:149], v[122:125], v[58:61]
    buffer_load_dwordx4 v15, s[4:7], s30 offen offset:0 lds
    ds_read_b64_tr_b16 v[130:131], v28 offset:32768
    v_mfma_f32_16x16x32_bf16 v[62:65], v[150:153], v[118:121], v[62:65]
    ds_read_b64_tr_b16 v[132:133], v28 offset:33792
    ds_read_b64_tr_b16 v[134:135], v29 offset:32768
    v_mfma_f32_16x16x32_bf16 v[66:69], v[150:153], v[122:125], v[66:69]
    buffer_load_dwordx4 v16, s[4:7], s30 offen offset:1024 lds
    v_mfma_f32_16x16x32_bf16 v[70:73], v[154:157], v[118:121], v[70:73]
    ds_read_b64_tr_b16 v[136:137], v29 offset:33792
    ds_read_b64_tr_b16 v[138:139], v30 offset:32768
    v_mfma_f32_16x16x32_bf16 v[74:77], v[154:157], v[122:125], v[74:77]
    ds_read_b64_tr_b16 v[140:141], v30 offset:33792
    v_mfma_f32_16x16x32_bf16 v[78:81], v[158:161], v[118:121], v[78:81]
    ds_read_b64_tr_b16 v[142:143], v31 offset:32768
    buffer_load_dwordx4 v17, s[4:7], s30 offen offset:2048 lds
    v_mfma_f32_16x16x32_bf16 v[82:85], v[158:161], v[122:125], v[82:85]
    ds_read_b64_tr_b16 v[144:145], v31 offset:33792
    v_mfma_f32_16x16x32_bf16 v[86:89], v[162:165], v[118:121], v[86:89]
    ds_read_b64_tr_b16 v[146:147], v32 offset:32768
    v_mfma_f32_16x16x32_bf16 v[90:93], v[162:165], v[122:125], v[90:93]
    ds_read_b64_tr_b16 v[148:149], v32 offset:33792
    v_mfma_f32_16x16x32_bf16 v[94:97], v[166:169], v[118:121], v[94:97]
    ds_read_b64_tr_b16 v[150:151], v33 offset:32768
    buffer_load_dwordx4 v18, s[4:7], s30 offen offset:3072 lds
    v_mfma_f32_16x16x32_bf16 v[98:101], v[166:169], v[122:125], v[98:101]
    ds_read_b64_tr_b16 v[152:153], v33 offset:33792
    v_mfma_f32_16x16x32_bf16 v[102:105], v[170:173], v[118:121], v[102:105]
    ds_read_b64_tr_b16 v[154:155], v34 offset:32768
    v_mfma_f32_16x16x32_bf16 v[106:109], v[170:173], v[122:125], v[106:109]
    ds_read_b64_tr_b16 v[156:157], v34 offset:33792
    s_waitcnt lgkmcnt(14)
    v_mfma_f32_16x16x32_bf16 v[46:49], v[126:129], v[110:113], v[46:49]
    ds_read_b128 v[118:121], v24 offset:32768
    s_add_u32 m0, s33, 16384
    v_mfma_f32_16x16x32_bf16 v[50:53], v[126:129], v[114:117], v[50:53]
    ds_read_b128 v[122:125], v24 offset:34816
    ds_read_b64_tr_b16 v[158:159], v35 offset:32768
    s_waitcnt lgkmcnt(15)
    v_mfma_f32_16x16x32_bf16 v[54:57], v[130:133], v[110:113], v[54:57]
    buffer_load_dwordx4 v19, s[8:11], s31 offen offset:0 lds
    ds_read_b64_tr_b16 v[160:161], v35 offset:33792
    v_mfma_f32_16x16x32_bf16 v[58:61], v[130:133], v[114:117], v[58:61]
    ds_read_b64_tr_b16 v[162:163], v36 offset:32768
    s_waitcnt lgkmcnt(15)
    v_mfma_f32_16x16x32_bf16 v[62:65], v[134:137], v[110:113], v[62:65]
    ds_read_b64_tr_b16 v[164:165], v36 offset:33792
    buffer_load_dwordx4 v20, s[8:11], s31 offen offset:1024 lds
    v_mfma_f32_16x16x32_bf16 v[66:69], v[134:137], v[114:117], v[66:69]
    ds_read_b64_tr_b16 v[166:167], v37 offset:32768
    ds_read_b64_tr_b16 v[168:169], v37 offset:33792
    s_waitcnt lgkmcnt(15)
    v_mfma_f32_16x16x32_bf16 v[70:73], v[138:141], v[110:113], v[70:73]
    buffer_load_dwordx4 v21, s[8:11], s31 offen offset:2048 lds
    ds_read_b64_tr_b16 v[170:171], v38 offset:32768
    v_mfma_f32_16x16x32_bf16 v[74:77], v[138:141], v[114:117], v[74:77]
    ds_read_b64_tr_b16 v[172:173], v38 offset:33792
    s_waitcnt lgkmcnt(15)
    v_mfma_f32_16x16x32_bf16 v[78:81], v[142:145], v[110:113], v[78:81]
    ds_read_b64_tr_b16 v[126:127], v39 offset:32768
    buffer_load_dwordx4 v22, s[8:11], s31 offen offset:3072 lds
    v_mfma_f32_16x16x32_bf16 v[82:85], v[142:145], v[114:117], v[82:85]
    ds_read_b64_tr_b16 v[128:129], v39 offset:33792
    s_waitcnt lgkmcnt(15)
    v_mfma_f32_16x16x32_bf16 v[86:89], v[146:149], v[110:113], v[86:89]
    ds_read_b64_tr_b16 v[130:131], v40 offset:32768
    v_mfma_f32_16x16x32_bf16 v[90:93], v[146:149], v[114:117], v[90:93]
    ds_read_b64_tr_b16 v[132:133], v40 offset:33792
    s_waitcnt lgkmcnt(15)
    v_mfma_f32_16x16x32_bf16 v[94:97], v[150:153], v[110:113], v[94:97]
    ds_read_b64_tr_b16 v[134:135], v41 offset:32768
    s_add_u32 s30, s30, 128
    s_add_u32 s31, s31, 245760
    s_cmp_eq_u32 s30, 1280
    s_cselect_b32 s30, 0, s30
    s_cselect_b32 s31, 0, s31
    v_mfma_f32_16x16x32_bf16 v[98:101], v[150:153], v[114:117], v[98:101]
    ds_read_b64_tr_b16 v[136:137], v41 offset:33792
    s_waitcnt lgkmcnt(15)
    v_mfma_f32_16x16x32_bf16 v[102:105], v[154:157], v[110:113], v[102:105]
    ds_read_b64_tr_b16 v[138:139], v42 offset:32768
    v_mfma_f32_16x16x32_bf16 v[106:109], v[154:157], v[114:117], v[106:109]
    ds_read_b64_tr_b16 v[140:141], v42 offset:33792
    s_waitcnt lgkmcnt(0)
    s_waitcnt vmcnt(17)
    s_barrier
    v_mfma_f32_16x16x32_bf16 v[46:49], v[158:161], v[118:121], v[46:49]
    s_waitcnt vmcnt(11)
    v_cmp_ne_u32 vcc, v4, v5
    s_cbranch_vccz A_f0x
    s_mov_b32 s34, 0x40000
A_f0:
    buffer_load_dword v5, v43, s[80:83], 0 offen sc1
    s_sub_u32 s34, s34, 1
    s_waitcnt vmcnt(0)
    v_cmp_ne_u32 vcc, v4, v5
    s_cbranch_scc1 A_f0x
    s_cbranch_vccnz A_f0
A_f0x:
    ds_read_b128 v[110:113], v23 offset:49152
    buffer_load_dwordx2 v[204:205], v45, s[16:19], s101 offen offset:0 sc1
    v_mfma_f32_16x16x32_bf16 v[50:53], v[158:161], v[122:125], v[50:53]
    ds_read_b128 v[114:117], v23 offset:51200
    buffer_load_dwordx2 v[206:207], v45, s[16:19], s101 offen offset:2048 sc1
    v_mfma_f32_16x16x32_bf16 v[54:57], v[162:165], v[118:121], v[54:57]
    ds_read_b64_tr_b16 v[142:143], v27 offset:49152
    s_add_u32 s101, s101, 4096
    s_cmp_lt_u32 s3, 2
    s_cselect_b32 s101, s101, 805306368
    buffer_load_dwordx2 v[208:209], v45, s[16:19], s101 offen sc1
    v_mfma_f32_16x16x32_bf16 v[58:61], v[162:165], v[122:125], v[58:61]
    ds_read_b64_tr_b16 v[144:145], v27 offset:50176
    ds_read_b64_tr_b16 v[146:147], v28 offset:49152
    v_mfma_f32_16x16x32_bf16 v[62:65], v[166:169], v[118:121], v[62:65]
    buffer_load_dword v190, v44, s[16:19], s45 offen offset:0 sc1
    ds_read_b64_tr_b16 v[148:149], v28 offset:50176
    buffer_load_dword v191, v44, s[16:19], s45 offen offset:256 sc1
    v_mfma_f32_16x16x32_bf16 v[66:69], v[166:169], v[122:125], v[66:69]
    ds_read_b64_tr_b16 v[150:151], v29 offset:49152
    ds_read_b64_tr_b16 v[152:153], v29 offset:50176
    v_mfma_f32_16x16x32_bf16 v[70:73], v[170:173], v[118:121], v[70:73]
    buffer_load_dword v192, v44, s[16:19], s45 offen offset:512 sc1
    ds_read_b64_tr_b16 v[154:155], v30 offset:49152
    v_mfma_f32_16x16x32_bf16 v[74:77], v[170:173], v[122:125], v[74:77]
    buffer_load_dword v193, v44, s[16:19], s45 offen offset:768 sc1
    ds_read_b64_tr_b16 v[156:157], v30 offset:50176
    v_mfma_f32_16x16x32_bf16 v[78:81], v[126:129], v[118:121], v[78:81]
    ds_read_b64_tr_b16 v[158:159], v31 offset:49152
    ds_read_b64_tr_b16 v[160:161], v31 offset:50176
    v_mfma_f32_16x16x32_bf16 v[82:85], v[126:129], v[122:125], v[82:85]
    buffer_load_dword v194, v44, s[16:19], s45 offen offset:1024 sc1
    ds_read_b64_tr_b16 v[162:163], v32 offset:49152
    v_mfma_f32_16x16x32_bf16 v[86:89], v[130:133], v[118:121], v[86:89]
    buffer_load_dword v195, v44, s[16:19], s45 offen offset:1280 sc1
    ds_read_b64_tr_b16 v[164:165], v32 offset:50176
    v_mfma_f32_16x16x32_bf16 v[90:93], v[130:133], v[122:125], v[90:93]
    buffer_load_dword v196, v44, s[16:19], s45 offen offset:1536 sc1
    v_mfma_f32_16x16x32_bf16 v[94:97], v[134:137], v[118:121], v[94:97]
    ds_read_b64_tr_b16 v[166:167], v33 offset:49152
    buffer_load_dword v197, v44, s[16:19], s45 offen offset:1792 sc1
    v_mfma_f32_16x16x32_bf16 v[98:101], v[134:137], v[122:125], v[98:101]
    ds_read_b64_tr_b16 v[168:169], v33 offset:50176
    buffer_load_dword v198, v44, s[16:19], s45 offen offset:2048 sc1
    v_mfma_f32_16x16x32_bf16 v[102:105], v[138:141], v[118:121], v[102:105]
    ds_read_b64_tr_b16 v[170:171], v34 offset:49152
    buffer_load_dword v199, v44, s[16:19], s45 offen offset:2304 sc1
    v_mfma_f32_16x16x32_bf16 v[106:109], v[138:141], v[122:125], v[106:109]
    ds_read_b64_tr_b16 v[172:173], v34 offset:50176
    s_waitcnt lgkmcnt(14)
    v_mfma_f32_16x16x32_bf16 v[46:49], v[142:145], v[110:113], v[46:49]
    ds_read_b128 v[118:121], v24 offset:49152
    ds_read_b128 v[122:125], v24 offset:51200
    v_mfma_f32_16x16x32_bf16 v[50:53], v[142:145], v[114:117], v[50:53]
    ds_read_b64_tr_b16 v[126:127], v35 offset:49152
    s_waitcnt lgkmcnt(15)
    v_mfma_f32_16x16x32_bf16 v[54:57], v[146:149], v[110:113], v[54:57]
    ds_read_b64_tr_b16 v[128:129], v35 offset:50176
    ds_read_b64_tr_b16 v[130:131], v36 offset:49152
    v_mfma_f32_16x16x32_bf16 v[58:61], v[146:149], v[114:117], v[58:61]
    ds_read_b64_tr_b16 v[132:133], v36 offset:50176
    s_waitcnt lgkmcnt(15)
    v_mfma_f32_16x16x32_bf16 v[62:65], v[150:153], v[110:113], v[62:65]
    ds_read_b64_tr_b16 v[134:135], v37 offset:49152
    v_mfma_f32_16x16x32_bf16 v[66:69], v[150:153], v[114:117], v[66:69]
    ds_read_b64_tr_b16 v[136:137], v37 offset:50176
    ds_read_b64_tr_b16 v[138:139], v38 offset:49152
    s_waitcnt lgkmcnt(15)
    v_mfma_f32_16x16x32_bf16 v[70:73], v[154:157], v[110:113], v[70:73]
    ds_read_b64_tr_b16 v[140:141], v38 offset:50176
    v_mfma_f32_16x16x32_bf16 v[74:77], v[154:157], v[114:117], v[74:77]
    s_movk_i32 s100, 0
    buffer_load_dword v250, v251, s[88:91], s100 offen
    v_mfma_f32_16x16x32_bf16 v[78:81], v[158:161], v[110:113], v[78:81]
    ds_read_b64_tr_b16 v[142:143], v39 offset:49152
    v_mfma_f32_16x16x32_bf16 v[82:85], v[158:161], v[114:117], v[82:85]
    ds_read_b64_tr_b16 v[144:145], v39 offset:50176
    s_waitcnt lgkmcnt(15)
    v_mfma_f32_16x16x32_bf16 v[86:89], v[162:165], v[110:113], v[86:89]
    ds_read_b64_tr_b16 v[146:147], v40 offset:49152
    v_mfma_f32_16x16x32_bf16 v[90:93], v[162:165], v[114:117], v[90:93]
    ds_read_b64_tr_b16 v[148:149], v40 offset:50176
    s_waitcnt lgkmcnt(15)
    v_mfma_f32_16x16x32_bf16 v[94:97], v[166:169], v[110:113], v[94:97]
    ds_read_b64_tr_b16 v[150:151], v41 offset:49152
    v_mfma_f32_16x16x32_bf16 v[98:101], v[166:169], v[114:117], v[98:101]
    ds_read_b64_tr_b16 v[152:153], v41 offset:50176
    s_waitcnt lgkmcnt(15)
    v_mfma_f32_16x16x32_bf16 v[102:105], v[170:173], v[110:113], v[102:105]
    ds_read_b64_tr_b16 v[154:155], v42 offset:49152
    v_mfma_f32_16x16x32_bf16 v[106:109], v[170:173], v[114:117], v[106:109]
    ds_read_b64_tr_b16 v[156:157], v42 offset:50176
    s_waitcnt lgkmcnt(0)
    s_waitcnt vmcnt(22)
    s_barrier
    v_mfma_f32_16x16x32_bf16 v[46:49], v[126:129], v[118:121], v[46:49]
    ds_read_b128 v[110:113], v23 offset:0
    ds_read_b128 v[114:117], v23 offset:2048
    v_mfma_f32_16x16x32_bf16 v[50:53], v[126:129], v[122:125], v[50:53]
    ds_read_b64_tr_b16 v[158:159], v27 offset:0
    v_mfma_f32_16x16x32_bf16 v[54:57], v[130:133], v[118:121], v[54:57]
    ds_read_b64_tr_b16 v[160:161], v27 offset:1024
    ds_read_b64_tr_b16 v[162:163], v28 offset:0
    v_mfma_f32_16x16x32_bf16 v[58:61], v[130:133], v[122:125], v[58:61]
    ds_read_b64_tr_b16 v[164:165], v28 offset:1024
    v_mfma_f32_16x16x32_bf16 v[62:65], v[134:137], v[118:121], v[62:65]
    ds_read_b64_tr_b16 v[166:167], v29 offset:0
    v_mfma_f32_16x16x32_bf16 v[66:69], v[134:137], v[122:125], v[66:69]
    ds_read_b64_tr_b16 v[168:169], v29 offset:1024
    ds_read_b64_tr_b16 v[170:171], v30 offset:0
    v_mfma_f32_16x16x32_bf16 v[70:73], v[138:141], v[118:121], v[70:73]
    ds_read_b64_tr_b16 v[172:173], v30 offset:1024
    v_mfma_f32_16x16x32_bf16 v[74:77], v[138:141], v[122:125], v[74:77]
    s_movk_i32 s100, 13824
    buffer_load_dword v250, v251, s[88:91], s100 offen
    v_mfma_f32_16x16x32_bf16 v[78:81], v[142:145], v[118:121], v[78:81]
    ds_read_b64_tr_b16 v[126:127], v31 offset:0
    v_mfma_f32_16x16x32_bf16 v[82:85], v[142:145], v[122:125], v[82:85]
    ds_read_b64_tr_b16 v[128:129], v31 offset:1024
    v_mfma_f32_16x16x32_bf16 v[86:89], v[146:149], v[118:121], v[86:89]
    ds_read_b64_tr_b16 v[130:131], v32 offset:0
    v_mfma_f32_16x16x32_bf16 v[90:93], v[146:149], v[122:125], v[90:93]
    ds_read_b64_tr_b16 v[132:133], v32 offset:1024
    v_mfma_f32_16x16x32_bf16 v[94:97], v[150:153], v[118:121], v[94:97]
    ds_read_b64_tr_b16 v[134:135], v33 offset:0
    v_mfma_f32_16x16x32_bf16 v[98:101], v[150:153], v[122:125], v[98:101]
    ds_read_b64_tr_b16 v[136:137], v33 offset:1024
    v_mfma_f32_16x16x32_bf16 v[102:105], v[154:157], v[118:121], v[102:105]
    ds_read_b64_tr_b16 v[138:139], v34 offset:0
    v_mfma_f32_16x16x32_bf16 v[106:109], v[154:157], v[122:125], v[106:109]
    ds_read_b64_tr_b16 v[140:141], v34 offset:1024
    s_waitcnt lgkmcnt(14)
    v_mfma_f32_16x16x32_bf16 v[46:49], v[158:161], v[110:113], v[46:49]
    ds_read_b128 v[118:121], v24 offset:0
    ds_read_b128 v[122:125], v24 offset:2048
    v_mfma_f32_16x16x32_bf16 v[50:53], v[158:161], v[114:117], v[50:53]
    ds_read_b64_tr_b16 v[142:143], v35 offset:0
    s_waitcnt lgkmcnt(15)
    v_mfma_f32_16x16x32_bf16 v[54:57], v[162:165], v[110:113], v[54:57]
    ds_read_b64_tr_b16 v[144:145], v35 offset:1024
    v_mfma_f32_16x16x32_bf16 v[58:61], v[162:165], v[114:117], v[58:61]
    ds_read_b64_tr_b16 v[146:147], v36 offset:0
    s_waitcnt lgkmcnt(15)
    v_mfma_f32_16x16x32_bf16 v[62:65], v[166:169], v[110:113], v[62:65]
    ds_read_b64_tr_b16 v[148:149], v36 offset:1024
    ds_read_b64_tr_b16 v[150:151], v37 offset:0
    v_mfma_f32_16x16x32_bf16 v[66:69], v[166:169], v[114:117], v[66:69]
    ds_read_b64_tr_b16 v[152:153], v37 offset:1024
    s_waitcnt lgkmcnt(15)
    v_mfma_f32_16x16x32_bf16 v[70:73], v[170:173], v[110:113], v[70:73]
    ds_read_b64_tr_b16 v[154:155], v38 offset:0
    v_mfma_f32_16x16x32_bf16 v[74:77], v[170:173], v[114:117], v[74:77]
    ds_read_b64_tr_b16 v[156:157], v38 offset:1024
    s_waitcnt lgkmcnt(15)
    v_mfma_f32_16x16x32_bf16 v[78:81], v[126:129], v[110:113], v[78:81]
    ds_read_b64_tr_b16 v[158:159], v39 offset:0
    ds_read_b64_tr_b16 v[160:161], v39 offset:1024
    v_mfma_f32_16x16x32_bf16 v[82:85], v[126:129], v[114:117], v[82:85]
    s_waitcnt vmcnt(13)
    v_add_f32 v204, v204, v206
    ds_read_b64_tr_b16 v[162:163], v40 offset:0
    s_waitcnt lgkmcnt(15)
    v_mfma_f32_16x16x32_bf16 v[86:89], v[130:133], v[110:113], v[86:89]
    v_add_f32 v205, v205, v207
    v_mfma_f32_16x16x32_bf16 v[90:93], v[130:133], v[114:117], v[90:93]
    ds_read_b64_tr_b16 v[164:165], v40 offset:1024
    s_waitcnt vmcnt(12)
    v_add_f32 v186, v204, v208
    v_mfma_f32_16x16x32_bf16 v[94:97], v[134:137], v[110:113], v[94:97]
    ds_read_b64_tr_b16 v[166:167], v41 offset:0
    ds_read_b64_tr_b16 v[168:169], v41 offset:1024
    v_mfma_f32_16x16x32_bf16 v[98:101], v[134:137], v[114:117], v[98:101]
    v_add_f32 v187, v205, v209
    s_waitcnt lgkmcnt(15)
    v_mfma_f32_16x16x32_bf16 v[102:105], v[138:141], v[110:113], v[102:105]
    ds_read_b64_tr_b16 v[170:171], v42 offset:0
    ds_write_b64 v203, v[186:187]
    v_mfma_f32_16x16x32_bf16 v[106:109], v[138:141], v[114:117], v[106:109]
    ds_read_b64_tr_b16 v[172:173], v42 offset:1024
    s_waitcnt lgkmcnt(0)
    s_barrier
    v_mfma_f32_16x16x32_bf16 v[46:49], v[142:145], v[118:121], v[46:49]
    ds_read_b128 v[110:113], v23 offset:16384
    ds_read_b128 v[114:117], v23 offset:18432
    ds_read_b64 v[204:205], v242 offset:0
    v_mfma_f32_16x16x32_bf16 v[50:53], v[142:145], v[122:125], v[50:53]
    ds_read_b64 v[206:207], v242 offset:1024
    ds_read_b64_tr_b16 v[126:127], v27 offset:16384
    ds_read_b64 v[208:209], v242 offset:2048
    v_mfma_f32_16x16x32_bf16 v[54:57], v[146:149], v[118:121], v[54:57]
    ds_read_b64_tr_b16 v[128:129], v27 offset:17408
    ds_read_b64 v[210:211], v242 offset:3072
    ds_read_b64_tr_b16 v[130:131], v28 offset:16384
    v_mfma_f32_16x16x32_bf16 v[58:61], v[146:149], v[122:125], v[58:61]
    s_waitcnt vmcnt(6)
    v_add_f32 v190, v190, v195
    s_waitcnt vmcnt(5)
    v_add_f32 v191, v191, v196
    v_mfma_f32_16x16x32_bf16 v[62:65], v[150:153], v[118:121], v[62:65]
    ds_read_b64_tr_b16 v[132:133], v28 offset:17408
    s_waitcnt vmcnt(4)
    v_add_f32 v192, v192, v197
    ds_read_b64_tr_b16 v[134:135], v29 offset:16384
    v_mfma_f32_16x16x32_bf16 v[66:69], v[150:153], v[122:125], v[66:69]
    s_waitcnt vmcnt(3)
    v_add_f32 v193, v193, v198
    ds_read_b64_tr_b16 v[136:137], v29 offset:17408
    s_waitcnt vmcnt(2)
    v_add_f32 v194, v194, v199
    v_mfma_f32_16x16x32_bf16 v[70:73], v[154:157], v[118:121], v[70:73]
    v_add_f32 v190, v190, v192
    ds_read_b64_tr_b16 v[138:139], v30 offset:16384
    v_add_f32 v191, v191, v193
    v_mfma_f32_16x16x32_bf16 v[74:77], v[154:157], v[122:125], v[74:77]
    ds_read_b64_tr_b16 v[140:141], v30 offset:17408
    v_add_f32 v190, v190, v191
    v_mfma_f32_16x16x32_bf16 v[78:81], v[158:161], v[118:121], v[78:81]
    ds_read_b64_tr_b16 v[142:143], v31 offset:16384
    ds_read_b64_tr_b16 v[144:145], v31 offset:17408
    v_add_f32 v178, v190, v194
    v_mfma_f32_16x16x32_bf16 v[82:85], v[158:161], v[122:125], v[82:85]
    v_mov_b32 v182, v178
    ds_read_b64_tr_b16 v[146:147], v32 offset:16384
    v_mfma_f32_16x16x32_bf16 v[86:89], v[162:165], v[118:121], v[86:89]
    s_waitcnt lgkmcnt(11)
    v_add_f32 v204, v204, v208
    v_permlane32_swap_b32 v178, v182
    ds_read_b64_tr_b16 v[148:149], v32 offset:17408
    v_mfma_f32_16x16x32_bf16 v[90:93], v[162:165], v[122:125], v[90:93]
    v_add_f32 v205, v205, v209
    v_mul_f32 v178, 0xbacccccd, v178
    v_mfma_f32_16x16x32_bf16 v[94:97], v[166:169], v[118:121], v[94:97]
    ds_read_b64_tr_b16 v[150:151], v33 offset:16384
    s_waitcnt lgkmcnt(11)
    v_add_f32 v206, v206, v210
    ds_read_b64_tr_b16 v[152:153], v33 offset:17408
    v_mfma_f32_16x16x32_bf16 v[98:101], v[166:169], v[122:125], v[98:101]
    v_mul_f32 v182, 0x3acccccd, v182
    v_add_f32 v207, v207, v211
    v_mfma_f32_16x16x32_bf16 v[102:105], v[170:173], v[118:121], v[102:105]
    ds_read_b64_tr_b16 v[154:155], v34 offset:16384
    v_cvt_pk_bf16_f32 v236, v178, v178
    v_add_f32 v204, v204, v206
    v_mfma_f32_16x16x32_bf16 v[106:109], v[170:173], v[122:125], v[106:109]
    ds_read_b64_tr_b16 v[156:157], v34 offset:17408
    v_fma_f32 v182, -v178, v178, v182
    v_mfma_f32_16x16x32_bf16 v[46:49], v[126:129], v[110:113], v[46:49]
    ds_read_b128 v[118:121], v24 offset:16384
    ds_read_b128 v[122:125], v24 offset:18432
    v_add_f32 v205, v205, v207
    v_mfma_f32_16x16x32_bf16 v[50:53], v[126:129], v[114:117], v[50:53]
    v_and_b32 v179, 0xffff0000, v236
    ds_read_b64_tr_b16 v[158:159], v35 offset:16384
    v_cvt_pk_bf16_f32 v208, v204, v204
    s_waitcnt lgkmcnt(15)
    v_mfma_f32_16x16x32_bf16 v[54:57], v[130:133], v[110:113], v[54:57]
    ds_read_b64_tr_b16 v[160:161], v35 offset:17408
    v_max_f32 v182, 0, v182
    ds_read_b64_tr_b16 v[162:163], v36 offset:16384
    v_mfma_f32_16x16x32_bf16 v[58:61], v[130:133], v[114:117], v[58:61]
    v_sub_f32 v178, v178, v179
    v_cvt_pk_bf16_f32 v209, v205, v205
    ds_read_b64_tr_b16 v[164:165], v36 offset:17408
    s_waitcnt lgkmcnt(15)
    v_mfma_f32_16x16x32_bf16 v[62:65], v[134:137], v[110:113], v[62:65]
    v_add_f32 v182, 0x3727c5ac, v182
    ds_read_b64_tr_b16 v[166:167], v37 offset:16384
    v_and_b32 v208, 0xffff0000, v208
    v_mfma_f32_16x16x32_bf16 v[66:69], v[134:137], v[114:117], v[66:69]
    ds_read_b64_tr_b16 v[168:169], v37 offset:17408
    v_cvt_pk_bf16_f32 v237, v178, v178
    v_and_b32 v209, 0xffff0000, v209
    s_waitcnt lgkmcnt(15)
    v_mfma_f32_16x16x32_bf16 v[70:73], v[138:141], v[110:113], v[70:73]
    ds_read_b64_tr_b16 v[170:171], v38 offset:16384
    v_rsq_f32 v240, v182
    ds_read_b64_tr_b16 v[172:173], v38 offset:17408
    v_mfma_f32_16x16x32_bf16 v[74:77], v[138:141], v[114:117], v[74:77]
    v_sub_f32 v204, v204, v208
    buffer_load_dword v5, off, s[24:27], 0 sc1
    s_waitcnt lgkmcnt(15)
    v_mfma_f32_16x16x32_bf16 v[78:81], v[142:145], v[110:113], v[78:81]
    ds_read_b64_tr_b16 v[126:127], v39 offset:16384
    ds_read_b64_tr_b16 v[128:129], v39 offset:17408
    v_mov_b32 v238, v236
    v_mfma_f32_16x16x32_bf16 v[82:85], v[142:145], v[114:117], v[82:85]
    v_sub_f32 v205, v205, v209
    ds_read_b64_tr_b16 v[130:131], v40 offset:16384
    s_waitcnt lgkmcnt(15)
    v_mfma_f32_16x16x32_bf16 v[86:89], v[146:149], v[110:113], v[86:89]
    v_mov_b32 v239, v237
    v_cvt_pk_bf16_f32 v204, v208, v204
    ds_read_b64_tr_b16 v[132:133], v40 offset:17408
    v_mfma_f32_16x16x32_bf16 v[90:93], v[146:149], v[114:117], v[90:93]
    v_permlane16_swap_b32 v236, v238
    ds_read_b64_tr_b16 v[134:135], v41 offset:16384
    v_mfma_f32_16x16x32_bf16 v[94:97], v[150:153], v[110:113], v[94:97]
    v_cvt_pk_bf16_f32 v205, v209, v205
    v_permlane16_swap_b32 v237, v239
    v_mfma_f32_16x16x32_bf16 v[98:101], v[150:153], v[114:117], v[98:101]
    ds_read_b64_tr_b16 v[136:137], v41 offset:17408
    v_mul_f32 v240, s46, v240
    ds_read_b64_tr_b16 v[138:139], v42 offset:16384
    s_waitcnt lgkmcnt(15)
    v_mfma_f32_16x16x32_bf16 v[102:105], v[154:157], v[110:113], v[102:105]
    v_mov_b32 v241, v240
    s_nop 1
    v_permlane16_swap_b32 v240, v241
    v_mfma_f32_16x16x32_bf16 v[106:109], v[154:157], v[114:117], v[106:109]
    ds_read_b64_tr_b16 v[140:141], v42 offset:17408
    s_mov_b32 vcc_lo, 0xffff
    s_mov_b32 vcc_hi, 0x0
    v_cndmask_b32 v220, 0, v204, vcc
    v_cndmask_b32 v221, 0, v204, vcc
    v_cndmask_b32 v228, 0, v205, vcc
    v_cndmask_b32 v229, 0, v205, vcc
    s_waitcnt lgkmcnt(14)
    v_mfma_f32_16x16x32_bf16 v[46:49], v[158:161], v[118:121], v[46:49]
    s_mov_b32 vcc_lo, 0xffff0000
    s_mov_b32 vcc_hi, 0x0
    v_cndmask_b32 v222, 0, v204, vcc
    v_cndmask_b32 v223, 0, v204, vcc
    v_cndmask_b32 v230, 0, v205, vcc
    v_cndmask_b32 v231, 0, v205, vcc
    v_mfma_f32_16x16x32_bf16 v[50:53], v[158:161], v[122:125], v[50:53]
    s_waitcnt lgkmcnt(12)
    v_mfma_f32_16x16x32_bf16 v[54:57], v[162:165], v[118:121], v[54:57]
    v_mfma_f32_16x16x32_bf16 v[58:61], v[162:165], v[122:125], v[58:61]
    s_waitcnt lgkmcnt(10)
    v_mfma_f32_16x16x32_bf16 v[62:65], v[166:169], v[118:121], v[62:65]
    s_mov_b32 vcc_lo, 0x0
    s_mov_b32 vcc_hi, 0xffff
    v_cndmask_b32 v224, 0, v204, vcc
    v_cndmask_b32 v225, 0, v204, vcc
    v_cndmask_b32 v232, 0, v205, vcc
    v_cndmask_b32 v233, 0, v205, vcc
    v_mfma_f32_16x16x32_bf16 v[66:69], v[166:169], v[122:125], v[66:69]
    s_waitcnt lgkmcnt(8)
    v_mfma_f32_16x16x32_bf16 v[70:73], v[170:173], v[118:121], v[70:73]
    v_mfma_f32_16x16x32_bf16 v[74:77], v[170:173], v[122:125], v[74:77]
    v_mfma_f32_16x16x16_bf16 v[46:49], v[220:221], v[236:237], v[46:49]
    s_mov_b32 vcc_lo, 0x0
    s_mov_b32 vcc_hi, 0xffff0000
    v_cndmask_b32 v226, 0, v204, vcc
    v_cndmask_b32 v227, 0, v204, vcc
    v_cndmask_b32 v234, 0, v205, vcc
    v_cndmask_b32 v235, 0, v205, vcc
    v_mfma_f32_16x16x16_bf16 v[50:53], v[220:221], v[238:239], v[50:53]
    v_mfma_f32_16x16x16_bf16 v[78:81], v[228:229], v[236:237], v[78:81]
    v_mfma_f32_16x16x16_bf16 v[82:85], v[228:229], v[238:239], v[82:85]
    s_waitcnt lgkmcnt(6)
    v_mfma_f32_16x16x32_bf16 v[78:81], v[126:129], v[118:121], v[78:81]
    v_mfma_f32_16x16x32_bf16 v[82:85], v[126:129], v[122:125], v[82:85]
    s_waitcnt lgkmcnt(4)
    v_mfma_f32_16x16x32_bf16 v[86:89], v[130:133], v[118:121], v[86:89]
    v_mfma_f32_16x16x32_bf16 v[90:93], v[130:133], v[122:125], v[90:93]
    s_waitcnt lgkmcnt(2)
    v_mfma_f32_16x16x32_bf16 v[94:97], v[134:137], v[118:121], v[94:97]
    v_mfma_f32_16x16x32_bf16 v[98:101], v[134:137], v[122:125], v[98:101]
    s_waitcnt lgkmcnt(0)
    v_mfma_f32_16x16x32_bf16 v[102:105], v[138:141], v[118:121], v[102:105]
    v_mfma_f32_16x16x32_bf16 v[106:109], v[138:141], v[122:125], v[106:109]
    v_mfma_f32_16x16x16_bf16 v[54:57], v[222:223], v[236:237], v[54:57]
    v_mfma_f32_16x16x16_bf16 v[58:61], v[222:223], v[238:239], v[58:61]
    v_mfma_f32_16x16x16_bf16 v[86:89], v[230:231], v[236:237], v[86:89]
    v_mfma_f32_16x16x16_bf16 v[90:93], v[230:231], v[238:239], v[90:93]
    v_mfma_f32_16x16x16_bf16 v[62:65], v[224:225], v[236:237], v[62:65]
    v_mfma_f32_16x16x16_bf16 v[66:69], v[224:225], v[238:239], v[66:69]
    v_mfma_f32_16x16x16_bf16 v[94:97], v[232:233], v[236:237], v[94:97]
    v_mfma_f32_16x16x16_bf16 v[98:101], v[232:233], v[238:239], v[98:101]
    v_mfma_f32_16x16x16_bf16 v[70:73], v[226:227], v[236:237], v[70:73]
    v_mfma_f32_16x16x16_bf16 v[74:77], v[226:227], v[238:239], v[74:77]
    v_mfma_f32_16x16x16_bf16 v[102:105], v[234:235], v[236:237], v[102:105]
    v_mfma_f32_16x16x16_bf16 v[106:109], v[234:235], v[238:239], v[106:109]
    s_cmp_ge_u32 s29, 5
    s_cselect_b32 s46, 1.0, 0x3ea52b5c
    s_cselect_b32 s34, 5, 0
    s_cselect_b32 s35, 64, 0
    s_sub_u32 s29, s29, s34
    s_add_u32 s42, s42, s35
    s_lshl_b32 s43, s42, 8
    s_add_u32 s43, s43, 212992
    s_lshl_b32 s42, s42, 10
    s_cmp_eq_u32 s29, 1
    s_cbranch_scc1 A_qk1
    s_cmp_eq_u32 s29, 2
    s_cbranch_scc1 A_qk2
    s_cmp_eq_u32 s29, 3
    s_cbranch_scc1 A_qk3
    s_cmp_eq_u32 s29, 4
    s_cbranch_scc1 A_qk4
    v_pk_mul_f32 v[46:47], v[46:47], v[240:241] op_sel_hi:[1,0]
    v_pk_mul_f32 v[48:49], v[48:49], v[240:241] op_sel_hi:[1,0]
    v_cvt_pk_bf16_f32 v126, v46, v47
    v_cvt_pk_bf16_f32 v127, v48, v49
    v_pk_mul_f32 v[50:51], v[50:51], v[240:241] op_sel:[0,1] op_sel_hi:[1,1]
    v_pk_mul_f32 v[52:53], v[52:53], v[240:241] op_sel:[0,1] op_sel_hi:[1,1]
    v_cvt_pk_bf16_f32 v128, v50, v51
    v_cvt_pk_bf16_f32 v129, v52, v53
    v_pk_mul_f32 v[54:55], v[54:55], v[240:241] op_sel_hi:[1,0]
    v_permlane16_swap_b32 v126, v128
    v_permlane16_swap_b32 v127, v129
    v_cvt_pk_bf16_f32 v130, v54, v55
    s_add_u32 s34, s42, 0
    buffer_store_dwordx4 v[126:129], v2, s[12:15], s34 offen sc1
    v_pk_mul_f32 v[56:57], v[56:57], v[240:241] op_sel_hi:[1,0]
    v_pk_mul_f32 v[58:59], v[58:59], v[240:241] op_sel:[0,1] op_sel_hi:[1,1]
    v_cvt_pk_bf16_f32 v131, v56, v57
    v_cvt_pk_bf16_f32 v132, v58, v59
    v_pk_mul_f32 v[60:61], v[60:61], v[240:241] op_sel:[0,1] op_sel_hi:[1,1]
    v_pk_mul_f32 v[62:63], v[62:63], v[240:241] op_sel_hi:[1,0]
    v_permlane16_swap_b32 v130, v132
    v_cvt_pk_bf16_f32 v133, v60, v61
    v_cvt_pk_bf16_f32 v134, v62, v63
    v_pk_mul_f32 v[64:65], v[64:65], v[240:241] op_sel_hi:[1,0]
    v_permlane16_swap_b32 v131, v133
    v_cvt_pk_bf16_f32 v135, v64, v65
    s_add_u32 s34, s43, 0
    buffer_store_dwordx2 v[130:131], v244, s[12:15], s34 offen sc1
    v_pk_mul_f32 v[66:67], v[66:67], v[240:241] op_sel:[0,1] op_sel_hi:[1,1]
    v_pk_mul_f32 v[68:69], v[68:69], v[240:241] op_sel:[0,1] op_sel_hi:[1,1]
    v_cvt_pk_bf16_f32 v136, v66, v67
    v_cvt_pk_bf16_f32 v137, v68, v69
    v_pk_mul_f32 v[70:71], v[70:71], v[240:241] op_sel_hi:[1,0]
    v_permlane16_swap_b32 v134, v136
    v_permlane16_swap_b32 v135, v137
    v_cvt_pk_bf16_f32 v138, v70, v71
    s_add_u32 s34, s42, 245760
    buffer_store_dwordx4 v[132:135], v2, s[12:15], s34 offen sc1
    v_pk_mul_f32 v[72:73], v[72:73], v[240:241] op_sel_hi:[1,0]
    v_pk_mul_f32 v[74:75], v[74:75], v[240:241] op_sel:[0,1] op_sel_hi:[1,1]
    v_cvt_pk_bf16_f32 v139, v72, v73
    v_cvt_pk_bf16_f32 v140, v74, v75
    v_pk_mul_f32 v[76:77], v[76:77], v[240:241] op_sel:[0,1] op_sel_hi:[1,1]
    v_pk_mul_f32 v[78:79], v[78:79], v[240:241] op_sel_hi:[1,0]
    v_permlane16_swap_b32 v138, v140
    v_cvt_pk_bf16_f32 v141, v76, v77
    v_cvt_pk_bf16_f32 v142, v78, v79
    v_pk_mul_f32 v[80:81], v[80:81], v[240:241] op_sel_hi:[1,0]
    v_permlane16_swap_b32 v139, v141
    v_cvt_pk_bf16_f32 v143, v80, v81
    s_add_u32 s34, s42, 491520
    buffer_store_dwordx4 v[136:139], v2, s[12:15], s34 offen sc1
    s_add_u32 s34, s43, 491520
    buffer_store_dwordx2 v[140:141], v244, s[12:15], s34 offen sc1
    v_pk_mul_f32 v[82:83], v[82:83], v[240:241] op_sel:[0,1] op_sel_hi:[1,1]
    v_pk_mul_f32 v[84:85], v[84:85], v[240:241] op_sel:[0,1] op_sel_hi:[1,1]
    v_cvt_pk_bf16_f32 v144, v82, v83
    v_cvt_pk_bf16_f32 v145, v84, v85
    v_pk_mul_f32 v[86:87], v[86:87], v[240:241] op_sel_hi:[1,0]
    v_permlane16_swap_b32 v142, v144
    v_permlane16_swap_b32 v143, v145
    v_cvt_pk_bf16_f32 v146, v86, v87
    s_add_u32 s34, s42, 737280
    buffer_store_dwordx4 v[142:145], v2, s[12:15], s34 offen sc1
    v_pk_mul_f32 v[88:89], v[88:89], v[240:241] op_sel_hi:[1,0]
    v_pk_mul_f32 v[90:91], v[90:91], v[240:241] op_sel:[0,1] op_sel_hi:[1,1]
    v_cvt_pk_bf16_f32 v147, v88, v89
    v_cvt_pk_bf16_f32 v148, v90, v91
    v_pk_mul_f32 v[92:93], v[92:93], v[240:241] op_sel:[0,1] op_sel_hi:[1,1]
    v_pk_mul_f32 v[94:95], v[94:95], v[240:241] op_sel_hi:[1,0]
    v_permlane16_swap_b32 v146, v148
    v_cvt_pk_bf16_f32 v149, v92, v93
    v_cvt_pk_bf16_f32 v150, v94, v95
    v_pk_mul_f32 v[96:97], v[96:97], v[240:241] op_sel_hi:[1,0]
    v_permlane16_swap_b32 v147, v149
    v_cvt_pk_bf16_f32 v151, v96, v97
    s_add_u32 s34, s42, 983040
    buffer_store_dwordx4 v[146:149], v2, s[12:15], s34 offen sc1
    v_pk_mul_f32 v[98:99], v[98:99], v[240:241] op_sel:[0,1] op_sel_hi:[1,1]
    v_pk_mul_f32 v[100:101], v[100:101], v[240:241] op_sel:[0,1] op_sel_hi:[1,1]
    v_cvt_pk_bf16_f32 v152, v98, v99
    v_cvt_pk_bf16_f32 v153, v100, v101
    v_pk_mul_f32 v[102:103], v[102:103], v[240:241] op_sel_hi:[1,0]
    v_permlane16_swap_b32 v150, v152
    v_permlane16_swap_b32 v151, v153
    v_cvt_pk_bf16_f32 v154, v102, v103
    s_add_u32 s34, s43, 983040
    buffer_store_dwordx2 v[150:151], v244, s[12:15], s34 offen sc1
    v_pk_mul_f32 v[104:105], v[104:105], v[240:241] op_sel_hi:[1,0]
    v_pk_mul_f32 v[106:107], v[106:107], v[240:241] op_sel:[0,1] op_sel_hi:[1,1]
    v_cvt_pk_bf16_f32 v155, v104, v105
    v_cvt_pk_bf16_f32 v156, v106, v107
    v_pk_mul_f32 v[108:109], v[108:109], v[240:241] op_sel:[0,1] op_sel_hi:[1,1]
    s_nop 0
    v_permlane16_swap_b32 v154, v156
    v_cvt_pk_bf16_f32 v157, v108, v109
    v_mov_b32 v204, v156
    s_nop 0
    v_permlane16_swap_b32 v155, v157
    v_permlane32_swap_b32 v204, v206
    s_add_u32 s34, s42, 1228800
    buffer_store_dwordx4 v[152:155], v2, s[12:15], s34 offen sc1
    v_mov_b32 v205, v157
    s_nop 1
    v_permlane32_swap_b32 v205, v207
    s_add_u32 s34, s42, 1474560
    buffer_store_dwordx4 v[204:207], v245, s[12:15], s34 offen offset:0 sc1
    s_branch A_done
W_qk1:
    s_branch W_b1
A_qk1:
    v_pk_mul_f32 v[46:47], v[46:47], v[240:241] op_sel_hi:[1,0]
    v_pk_mul_f32 v[48:49], v[48:49], v[240:241] op_sel_hi:[1,0]
    v_cvt_pk_bf16_f32 v126, v46, v47
    v_cvt_pk_bf16_f32 v127, v48, v49
    v_pk_mul_f32 v[50:51], v[50:51], v[240:241] op_sel:[0,1] op_sel_hi:[1,1]
    v_pk_mul_f32 v[52:53], v[52:53], v[240:241] op_sel:[0,1] op_sel_hi:[1,1]
    v_cvt_pk_bf16_f32 v128, v50, v51
    v_cvt_pk_bf16_f32 v129, v52, v53
    v_pk_mul_f32 v[54:55], v[54:55], v[240:241] op_sel_hi:[1,0]
    v_permlane16_swap_b32 v126, v128
    v_permlane16_swap_b32 v127, v129
    v_mov_b32 v204, v126
    v_mov_b32 v205, v127
    v_cvt_pk_bf16_f32 v130, v54, v55
    v_permlane32_swap_b32 v204, v206
    v_permlane32_swap_b32 v205, v207
    v_pk_mul_f32 v[56:57], v[56:57], v[240:241] op_sel_hi:[1,0]
    s_add_u32 s34, s42, 1474560
    buffer_store_dwordx4 v[204:207], v245, s[12:15], s34 offen offset:512 sc1
    s_add_u32 s34, s43, 1474560
    buffer_store_dwordx2 v[128:129], v244, s[12:15], s34 offen sc1
    v_cvt_pk_bf16_f32 v131, v56, v57
    v_pk_mul_f32 v[58:59], v[58:59], v[240:241] op_sel:[0,1] op_sel_hi:[1,1]
    v_pk_mul_f32 v[60:61], v[60:61], v[240:241] op_sel:[0,1] op_sel_hi:[1,1]
    v_cvt_pk_bf16_f32 v132, v58, v59
    v_cvt_pk_bf16_f32 v133, v60, v61
    v_pk_mul_f32 v[62:63], v[62:63], v[240:241] op_sel_hi:[1,0]
    v_permlane16_swap_b32 v130, v132
    v_permlane16_swap_b32 v131, v133
    v_cvt_pk_bf16_f32 v134, v62, v63
    s_add_u32 s34, s42, 1720320
    buffer_store_dwordx4 v[130:133], v2, s[12:15], s34 offen sc1
    v_pk_mul_f32 v[64:65], v[64:65], v[240:241] op_sel_hi:[1,0]
    v_pk_mul_f32 v[66:67], v[66:67], v[240:241] op_sel:[0,1] op_sel_hi:[1,1]
    v_cvt_pk_bf16_f32 v135, v64, v65
    v_cvt_pk_bf16_f32 v136, v66, v67
    v_pk_mul_f32 v[68:69], v[68:69], v[240:241] op_sel:[0,1] op_sel_hi:[1,1]
    v_pk_mul_f32 v[70:71], v[70:71], v[240:241] op_sel_hi:[1,0]
    v_permlane16_swap_b32 v134, v136
    v_cvt_pk_bf16_f32 v137, v68, v69
    v_cvt_pk_bf16_f32 v138, v70, v71
    v_pk_mul_f32 v[72:73], v[72:73], v[240:241] op_sel_hi:[1,0]
    v_permlane16_swap_b32 v135, v137
    v_cvt_pk_bf16_f32 v139, v72, v73
    s_add_u32 s34, s42, 1966080
    buffer_store_dwordx4 v[134:137], v2, s[12:15], s34 offen sc1
    v_pk_mul_f32 v[74:75], v[74:75], v[240:241] op_sel:[0,1] op_sel_hi:[1,1]
    v_pk_mul_f32 v[76:77], v[76:77], v[240:241] op_sel:[0,1] op_sel_hi:[1,1]
    v_cvt_pk_bf16_f32 v140, v74, v75
    v_cvt_pk_bf16_f32 v141, v76, v77
    v_pk_mul_f32 v[78:79], v[78:79], v[240:241] op_sel_hi:[1,0]
    v_permlane16_swap_b32 v138, v140
    v_permlane16_swap_b32 v139, v141
    v_cvt_pk_bf16_f32 v142, v78, v79
    s_add_u32 s34, s43, 1966080
    buffer_store_dwordx2 v[138:139], v244, s[12:15], s34 offen sc1
    v_pk_mul_f32 v[80:81], v[80:81], v[240:241] op_sel_hi:[1,0]
    v_pk_mul_f32 v[82:83], v[82:83], v[240:241] op_sel:[0,1] op_sel_hi:[1,1]
    v_cvt_pk_bf16_f32 v143, v80, v81
    v_cvt_pk_bf16_f32 v144, v82, v83
    v_pk_mul_f32 v[84:85], v[84:85], v[240:241] op_sel:[0,1] op_sel_hi:[1,1]
    v_pk_mul_f32 v[86:87], v[86:87], v[240:241] op_sel_hi:[1,0]
    v_permlane16_swap_b32 v142, v144
    v_cvt_pk_bf16_f32 v145, v84, v85
    v_cvt_pk_bf16_f32 v146, v86, v87
    v_pk_mul_f32 v[88:89], v[88:89], v[240:241] op_sel_hi:[1,0]
    v_permlane16_swap_b32 v143, v145
    v_cvt_pk_bf16_f32 v147, v88, v89
    s_add_u32 s34, s42, 2211840
    buffer_store_dwordx4 v[140:143], v2, s[12:15], s34 offen sc1
    v_pk_mul_f32 v[90:91], v[90:91], v[240:241] op_sel:[0,1] op_sel_hi:[1,1]
    v_pk_mul_f32 v[92:93], v[92:93], v[240:241] op_sel:[0,1] op_sel_hi:[1,1]
    v_cvt_pk_bf16_f32 v148, v90, v91
    v_cvt_pk_bf16_f32 v149, v92, v93
    v_pk_mul_f32 v[94:95], v[94:95], v[240:241] op_sel_hi:[1,0]
    v_permlane16_swap_b32 v146, v148
    v_permlane16_swap_b32 v147, v149
    v_cvt_pk_bf16_f32 v150, v94, v95
    s_add_u32 s34, s42, 2457600
    buffer_store_dwordx4 v[144:147], v2, s[12:15], s34 offen sc1
    s_add_u32 s34, s43, 2457600
    buffer_store_dwordx2 v[148:149], v244, s[12:15], s34 offen sc1
    v_pk_mul_f32 v[96:97], v[96:97], v[240:241] op_sel_hi:[1,0]
    v_pk_mul_f32 v[98:99], v[98:99], v[240:241] op_sel:[0,1] op_sel_hi:[1,1]
    v_cvt_pk_bf16_f32 v151, v96, v97
    v_cvt_pk_bf16_f32 v152, v98, v99
    v_pk_mul_f32 v[100:101], v[100:101], v[240:241] op_sel:[0,1] op_sel_hi:[1,1]
    v_pk_mul_f32 v[102:103], v[102:103], v[240:241] op_sel_hi:[1,0]
    v_permlane16_swap_b32 v150, v152
    v_cvt_pk_bf16_f32 v153, v100, v101
    v_cvt_pk_bf16_f32 v154, v102, v103
    v_pk_mul_f32 v[104:105], v[104:105], v[240:241] op_sel_hi:[1,0]
    v_permlane16_swap_b32 v151, v153
    v_cvt_pk_bf16_f32 v155, v104, v105
    s_add_u32 s34, s42, 2703360
    buffer_store_dwordx4 v[150:153], v2, s[12:15], s34 offen sc1
    v_pk_mul_f32 v[106:107], v[106:107], v[240:241] op_sel:[0,1] op_sel_hi:[1,1]
    v_pk_mul_f32 v[108:109], v[108:109], v[240:241] op_sel:[0,1] op_sel_hi:[1,1]
    v_cvt_pk_bf16_f32 v156, v106, v107
    v_cvt_pk_bf16_f32 v157, v108, v109
    s_nop 0
    v_permlane16_swap_b32 v154, v156
    v_permlane16_swap_b32 v155, v157
    s_add_u32 s34, s42, 2949120
    buffer_store_dwordx4 v[154:157], v2, s[12:15], s34 offen sc1
    s_branch A_done
W_qk2:
    s_branch W_b1
A_qk2:
    v_pk_mul_f32 v[46:47], v[46:47], v[240:241] op_sel_hi:[1,0]
    v_pk_mul_f32 v[48:49], v[48:49], v[240:241] op_sel_hi:[1,0]
    v_cvt_pk_bf16_f32 v126, v46, v47
    v_cvt_pk_bf16_f32 v127, v48, v49
    v_pk_mul_f32 v[50:51], v[50:51], v[240:241] op_sel:[0,1] op_sel_hi:[1,1]
    v_pk_mul_f32 v[52:53], v[52:53], v[240:241] op_sel:[0,1] op_sel_hi:[1,1]
    v_cvt_pk_bf16_f32 v128, v50, v51
    v_cvt_pk_bf16_f32 v129, v52, v53
    v_pk_mul_f32 v[54:55], v[54:55], v[240:241] op_sel_hi:[1,0]
    v_permlane16_swap_b32 v126, v128
    v_permlane16_swap_b32 v127, v129
    v_cvt_pk_bf16_f32 v130, v54, v55
    s_add_u32 s34, s43, 2949120
    buffer_store_dwordx2 v[126:127], v244, s[12:15], s34 offen sc1
    v_pk_mul_f32 v[56:57], v[56:57], v[240:241] op_sel_hi:[1,0]
    v_pk_mul_f32 v[58:59], v[58:59], v[240:241] op_sel:[0,1] op_sel_hi:[1,1]
    v_cvt_pk_bf16_f32 v131, v56, v57
    v_cvt_pk_bf16_f32 v132, v58, v59
    v_pk_mul_f32 v[60:61], v[60:61], v[240:241] op_sel:[0,1] op_sel_hi:[1,1]
    v_pk_mul_f32 v[62:63], v[62:63], v[240:241] op_sel_hi:[1,0]
    v_permlane16_swap_b32 v130, v132
    v_cvt_pk_bf16_f32 v133, v60, v61
    v_cvt_pk_bf16_f32 v134, v62, v63
    v_pk_mul_f32 v[64:65], v[64:65], v[240:241] op_sel_hi:[1,0]
    v_permlane16_swap_b32 v131, v133
    v_cvt_pk_bf16_f32 v135, v64, v65
    s_add_u32 s34, s42, 3194880
    buffer_store_dwordx4 v[128:131], v2, s[12:15], s34 offen sc1
    v_pk_mul_f32 v[66:67], v[66:67], v[240:241] op_sel:[0,1] op_sel_hi:[1,1]
    v_pk_mul_f32 v[68:69], v[68:69], v[240:241] op_sel:[0,1] op_sel_hi:[1,1]
    v_cvt_pk_bf16_f32 v136, v66, v67
    v_cvt_pk_bf16_f32 v137, v68, v69
    v_pk_mul_f32 v[70:71], v[70:71], v[240:241] op_sel_hi:[1,0]
    v_permlane16_swap_b32 v134, v136
    v_permlane16_swap_b32 v135, v137
    v_cvt_pk_bf16_f32 v138, v70, v71
    s_add_u32 s34, s42, 3440640
    buffer_store_dwordx4 v[132:135], v2, s[12:15], s34 offen sc1
    s_add_u32 s34, s43, 3440640
    buffer_store_dwordx2 v[136:137], v244, s[12:15], s34 offen sc1
    v_pk_mul_f32 v[72:73], v[72:73], v[240:241] op_sel_hi:[1,0]
    v_pk_mul_f32 v[74:75], v[74:75], v[240:241] op_sel:[0,1] op_sel_hi:[1,1]
    v_cvt_pk_bf16_f32 v139, v72, v73
    v_cvt_pk_bf16_f32 v140, v74, v75
    v_pk_mul_f32 v[76:77], v[76:77], v[240:241] op_sel:[0,1] op_sel_hi:[1,1]
    v_pk_mul_f32 v[78:79], v[78:79], v[240:241] op_sel_hi:[1,0]
    v_permlane16_swap_b32 v138, v140
    v_cvt_pk_bf16_f32 v141, v76, v77
    v_cvt_pk_bf16_f32 v142, v78, v79
    v_pk_mul_f32 v[80:81], v[80:81], v[240:241] op_sel_hi:[1,0]
    v_permlane16_swap_b32 v139, v141
    v_cvt_pk_bf16_f32 v143, v80, v81
    s_add_u32 s34, s42, 3686400
    buffer_store_dwordx4 v[138:141], v2, s[12:15], s34 offen sc1
    v_pk_mul_f32 v[82:83], v[82:83], v[240:241] op_sel:[0,1] op_sel_hi:[1,1]
    v_pk_mul_f32 v[84:85], v[84:85], v[240:241] op_sel:[0,1] op_sel_hi:[1,1]
    v_cvt_pk_bf16_f32 v144, v82, v83
    v_cvt_pk_bf16_f32 v145, v84, v85
    v_pk_mul_f32 v[86:87], v[86:87], v[240:241] op_sel_hi:[1,0]
    v_permlane16_swap_b32 v142, v144
    v_permlane16_swap_b32 v143, v145
    v_cvt_pk_bf16_f32 v146, v86, v87
    s_add_u32 s34, s42, 3932160
    buffer_store_dwordx4 v[142:145], v2, s[12:15], s34 offen sc1
    v_pk_mul_f32 v[88:89], v[88:89], v[240:241] op_sel_hi:[1,0]
    v_pk_mul_f32 v[90:91], v[90:91], v[240:241] op_sel:[0,1] op_sel_hi:[1,1]
    v_cvt_pk_bf16_f32 v147, v88, v89
    v_cvt_pk_bf16_f32 v148, v90, v91
    v_pk_mul_f32 v[92:93], v[92:93], v[240:241] op_sel:[0,1] op_sel_hi:[1,1]
    v_pk_mul_f32 v[94:95], v[94:95], v[240:241] op_sel_hi:[1,0]
    v_permlane16_swap_b32 v146, v148
    v_cvt_pk_bf16_f32 v149, v92, v93
    v_cvt_pk_bf16_f32 v150, v94, v95
    v_pk_mul_f32 v[96:97], v[96:97], v[240:241] op_sel_hi:[1,0]
    v_permlane16_swap_b32 v147, v149
    v_cvt_pk_bf16_f32 v151, v96, v97
    s_add_u32 s34, s43, 3932160
    buffer_store_dwordx2 v[146:147], v244, s[12:15], s34 offen sc1
    v_pk_mul_f32 v[98:99], v[98:99], v[240:241] op_sel:[0,1] op_sel_hi:[1,1]
    v_pk_mul_f32 v[100:101], v[100:101], v[240:241] op_sel:[0,1] op_sel_hi:[1,1]
    v_cvt_pk_bf16_f32 v152, v98, v99
    v_cvt_pk_bf16_f32 v153, v100, v101
    v_pk_mul_f32 v[102:103], v[102:103], v[240:241] op_sel_hi:[1,0]
    v_permlane16_swap_b32 v150, v152
    v_permlane16_swap_b32 v151, v153
    v_cvt_pk_bf16_f32 v154, v102, v103
    s_add_u32 s34, s42, 4177920
    buffer_store_dwordx4 v[148:151], v2, s[12:15], s34 offen sc1
    v_pk_mul_f32 v[104:105], v[104:105], v[240:241] op_sel_hi:[1,0]
    v_pk_mul_f32 v[106:107], v[106:107], v[240:241] op_sel:[0,1] op_sel_hi:[1,1]
    v_cvt_pk_bf16_f32 v155, v104, v105
    v_cvt_pk_bf16_f32 v156, v106, v107
    v_pk_mul_f32 v[108:109], v[108:109], v[240:241] op_sel:[0,1] op_sel_hi:[1,1]
    s_nop 0
    v_permlane16_swap_b32 v154, v156
    v_cvt_pk_bf16_f32 v157, v108, v109
    s_nop 1
    v_permlane16_swap_b32 v155, v157
    s_add_u32 s34, s42, 4423680
    buffer_store_dwordx4 v[152:155], v2, s[12:15], s34 offen sc1
    s_add_u32 s34, s43, 4423680
    buffer_store_dwordx2 v[156:157], v244, s[12:15], s34 offen sc1
    s_branch A_done
W_qk3:
    s_branch W_b1
A_qk3:
    v_pk_mul_f32 v[46:47], v[46:47], v[240:241] op_sel_hi:[1,0]
    v_pk_mul_f32 v[48:49], v[48:49], v[240:241] op_sel_hi:[1,0]
    v_cvt_pk_bf16_f32 v126, v46, v47
    v_cvt_pk_bf16_f32 v127, v48, v49
    v_pk_mul_f32 v[50:51], v[50:51], v[240:241] op_sel:[0,1] op_sel_hi:[1,1]
    v_pk_mul_f32 v[52:53], v[52:53], v[240:241] op_sel:[0,1] op_sel_hi:[1,1]
    v_cvt_pk_bf16_f32 v128, v50, v51
    v_cvt_pk_bf16_f32 v129, v52, v53
    v_pk_mul_f32 v[54:55], v[54:55], v[240:241] op_sel_hi:[1,0]
    v_permlane16_swap_b32 v126, v128
    v_permlane16_swap_b32 v127, v129
    v_cvt_pk_bf16_f32 v130, v54, v55
    s_add_u32 s34, s42, 4669440
    buffer_store_dwordx4 v[126:129], v2, s[12:15], s34 offen sc1
    v_pk_mul_f32 v[56:57], v[56:57], v[240:241] op_sel_hi:[1,0]
    v_pk_mul_f32 v[58:59], v[58:59], v[240:241] op_sel:[0,1] op_sel_hi:[1,1]
    v_cvt_pk_bf16_f32 v131, v56, v57
    v_cvt_pk_bf16_f32 v132, v58, v59
    v_pk_mul_f32 v[60:61], v[60:61], v[240:241] op_sel:[0,1] op_sel_hi:[1,1]
    v_pk_mul_f32 v[62:63], v[62:63], v[240:241] op_sel_hi:[1,0]
    v_permlane16_swap_b32 v130, v132
    v_cvt_pk_bf16_f32 v133, v60, v61
    v_cvt_pk_bf16_f32 v134, v62, v63
    v_pk_mul_f32 v[64:65], v[64:65], v[240:241] op_sel_hi:[1,0]
    v_permlane16_swap_b32 v131, v133
    v_cvt_pk_bf16_f32 v135, v64, v65
    s_add_u32 s34, s42, 4915200
    buffer_store_dwordx4 v[130:133], v2, s[12:15], s34 offen sc1
    v_pk_mul_f32 v[66:67], v[66:67], v[240:241] op_sel:[0,1] op_sel_hi:[1,1]
    v_pk_mul_f32 v[68:69], v[68:69], v[240:241] op_sel:[0,1] op_sel_hi:[1,1]
    v_cvt_pk_bf16_f32 v136, v66, v67
    v_cvt_pk_bf16_f32 v137, v68, v69
    v_pk_mul_f32 v[70:71], v[70:71], v[240:241] op_sel_hi:[1,0]
    v_permlane16_swap_b32 v134, v136
    v_permlane16_swap_b32 v135, v137
    v_cvt_pk_bf16_f32 v138, v70, v71
    s_add_u32 s34, s43, 4915200
    buffer_store_dwordx2 v[134:135], v244, s[12:15], s34 offen sc1
    v_pk_mul_f32 v[72:73], v[72:73], v[240:241] op_sel_hi:[1,0]
    v_pk_mul_f32 v[74:75], v[74:75], v[240:241] op_sel:[0,1] op_sel_hi:[1,1]
    v_cvt_pk_bf16_f32 v139, v72, v73
    v_cvt_pk_bf16_f32 v140, v74, v75
    v_pk_mul_f32 v[76:77], v[76:77], v[240:241] op_sel:[0,1] op_sel_hi:[1,1]
    v_pk_mul_f32 v[78:79], v[78:79], v[240:241] op_sel_hi:[1,0]
    v_permlane16_swap_b32 v138, v140
    v_cvt_pk_bf16_f32 v141, v76, v77
    v_cvt_pk_bf16_f32 v142, v78, v79
    v_pk_mul_f32 v[80:81], v[80:81], v[240:241] op_sel_hi:[1,0]
    v_permlane16_swap_b32 v139, v141
    v_cvt_pk_bf16_f32 v143, v80, v81
    s_add_u32 s34, s42, 5160960
    buffer_store_dwordx4 v[136:139], v2, s[12:15], s34 offen sc1
    v_pk_mul_f32 v[82:83], v[82:83], v[240:241] op_sel:[0,1] op_sel_hi:[1,1]
    v_pk_mul_f32 v[84:85], v[84:85], v[240:241] op_sel:[0,1] op_sel_hi:[1,1]
    v_cvt_pk_bf16_f32 v144, v82, v83
    v_cvt_pk_bf16_f32 v145, v84, v85
    v_pk_mul_f32 v[86:87], v[86:87], v[240:241] op_sel_hi:[1,0]
    v_permlane16_swap_b32 v142, v144
    v_permlane16_swap_b32 v143, v145
    v_cvt_pk_bf16_f32 v146, v86, v87
    s_add_u32 s34, s42, 5406720
    buffer_store_dwordx4 v[140:143], v2, s[12:15], s34 offen sc1
    s_add_u32 s34, s43, 5406720
    buffer_store_dwordx2 v[144:145], v244, s[12:15], s34 offen sc1
    v_pk_mul_f32 v[88:89], v[88:89], v[240:241] op_sel_hi:[1,0]
    v_pk_mul_f32 v[90:91], v[90:91], v[240:241] op_sel:[0,1] op_sel_hi:[1,1]
    v_cvt_pk_bf16_f32 v147, v88, v89
    v_cvt_pk_bf16_f32 v148, v90, v91
    v_pk_mul_f32 v[92:93], v[92:93], v[240:241] op_sel:[0,1] op_sel_hi:[1,1]
    v_pk_mul_f32 v[94:95], v[94:95], v[240:241] op_sel_hi:[1,0]
    v_permlane16_swap_b32 v146, v148
    v_cvt_pk_bf16_f32 v149, v92, v93
    v_cvt_pk_bf16_f32 v150, v94, v95
    v_pk_mul_f32 v[96:97], v[96:97], v[240:241] op_sel_hi:[1,0]
    v_permlane16_swap_b32 v147, v149
    v_cvt_pk_bf16_f32 v151, v96, v97
    s_add_u32 s34, s42, 5652480
    buffer_store_dwordx4 v[146:149], v2, s[12:15], s34 offen sc1
    v_pk_mul_f32 v[98:99], v[98:99], v[240:241] op_sel:[0,1] op_sel_hi:[1,1]
    v_pk_mul_f32 v[100:101], v[100:101], v[240:241] op_sel:[0,1] op_sel_hi:[1,1]
    v_cvt_pk_bf16_f32 v152, v98, v99
    v_cvt_pk_bf16_f32 v153, v100, v101
    v_pk_mul_f32 v[102:103], v[102:103], v[240:241] op_sel_hi:[1,0]
    v_permlane16_swap_b32 v150, v152
    v_permlane16_swap_b32 v151, v153
    v_cvt_pk_bf16_f32 v154, v102, v103
    s_add_u32 s34, s42, 5898240
    buffer_store_dwordx4 v[150:153], v2, s[12:15], s34 offen sc1
    v_pk_mul_f32 v[104:105], v[104:105], v[240:241] op_sel_hi:[1,0]
    v_pk_mul_f32 v[106:107], v[106:107], v[240:241] op_sel:[0,1] op_sel_hi:[1,1]
    v_cvt_pk_bf16_f32 v155, v104, v105
    v_cvt_pk_bf16_f32 v156, v106, v107
    v_pk_mul_f32 v[108:109], v[108:109], v[240:241] op_sel:[0,1] op_sel_hi:[1,1]
    s_nop 0
    v_permlane16_swap_b32 v154, v156
    v_cvt_pk_bf16_f32 v157, v108, v109
    v_mov_b32 v204, v156
    s_nop 0
    v_permlane16_swap_b32 v155, v157
    v_permlane32_swap_b32 v204, v206
    s_add_u32 s34, s43, 5898240
    buffer_store_dwordx2 v[154:155], v244, s[12:15], s34 offen sc1
    v_mov_b32 v205, v157
    s_nop 1
    v_permlane32_swap_b32 v205, v207
    s_add_u32 s34, s42, 6144000
    buffer_store_dwordx4 v[204:207], v245, s[12:15], s34 offen offset:0 sc1
    s_branch A_done
W_qk4:
    s_branch W_b1
A_qk4:
    v_pk_mul_f32 v[46:47], v[46:47], v[240:241] op_sel_hi:[1,0]
    v_pk_mul_f32 v[48:49], v[48:49], v[240:241] op_sel_hi:[1,0]
    v_cvt_pk_bf16_f32 v126, v46, v47
    v_cvt_pk_bf16_f32 v127, v48, v49
    v_pk_mul_f32 v[50:51], v[50:51], v[240:241] op_sel:[0,1] op_sel_hi:[1,1]
    v_pk_mul_f32 v[52:53], v[52:53], v[240:241] op_sel:[0,1] op_sel_hi:[1,1]
    v_cvt_pk_bf16_f32 v128, v50, v51
    v_cvt_pk_bf16_f32 v129, v52, v53
    v_pk_mul_f32 v[54:55], v[54:55], v[240:241] op_sel_hi:[1,0]
    v_permlane16_swap_b32 v126, v128
    v_permlane16_swap_b32 v127, v129
    v_mov_b32 v204, v126
    v_mov_b32 v205, v127
    v_cvt_pk_bf16_f32 v130, v54, v55
    v_permlane32_swap_b32 v204, v206
    v_permlane32_swap_b32 v205, v207
    v_pk_mul_f32 v[56:57], v[56:57], v[240:241] op_sel_hi:[1,0]
    s_add_u32 s34, s42, 6144000
    buffer_store_dwordx4 v[204:207], v245, s[12:15], s34 offen offset:512 sc1
    v_cvt_pk_bf16_f32 v131, v56, v57
    v_pk_mul_f32 v[58:59], v[58:59], v[240:241] op_sel:[0,1] op_sel_hi:[1,1]
    v_pk_mul_f32 v[60:61], v[60:61], v[240:241] op_sel:[0,1] op_sel_hi:[1,1]
    v_cvt_pk_bf16_f32 v132, v58, v59
    v_cvt_pk_bf16_f32 v133, v60, v61
    v_pk_mul_f32 v[62:63], v[62:63], v[240:241] op_sel_hi:[1,0]
    v_permlane16_swap_b32 v130, v132
    v_permlane16_swap_b32 v131, v133
    v_cvt_pk_bf16_f32 v134, v62, v63
    s_add_u32 s34, s42, 6389760
    buffer_store_dwordx4 v[128:131], v2, s[12:15], s34 offen sc1
    s_add_u32 s34, s43, 6389760
    buffer_store_dwordx2 v[132:133], v244, s[12:15], s34 offen sc1
    v_pk_mul_f32 v[64:65], v[64:65], v[240:241] op_sel_hi:[1,0]
    v_pk_mul_f32 v[66:67], v[66:67], v[240:241] op_sel:[0,1] op_sel_hi:[1,1]
    v_cvt_pk_bf16_f32 v135, v64, v65
    v_cvt_pk_bf16_f32 v136, v66, v67
    v_pk_mul_f32 v[68:69], v[68:69], v[240:241] op_sel:[0,1] op_sel_hi:[1,1]
    v_pk_mul_f32 v[70:71], v[70:71], v[240:241] op_sel_hi:[1,0]
    v_permlane16_swap_b32 v134, v136
    v_cvt_pk_bf16_f32 v137, v68, v69
    v_cvt_pk_bf16_f32 v138, v70, v71
    v_pk_mul_f32 v[72:73], v[72:73], v[240:241] op_sel_hi:[1,0]
    v_permlane16_swap_b32 v135, v137
    v_cvt_pk_bf16_f32 v139, v72, v73
    s_add_u32 s34, s42, 6635520
    buffer_store_dwordx4 v[134:137], v2, s[12:15], s34 offen sc1
    v_pk_mul_f32 v[74:75], v[74:75], v[240:241] op_sel:[0,1] op_sel_hi:[1,1]
    v_pk_mul_f32 v[76:77], v[76:77], v[240:241] op_sel:[0,1] op_sel_hi:[1,1]
    v_cvt_pk_bf16_f32 v140, v74, v75
    v_cvt_pk_bf16_f32 v141, v76, v77
    v_pk_mul_f32 v[78:79], v[78:79], v[240:241] op_sel_hi:[1,0]
    v_permlane16_swap_b32 v138, v140
    v_permlane16_swap_b32 v139, v141
    v_cvt_pk_bf16_f32 v142, v78, v79
    s_add_u32 s34, s42, 6881280
    buffer_store_dwordx4 v[138:141], v2, s[12:15], s34 offen sc1
    v_pk_mul_f32 v[80:81], v[80:81], v[240:241] op_sel_hi:[1,0]
    v_pk_mul_f32 v[82:83], v[82:83], v[240:241] op_sel:[0,1] op_sel_hi:[1,1]
    v_cvt_pk_bf16_f32 v143, v80, v81
    v_cvt_pk_bf16_f32 v144, v82, v83
    v_pk_mul_f32 v[84:85], v[84:85], v[240:241] op_sel:[0,1] op_sel_hi:[1,1]
    v_pk_mul_f32 v[86:87], v[86:87], v[240:241] op_sel_hi:[1,0]
    v_permlane16_swap_b32 v142, v144
    v_cvt_pk_bf16_f32 v145, v84, v85
    v_cvt_pk_bf16_f32 v146, v86, v87
    v_pk_mul_f32 v[88:89], v[88:89], v[240:241] op_sel_hi:[1,0]
    v_permlane16_swap_b32 v143, v145
    v_cvt_pk_bf16_f32 v147, v88, v89
    s_add_u32 s34, s43, 6881280
    buffer_store_dwordx2 v[142:143], v244, s[12:15], s34 offen sc1
    v_pk_mul_f32 v[90:91], v[90:91], v[240:241] op_sel:[0,1] op_sel_hi:[1,1]
    v_pk_mul_f32 v[92:93], v[92:93], v[240:241] op_sel:[0,1] op_sel_hi:[1,1]
    v_cvt_pk_bf16_f32 v148, v90, v91
    v_cvt_pk_bf16_f32 v149, v92, v93
    v_pk_mul_f32 v[94:95], v[94:95], v[240:241] op_sel_hi:[1,0]
    v_permlane16_swap_b32 v146, v148
    v_permlane16_swap_b32 v147, v149
    v_cvt_pk_bf16_f32 v150, v94, v95
    s_add_u32 s34, s42, 7127040
    buffer_store_dwordx4 v[144:147], v2, s[12:15], s34 offen sc1
    v_pk_mul_f32 v[96:97], v[96:97], v[240:241] op_sel_hi:[1,0]
    v_pk_mul_f32 v[98:99], v[98:99], v[240:241] op_sel:[0,1] op_sel_hi:[1,1]
    v_cvt_pk_bf16_f32 v151, v96, v97
    v_cvt_pk_bf16_f32 v152, v98, v99
    v_pk_mul_f32 v[100:101], v[100:101], v[240:241] op_sel:[0,1] op_sel_hi:[1,1]
    v_pk_mul_f32 v[102:103], v[102:103], v[240:241] op_sel_hi:[1,0]
    v_permlane16_swap_b32 v150, v152
    v_cvt_pk_bf16_f32 v153, v100, v101
    v_cvt_pk_bf16_f32 v154, v102, v103
    v_pk_mul_f32 v[104:105], v[104:105], v[240:241] op_sel_hi:[1,0]
    v_permlane16_swap_b32 v151, v153
    v_cvt_pk_bf16_f32 v155, v104, v105
    s_add_u32 s34, s42, 7372800
    buffer_store_dwordx4 v[148:151], v2, s[12:15], s34 offen sc1
    s_add_u32 s34, s43, 7372800
    buffer_store_dwordx2 v[152:153], v244, s[12:15], s34 offen sc1
    v_pk_mul_f32 v[106:107], v[106:107], v[240:241] op_sel:[0,1] op_sel_hi:[1,1]
    v_pk_mul_f32 v[108:109], v[108:109], v[240:241] op_sel:[0,1] op_sel_hi:[1,1]
    v_cvt_pk_bf16_f32 v156, v106, v107
    v_cvt_pk_bf16_f32 v157, v108, v109
    s_nop 0
    v_permlane16_swap_b32 v154, v156
    v_permlane16_swap_b32 v155, v157
    s_add_u32 s34, s42, 7618560
    buffer_store_dwordx4 v[154:157], v2, s[12:15], s34 offen sc1
    s_branch A_done
A_v:
    s_sub_u32 s34, s29, 10
    s_lshl_b32 s34, s34, 7
    v_mul_u32_u24 v12, 320, v13
    s_lshl_b32 s35, s3, 7
    s_add_u32 s35, s35, 135168
    v_lshl_add_u32 v243, v10, 2, s35
    v_lshl_add_u32 v244, v11, 4, s35
    v_add_u32 v10, s34, v10
    s_mul_i32 s42, s42, 1280
    s_add_u32 s42, s42, 131072
    v_add_u32 v11, 0, v10
    v_mul_u32_u24 v13, 3277, v11
    v_lshrrev_b32 v13, 16, v13
    v_mul_u32_u24 v245, 245440, v13
    v_lshl_add_u32 v245, v11, 4, v245
    v_add_u32 v245, v245, v12
    v_add_u32 v11, 32, v10
    v_mul_u32_u24 v13, 3277, v11
    v_lshrrev_b32 v13, 16, v13
    v_mul_u32_u24 v246, 245440, v13
    v_lshl_add_u32 v246, v11, 4, v246
    v_add_u32 v246, v246, v12
    v_add_u32 v11, 64, v10
    v_mul_u32_u24 v13, 3277, v11
    v_lshrrev_b32 v13, 16, v13
    v_mul_u32_u24 v247, 245440, v13
    v_lshl_add_u32 v247, v11, 4, v247
    v_add_u32 v247, v247, v12
    v_add_u32 v11, 96, v10
    v_mul_u32_u24 v13, 3277, v11
    v_lshrrev_b32 v13, 16, v13
    v_mul_u32_u24 v248, 245440, v13
    v_lshl_add_u32 v248, v11, 4, v248
    v_add_u32 v248, v248, v12
    s_waitcnt vmcnt(8)
    s_barrier
    ds_read_b128 v[110:113], v23 offset:0
    ds_read_b128 v[114:117], v23 offset:2048
    ds_read_b64_tr_b16 v[126:127], v27 offset:0
    ds_read_b64_tr_b16 v[128:129], v27 offset:1024
    ds_read_b64_tr_b16 v[130:131], v28 offset:0
    ds_read_b64_tr_b16 v[132:133], v28 offset:1024
    ds_read_b64_tr_b16 v[134:135], v29 offset:0
    ds_read_b64_tr_b16 v[136:137], v29 offset:1024
    ds_read_b64_tr_b16 v[138:139], v30 offset:0
    ds_read_b64_tr_b16 v[140:141], v30 offset:1024
    ds_read_b64_tr_b16 v[142:143], v31 offset:0
    ds_read_b64_tr_b16 v[144:145], v31 offset:1024
    ds_read_b64_tr_b16 v[146:147], v32 offset:0
    ds_read_b64_tr_b16 v[148:149], v32 offset:1024
    ds_read_b64_tr_b16 v[150:151], v33 offset:0
    ds_read_b64_tr_b16 v[152:153], v33 offset:1024
    ds_read_b64_tr_b16 v[154:155], v34 offset:0
    ds_read_b64_tr_b16 v[156:157], v34 offset:1024
    s_waitcnt lgkmcnt(14)
    v_mfma_f32_16x16x32_bf16 v[46:49], v[110:113], v[126:129], 0
    ds_read_b128 v[118:121], v24 offset:0
    s_add_u32 m0, s32, 32768
    v_mfma_f32_16x16x32_bf16 v[54:57], v[114:117], v[126:129], 0
    ds_read_b128 v[122:125], v24 offset:2048
    ds_read_b64_tr_b16 v[158:159], v35 offset:0
    s_waitcnt lgkmcnt(15)
    v_mfma_f32_16x16x32_bf16 v[50:53], v[110:113], v[130:133], 0
    buffer_load_dwordx4 v15, s[4:7], s30 offen offset:0 lds
    ds_read_b64_tr_b16 v[160:161], v35 offset:1024
    v_mfma_f32_16x16x32_bf16 v[58:61], v[114:117], v[130:133], 0
    ds_read_b64_tr_b16 v[162:163], v36 offset:0
    s_waitcnt lgkmcnt(15)
    v_mfma_f32_16x16x32_bf16 v[62:65], v[110:113], v[134:137], 0
    ds_read_b64_tr_b16 v[164:165], v36 offset:1024
    buffer_load_dwordx4 v16, s[4:7], s30 offen offset:1024 lds
    v_mfma_f32_16x16x32_bf16 v[70:73], v[114:117], v[134:137], 0
    ds_read_b64_tr_b16 v[166:167], v37 offset:0
    ds_read_b64_tr_b16 v[168:169], v37 offset:1024
    s_waitcnt lgkmcnt(15)
    v_mfma_f32_16x16x32_bf16 v[66:69], v[110:113], v[138:141], 0
    buffer_load_dwordx4 v17, s[4:7], s30 offen offset:2048 lds
    ds_read_b64_tr_b16 v[170:171], v38 offset:0
    v_mfma_f32_16x16x32_bf16 v[74:77], v[114:117], v[138:141], 0
    ds_read_b64_tr_b16 v[172:173], v38 offset:1024
    v_dot2_f32_bf16 v178, v110, v174, v178
    v_dot2_f32_bf16 v182, v110, v110, v182
    v_dot2_f32_bf16 v178, v111, v174, v178
    v_dot2_f32_bf16 v182, v111, v111, v182
    v_dot2_f32_bf16 v178, v112, v174, v178
    v_dot2_f32_bf16 v182, v112, v112, v182
    v_dot2_f32_bf16 v178, v113, v174, v178
    v_dot2_f32_bf16 v182, v113, v113, v182
    s_cmp_ge_u32 s3, 2
    s_cbranch_scc1 A_s01
    v_dot2_f32_bf16 v186, v126, v174, v186
    v_dot2_f32_bf16 v187, v130, v174, v187
    v_dot2_f32_bf16 v188, v134, v174, v188
    v_dot2_f32_bf16 v189, v138, v174, v189
    v_dot2_f32_bf16 v186, v127, v174, v186
    v_dot2_f32_bf16 v187, v131, v174, v187
    v_dot2_f32_bf16 v188, v135, v174, v188
    v_dot2_f32_bf16 v189, v139, v174, v189
    v_dot2_f32_bf16 v186, v128, v174, v186
    v_dot2_f32_bf16 v187, v132, v174, v187
    v_dot2_f32_bf16 v188, v136, v174, v188
    v_dot2_f32_bf16 v189, v140, v174, v189
    v_dot2_f32_bf16 v186, v129, v174, v186
    v_dot2_f32_bf16 v187, v133, v174, v187
    v_dot2_f32_bf16 v188, v137, v174, v188
    v_dot2_f32_bf16 v189, v141, v174, v189
A_s01:
    s_waitcnt lgkmcnt(15)
    v_mfma_f32_16x16x32_bf16 v[78:81], v[110:113], v[142:145], 0
    ds_read_b64_tr_b16 v[126:127], v39 offset:0
    buffer_load_dwordx4 v18, s[4:7], s30 offen offset:3072 lds
    v_mfma_f32_16x16x32_bf16 v[86:89], v[114:117], v[142:145], 0
    ds_read_b64_tr_b16 v[128:129], v39 offset:1024
    s_waitcnt lgkmcnt(15)
    v_mfma_f32_16x16x32_bf16 v[82:85], v[110:113], v[146:149], 0
    ds_read_b64_tr_b16 v[130:131], v40 offset:0
    s_add_u32 m0, s33, 32768
    v_mfma_f32_16x16x32_bf16 v[90:93], v[114:117], v[146:149], 0
    ds_read_b64_tr_b16 v[132:133], v40 offset:1024
    s_waitcnt lgkmcnt(15)
    v_mfma_f32_16x16x32_bf16 v[94:97], v[110:113], v[150:153], 0
    ds_read_b64_tr_b16 v[134:135], v41 offset:0
    buffer_load_dwordx4 v19, s[8:11], s31 offen offset:0 lds
    v_mfma_f32_16x16x32_bf16 v[102:105], v[114:117], v[150:153], 0
    ds_read_b64_tr_b16 v[136:137], v41 offset:1024
    s_waitcnt lgkmcnt(15)
    v_mfma_f32_16x16x32_bf16 v[98:101], v[110:113], v[154:157], 0
    ds_read_b64_tr_b16 v[138:139], v42 offset:0
    buffer_load_dwordx4 v20, s[8:11], s31 offen offset:1024 lds
    v_mfma_f32_16x16x32_bf16 v[106:109], v[114:117], v[154:157], 0
    ds_read_b64_tr_b16 v[140:141], v42 offset:1024
    v_dot2_f32_bf16 v179, v114, v174, v179
    v_dot2_f32_bf16 v183, v114, v114, v183
    v_dot2_f32_bf16 v179, v115, v174, v179
    v_dot2_f32_bf16 v183, v115, v115, v183
    v_dot2_f32_bf16 v179, v116, v174, v179
    v_dot2_f32_bf16 v183, v116, v116, v183
    v_dot2_f32_bf16 v179, v117, v174, v179
    v_dot2_f32_bf16 v183, v117, v117, v183
    s_cmp_ge_u32 s3, 2
    s_cbranch_scc0 A_s11
    v_dot2_f32_bf16 v186, v142, v174, v186
    v_dot2_f32_bf16 v187, v146, v174, v187
    v_dot2_f32_bf16 v188, v150, v174, v188
    v_dot2_f32_bf16 v189, v154, v174, v189
    v_dot2_f32_bf16 v186, v143, v174, v186
    v_dot2_f32_bf16 v187, v147, v174, v187
    v_dot2_f32_bf16 v188, v151, v174, v188
    v_dot2_f32_bf16 v189, v155, v174, v189
    v_dot2_f32_bf16 v186, v144, v174, v186
    v_dot2_f32_bf16 v187, v148, v174, v187
    v_dot2_f32_bf16 v188, v152, v174, v188
    v_dot2_f32_bf16 v189, v156, v174, v189
    v_dot2_f32_bf16 v186, v145, v174, v186
    v_dot2_f32_bf16 v187, v149, v174, v187
    v_dot2_f32_bf16 v188, v153, v174, v188
    v_dot2_f32_bf16 v189, v157, v174, v189
A_s11:
    s_lshl_b32 s34, s3, 10
    v_add_u32 v203, s34, v242
    v_permlane16_swap_b32 v186, v187
    v_permlane16_swap_b32 v188, v189
    v_add_f32 v186, v186, v187
    v_add_f32 v188, v188, v189
    s_nop 1
    v_permlane32_swap_b32 v186, v188
    v_add_f32 v186, v186, v188
    ds_write_b32 v203, v186
    s_waitcnt lgkmcnt(0)
    s_waitcnt vmcnt(6)
    s_barrier
    v_mfma_f32_16x16x32_bf16 v[46:49], v[118:121], v[158:161], v[46:49]
    ds_read_b32 v204, v242 offset:0
    ds_read_b32 v206, v242 offset:1024
    ds_read_b32 v205, v242 offset:2048
    v_mfma_f32_16x16x32_bf16 v[54:57], v[122:125], v[158:161], v[54:57]
    ds_read_b32 v207, v242 offset:3072
    ds_read_b128 v[110:113], v23 offset:16384
    v_mfma_f32_16x16x32_bf16 v[50:53], v[118:121], v[162:165], v[50:53]
    buffer_load_dwordx4 v21, s[8:11], s31 offen offset:2048 lds
    ds_read_b128 v[114:117], v23 offset:18432
    ds_read_b64_tr_b16 v[142:143], v27 offset:16384
    v_mfma_f32_16x16x32_bf16 v[58:61], v[122:125], v[162:165], v[58:61]
    buffer_load_dwordx4 v22, s[8:11], s31 offen offset:3072 lds
    ds_read_b64_tr_b16 v[144:145], v27 offset:17408
    v_mfma_f32_16x16x32_bf16 v[62:65], v[118:121], v[166:169], v[62:65]
    ds_read_b64_tr_b16 v[146:147], v28 offset:16384
    s_add_u32 s30, s30, 128
    s_add_u32 s31, s31, 245760
    s_cmp_eq_u32 s30, 1280
    s_cselect_b32 s30, 0, s30
    s_cselect_b32 s31, 0, s31
    v_mfma_f32_16x16x32_bf16 v[70:73], v[122:125], v[166:169], v[70:73]
    ds_read_b64_tr_b16 v[148:149], v28 offset:17408
    ds_read_b64_tr_b16 v[150:151], v29 offset:16384
    s_add_u32 m0, s32, 49152
    v_mfma_f32_16x16x32_bf16 v[66:69], v[118:121], v[170:173], v[66:69]
    ds_read_b64_tr_b16 v[152:153], v29 offset:17408
    ds_read_b64_tr_b16 v[154:155], v30 offset:16384
    v_mfma_f32_16x16x32_bf16 v[74:77], v[122:125], v[170:173], v[74:77]
    buffer_load_dwordx4 v15, s[4:7], s30 offen offset:0 lds
    ds_read_b64_tr_b16 v[156:157], v30 offset:17408
    v_dot2_f32_bf16 v178, v118, v174, v178
    v_dot2_f32_bf16 v182, v118, v118, v182
    v_dot2_f32_bf16 v178, v119, v174, v178
    v_dot2_f32_bf16 v182, v119, v119, v182
    v_dot2_f32_bf16 v178, v120, v174, v178
    v_dot2_f32_bf16 v182, v120, v120, v182
    v_dot2_f32_bf16 v178, v121, v174, v178
    v_dot2_f32_bf16 v182, v121, v121, v182
    v_mfma_f32_16x16x32_bf16 v[78:81], v[118:121], v[126:129], v[78:81]
    s_waitcnt lgkmcnt(12)
    v_add_f32 v204, v204, v206
    s_waitcnt lgkmcnt(10)
    v_add_f32 v205, v205, v207
    v_mfma_f32_16x16x32_bf16 v[86:89], v[122:125], v[126:129], v[86:89]
    buffer_store_dwordx2 v[204:205], v45, s[16:19], s44 offen sc1
    ds_read_b64_tr_b16 v[158:159], v31 offset:16384
    v_mfma_f32_16x16x32_bf16 v[82:85], v[118:121], v[130:133], v[82:85]
    buffer_load_dwordx4 v16, s[4:7], s30 offen offset:1024 lds
    ds_read_b64_tr_b16 v[160:161], v31 offset:17408
    v_mfma_f32_16x16x32_bf16 v[90:93], v[122:125], v[130:133], v[90:93]
    ds_read_b64_tr_b16 v[162:163], v32 offset:16384
    v_mfma_f32_16x16x32_bf16 v[94:97], v[118:121], v[134:137], v[94:97]
    buffer_load_dwordx4 v17, s[4:7], s30 offen offset:2048 lds
    ds_read_b64_tr_b16 v[164:165], v32 offset:17408
    v_mfma_f32_16x16x32_bf16 v[102:105], v[122:125], v[134:137], v[102:105]
    ds_read_b64_tr_b16 v[166:167], v33 offset:16384
    ds_read_b64_tr_b16 v[168:169], v33 offset:17408
    v_mfma_f32_16x16x32_bf16 v[98:101], v[118:121], v[138:141], v[98:101]
    buffer_load_dwordx4 v18, s[4:7], s30 offen offset:3072 lds
    ds_read_b64_tr_b16 v[170:171], v34 offset:16384
    v_mfma_f32_16x16x32_bf16 v[106:109], v[122:125], v[138:141], v[106:109]
    ds_read_b64_tr_b16 v[172:173], v34 offset:17408
    v_dot2_f32_bf16 v179, v122, v174, v179
    v_dot2_f32_bf16 v183, v122, v122, v183
    v_dot2_f32_bf16 v179, v123, v174, v179
    v_dot2_f32_bf16 v183, v123, v123, v183
    v_dot2_f32_bf16 v179, v124, v174, v179
    v_dot2_f32_bf16 v183, v124, v124, v183
    v_dot2_f32_bf16 v179, v125, v174, v179
    v_dot2_f32_bf16 v183, v125, v125, v183
    s_waitcnt lgkmcnt(14)
    v_mfma_f32_16x16x32_bf16 v[46:49], v[110:113], v[142:145], v[46:49]
    ds_read_b128 v[118:121], v24 offset:16384
    v_permlane16_swap_b32 v178, v179
    s_add_u32 m0, s33, 49152
    v_mfma_f32_16x16x32_bf16 v[54:57], v[114:117], v[142:145], v[54:57]
    v_permlane16_swap_b32 v182, v183
    ds_read_b128 v[122:125], v24 offset:18432
    s_waitcnt lgkmcnt(14)
    v_mfma_f32_16x16x32_bf16 v[50:53], v[110:113], v[146:149], v[50:53]
    v_add_f32 v178, v178, v179
    ds_read_b64_tr_b16 v[126:127], v35 offset:16384
    v_add_f32 v182, v182, v183
    v_mfma_f32_16x16x32_bf16 v[58:61], v[114:117], v[146:149], v[58:61]
    ds_read_b64_tr_b16 v[128:129], v35 offset:17408
    v_permlane32_swap_b32 v178, v182
    s_waitcnt lgkmcnt(14)
    v_mfma_f32_16x16x32_bf16 v[62:65], v[110:113], v[150:153], v[62:65]
    buffer_load_dwordx4 v19, s[8:11], s31 offen offset:0 lds
    v_add_f32 v178, v178, v182
    buffer_store_dword v178, v44, s[16:19], s41 offen sc1
    v_mfma_f32_16x16x32_bf16 v[70:73], v[114:117], v[150:153], v[70:73]
    ds_read_b64_tr_b16 v[130:131], v36 offset:16384
    ds_read_b64_tr_b16 v[132:133], v36 offset:17408
    s_waitcnt lgkmcnt(14)
    v_mfma_f32_16x16x32_bf16 v[66:69], v[110:113], v[154:157], v[66:69]
    ds_read_b64_tr_b16 v[134:135], v37 offset:16384
    buffer_load_dwordx4 v20, s[8:11], s31 offen offset:1024 lds
    ds_read_b64_tr_b16 v[136:137], v37 offset:17408
    v_mfma_f32_16x16x32_bf16 v[74:77], v[114:117], v[154:157], v[74:77]
    ds_read_b64_tr_b16 v[138:139], v38 offset:16384
    ds_read_b64_tr_b16 v[140:141], v38 offset:17408
    s_waitcnt lgkmcnt(15)
    v_mfma_f32_16x16x32_bf16 v[78:81], v[110:113], v[158:161], v[78:81]
    ds_read_b64_tr_b16 v[142:143], v39 offset:16384
    buffer_load_dwordx4 v21, s[8:11], s31 offen offset:2048 lds
    v_mfma_f32_16x16x32_bf16 v[86:89], v[114:117], v[158:161], v[86:89]
    ds_read_b64_tr_b16 v[144:145], v39 offset:17408
    s_waitcnt lgkmcnt(15)
    v_mfma_f32_16x16x32_bf16 v[82:85], v[110:113], v[162:165], v[82:85]
    ds_read_b64_tr_b16 v[146:147], v40 offset:16384
    buffer_load_dwordx4 v22, s[8:11], s31 offen offset:3072 lds
    v_mfma_f32_16x16x32_bf16 v[90:93], v[114:117], v[162:165], v[90:93]
    ds_read_b64_tr_b16 v[148:149], v40 offset:17408
    s_waitcnt lgkmcnt(15)
    v_mfma_f32_16x16x32_bf16 v[94:97], v[110:113], v[166:169], v[94:97]
    ds_read_b64_tr_b16 v[150:151], v41 offset:16384
    v_mfma_f32_16x16x32_bf16 v[102:105], v[114:117], v[166:169], v[102:105]
    ds_read_b64_tr_b16 v[152:153], v41 offset:17408
    s_add_u32 s30, s30, 128
    s_add_u32 s31, s31, 245760
    s_cmp_eq_u32 s30, 1280
    s_cselect_b32 s30, 0, s30
    s_cselect_b32 s31, 0, s31
    s_waitcnt lgkmcnt(15)
    v_mfma_f32_16x16x32_bf16 v[98:101], v[110:113], v[170:173], v[98:101]
    ds_read_b64_tr_b16 v[154:155], v42 offset:16384
    v_mfma_f32_16x16x32_bf16 v[106:109], v[114:117], v[170:173], v[106:109]
    ds_read_b64_tr_b16 v[156:157], v42 offset:17408
    s_waitcnt lgkmcnt(0)
    s_waitcnt vmcnt(10)
    s_barrier
    v_mfma_f32_16x16x32_bf16 v[46:49], v[118:121], v[126:129], v[46:49]
    buffer_load_dword v5, off, s[24:27], s38 offset:128 sc1
    ds_read_b128 v[110:113], v23 offset:32768
    v_mfma_f32_16x16x32_bf16 v[54:57], v[122:125], v[126:129], v[54:57]
    s_add_u32 m0, s32, 0
    ds_read_b128 v[114:117], v23 offset:34816
    v_mfma_f32_16x16x32_bf16 v[50:53], v[118:121], v[130:133], v[50:53]
    ds_read_b64_tr_b16 v[158:159], v27 offset:32768
    ds_read_b64_tr_b16 v[160:161], v27 offset:33792
    v_mfma_f32_16x16x32_bf16 v[58:61], v[122:125], v[130:133], v[58:61]
    buffer_load_dwordx4 v15, s[4:7], s30 offen offset:0 lds
    v_mfma_f32_16x16x32_bf16 v[62:65], v[118:121], v[134:137], v[62:65]
    ds_read_b64_tr_b16 v[162:163], v28 offset:32768
    ds_read_b64_tr_b16 v[164:165], v28 offset:33792
    v_mfma_f32_16x16x32_bf16 v[70:73], v[122:125], v[134:137], v[70:73]
    ds_read_b64_tr_b16 v[166:167], v29 offset:32768
    buffer_load_dwordx4 v16, s[4:7], s30 offen offset:1024 lds
    v_mfma_f32_16x16x32_bf16 v[66:69], v[118:121], v[138:141], v[66:69]
    ds_read_b64_tr_b16 v[168:169], v29 offset:33792
    ds_read_b64_tr_b16 v[170:171], v30 offset:32768
    v_mfma_f32_16x16x32_bf16 v[74:77], v[122:125], v[138:141], v[74:77]
    ds_read_b64_tr_b16 v[172:173], v30 offset:33792
    v_mfma_f32_16x16x32_bf16 v[78:81], v[118:121], v[142:145], v[78:81]
    ds_read_b64_tr_b16 v[126:127], v31 offset:32768
    buffer_load_dwordx4 v17, s[4:7], s30 offen offset:2048 lds
    v_mfma_f32_16x16x32_bf16 v[86:89], v[122:125], v[142:145], v[86:89]
    ds_read_b64_tr_b16 v[128:129], v31 offset:33792
    v_mfma_f32_16x16x32_bf16 v[82:85], v[118:121], v[146:149], v[82:85]
    ds_read_b64_tr_b16 v[130:131], v32 offset:32768
    v_mfma_f32_16x16x32_bf16 v[90:93], v[122:125], v[146:149], v[90:93]
    ds_read_b64_tr_b16 v[132:133], v32 offset:33792
    v_mfma_f32_16x16x32_bf16 v[94:97], v[118:121], v[150:153], v[94:97]
    ds_read_b64_tr_b16 v[134:135], v33 offset:32768
    buffer_load_dwordx4 v18, s[4:7], s30 offen offset:3072 lds
    v_mfma_f32_16x16x32_bf16 v[102:105], v[122:125], v[150:153], v[102:105]
    ds_read_b64_tr_b16 v[136:137], v33 offset:33792
    v_mfma_f32_16x16x32_bf16 v[98:101], v[118:121], v[154:157], v[98:101]
    ds_read_b64_tr_b16 v[138:139], v34 offset:32768
    v_mfma_f32_16x16x32_bf16 v[106:109], v[122:125], v[154:157], v[106:109]
    ds_read_b64_tr_b16 v[140:141], v34 offset:33792
    s_waitcnt lgkmcnt(14)
    v_mfma_f32_16x16x32_bf16 v[46:49], v[110:113], v[158:161], v[46:49]
    ds_read_b128 v[118:121], v24 offset:32768
    s_add_u32 m0, s33, 0
    v_mfma_f32_16x16x32_bf16 v[54:57], v[114:117], v[158:161], v[54:57]
    ds_read_b128 v[122:125], v24 offset:34816
    ds_read_b64_tr_b16 v[142:143], v35 offset:32768
    s_waitcnt lgkmcnt(15)
    v_mfma_f32_16x16x32_bf16 v[50:53], v[110:113], v[162:165], v[50:53]
    buffer_load_dwordx4 v19, s[8:11], s31 offen offset:0 lds
    ds_read_b64_tr_b16 v[144:145], v35 offset:33792
    v_mfma_f32_16x16x32_bf16 v[58:61], v[114:117], v[162:165], v[58:61]
    ds_read_b64_tr_b16 v[146:147], v36 offset:32768
    s_waitcnt lgkmcnt(15)
    v_mfma_f32_16x16x32_bf16 v[62:65], v[110:113], v[166:169], v[62:65]
    ds_read_b64_tr_b16 v[148:149], v36 offset:33792
    buffer_load_dwordx4 v20, s[8:11], s31 offen offset:1024 lds
    v_mfma_f32_16x16x32_bf16 v[70:73], v[114:117], v[166:169], v[70:73]
    ds_read_b64_tr_b16 v[150:151], v37 offset:32768
    ds_read_b64_tr_b16 v[152:153], v37 offset:33792
    s_waitcnt lgkmcnt(15)
    v_mfma_f32_16x16x32_bf16 v[66:69], v[110:113], v[170:173], v[66:69]
    buffer_load_dwordx4 v21, s[8:11], s31 offen offset:2048 lds
    ds_read_b64_tr_b16 v[154:155], v38 offset:32768
    v_mfma_f32_16x16x32_bf16 v[74:77], v[114:117], v[170:173], v[74:77]
    ds_read_b64_tr_b16 v[156:157], v38 offset:33792
    s_waitcnt lgkmcnt(15)
    v_mfma_f32_16x16x32_bf16 v[78:81], v[110:113], v[126:129], v[78:81]
    ds_read_b64_tr_b16 v[158:159], v39 offset:32768
    buffer_load_dwordx4 v22, s[8:11], s31 offen offset:3072 lds
    v_mfma_f32_16x16x32_bf16 v[86:89], v[114:117], v[126:129], v[86:89]
    ds_read_b64_tr_b16 v[160:161], v39 offset:33792
    s_add_u32 s30, s30, 128
    s_add_u32 s31, s31, 245760
    s_cmp_eq_u32 s30, 1280
    s_cselect_b32 s30, 0, s30
    s_cselect_b32 s31, 0, s31
    s_waitcnt lgkmcnt(15)
    v_mfma_f32_16x16x32_bf16 v[82:85], v[110:113], v[130:133], v[82:85]
    ds_read_b64_tr_b16 v[162:163], v40 offset:32768
    v_mfma_f32_16x16x32_bf16 v[90:93], v[114:117], v[130:133], v[90:93]
    ds_read_b64_tr_b16 v[164:165], v40 offset:33792
    s_add_u32 m0, s32, 16384
    s_waitcnt lgkmcnt(15)
    v_mfma_f32_16x16x32_bf16 v[94:97], v[110:113], v[134:137], v[94:97]
    ds_read_b64_tr_b16 v[166:167], v41 offset:32768
    buffer_load_dwordx4 v15, s[4:7], s30 offen offset:0 lds
    v_mfma_f32_16x16x32_bf16 v[102:105], v[114:117], v[134:137], v[102:105]
    ds_read_b64_tr_b16 v[168:169], v41 offset:33792
    s_waitcnt lgkmcnt(15)
    v_mfma_f32_16x16x32_bf16 v[98:101], v[110:113], v[138:141], v[98:101]
    ds_read_b64_tr_b16 v[170:171], v42 offset:32768
    buffer_load_dwordx4 v16, s[4:7], s30 offen offset:1024 lds
    v_mfma_f32_16x16x32_bf16 v[106:109], v[114:117], v[138:141], v[106:109]
    ds_read_b64_tr_b16 v[172:173], v42 offset:33792
    s_waitcnt lgkmcnt(0)
    s_waitcnt vmcnt(11)
    s_barrier
    v_mfma_f32_16x16x32_bf16 v[46:49], v[118:121], v[142:145], v[46:49]
    s_waitcnt vmcnt(10)
    v_cmp_gt_u32 vcc, s39, v5
    s_cbranch_vccz A_c1x
    s_mov_b32 s34, 0x40000
A_c1:
    buffer_load_dword v5, off, s[24:27], s38 offset:128 sc1
    s_sub_u32 s34, s34, 1
    s_waitcnt vmcnt(0)
    v_cmp_gt_u32 vcc, s39, v5
    s_cbranch_scc1 A_c1x
    s_cbranch_vccnz A_c1
A_c1x:
    s_mov_b64 exec, 1
    buffer_store_dword v4, off, s[80:83], s40 sc1
    s_mov_b64 exec, -1
    v_mfma_f32_16x16x32_bf16 v[54:57], v[122:125], v[142:145], v[54:57]
    ds_read_b128 v[110:113], v23 offset:49152
    buffer_load_dwordx4 v17, s[4:7], s30 offen offset:2048 lds
    v_mfma_f32_16x16x32_bf16 v[50:53], v[118:121], v[146:149], v[50:53]
    ds_read_b128 v[114:117], v23 offset:51200
    ds_read_b64_tr_b16 v[126:127], v27 offset:49152
    v_mfma_f32_16x16x32_bf16 v[58:61], v[122:125], v[146:149], v[58:61]
    ds_read_b64_tr_b16 v[128:129], v27 offset:50176
    v_mfma_f32_16x16x32_bf16 v[62:65], v[118:121], v[150:153], v[62:65]
    ds_read_b64_tr_b16 v[130:131], v28 offset:49152
    ds_read_b64_tr_b16 v[132:133], v28 offset:50176
    v_mfma_f32_16x16x32_bf16 v[70:73], v[122:125], v[150:153], v[70:73]
    buffer_load_dwordx4 v18, s[4:7], s30 offen offset:3072 lds
    ds_read_b64_tr_b16 v[134:135], v29 offset:49152
    v_mfma_f32_16x16x32_bf16 v[66:69], v[118:121], v[154:157], v[66:69]
    ds_read_b64_tr_b16 v[136:137], v29 offset:50176
    ds_read_b64_tr_b16 v[138:139], v30 offset:49152
    v_mfma_f32_16x16x32_bf16 v[74:77], v[122:125], v[154:157], v[74:77]
    ds_read_b64_tr_b16 v[140:141], v30 offset:50176
    v_mfma_f32_16x16x32_bf16 v[78:81], v[118:121], v[158:161], v[78:81]
    ds_read_b64_tr_b16 v[142:143], v31 offset:49152
    s_add_u32 m0, s33, 16384
    v_mfma_f32_16x16x32_bf16 v[86:89], v[122:125], v[158:161], v[86:89]
    ds_read_b64_tr_b16 v[144:145], v31 offset:50176
    v_mfma_f32_16x16x32_bf16 v[82:85], v[118:121], v[162:165], v[82:85]
    ds_read_b64_tr_b16 v[146:147], v32 offset:49152
    buffer_load_dwordx4 v19, s[8:11], s31 offen offset:0 lds
    v_mfma_f32_16x16x32_bf16 v[90:93], v[122:125], v[162:165], v[90:93]
    ds_read_b64_tr_b16 v[148:149], v32 offset:50176
    v_mfma_f32_16x16x32_bf16 v[94:97], v[118:121], v[166:169], v[94:97]
    ds_read_b64_tr_b16 v[150:151], v33 offset:49152
    v_mfma_f32_16x16x32_bf16 v[102:105], v[122:125], v[166:169], v[102:105]
    ds_read_b64_tr_b16 v[152:153], v33 offset:50176
    buffer_load_dwordx4 v20, s[8:11], s31 offen offset:1024 lds
    v_mfma_f32_16x16x32_bf16 v[98:101], v[118:121], v[170:173], v[98:101]
    ds_read_b64_tr_b16 v[154:155], v34 offset:49152
    v_mfma_f32_16x16x32_bf16 v[106:109], v[122:125], v[170:173], v[106:109]
    ds_read_b64_tr_b16 v[156:157], v34 offset:50176
    s_waitcnt lgkmcnt(14)
    v_mfma_f32_16x16x32_bf16 v[46:49], v[110:113], v[126:129], v[46:49]
    ds_read_b128 v[118:121], v24 offset:49152
    buffer_load_dwordx4 v21, s[8:11], s31 offen offset:2048 lds
    v_mfma_f32_16x16x32_bf16 v[54:57], v[114:117], v[126:129], v[54:57]
    ds_read_b128 v[122:125], v24 offset:51200
    ds_read_b64_tr_b16 v[158:159], v35 offset:49152
    s_waitcnt lgkmcnt(15)
    v_mfma_f32_16x16x32_bf16 v[50:53], v[110:113], v[130:133], v[50:53]
    buffer_load_dwordx4 v22, s[8:11], s31 offen offset:3072 lds
    ds_read_b64_tr_b16 v[160:161], v35 offset:50176
    v_mfma_f32_16x16x32_bf16 v[58:61], v[114:117], v[130:133], v[58:61]
    ds_read_b64_tr_b16 v[162:163], v36 offset:49152
    s_add_u32 s30, s30, 128
    s_add_u32 s31, s31, 245760
    s_cmp_eq_u32 s30, 1280
    s_cselect_b32 s30, 0, s30
    s_cselect_b32 s31, 0, s31
    s_waitcnt lgkmcnt(15)
    v_mfma_f32_16x16x32_bf16 v[62:65], v[110:113], v[134:137], v[62:65]
    ds_read_b64_tr_b16 v[164:165], v36 offset:50176
    ds_read_b64_tr_b16 v[166:167], v37 offset:49152
    v_mfma_f32_16x16x32_bf16 v[70:73], v[114:117], v[134:137], v[70:73]
    s_add_u32 m0, s32, 32768
    ds_read_b64_tr_b16 v[168:169], v37 offset:50176
    s_waitcnt lgkmcnt(15)
    v_mfma_f32_16x16x32_bf16 v[66:69], v[110:113], v[138:141], v[66:69]
    ds_read_b64_tr_b16 v[170:171], v38 offset:49152
    buffer_load_dwordx4 v15, s[4:7], s30 offen offset:0 lds
    v_mfma_f32_16x16x32_bf16 v[74:77], v[114:117], v[138:141], v[74:77]
    ds_read_b64_tr_b16 v[172:173], v38 offset:50176
    s_waitcnt lgkmcnt(15)
    v_mfma_f32_16x16x32_bf16 v[78:81], v[110:113], v[142:145], v[78:81]
    ds_read_b64_tr_b16 v[126:127], v39 offset:49152
    buffer_load_dwordx4 v16, s[4:7], s30 offen offset:1024 lds
    v_mfma_f32_16x16x32_bf16 v[86:89], v[114:117], v[142:145], v[86:89]
    ds_read_b64_tr_b16 v[128:129], v39 offset:50176
    s_waitcnt lgkmcnt(15)
    v_mfma_f32_16x16x32_bf16 v[82:85], v[110:113], v[146:149], v[82:85]
    ds_read_b64_tr_b16 v[130:131], v40 offset:49152
    buffer_load_dwordx4 v17, s[4:7], s30 offen offset:2048 lds
    v_mfma_f32_16x16x32_bf16 v[90:93], v[114:117], v[146:149], v[90:93]
    ds_read_b64_tr_b16 v[132:133], v40 offset:50176
    s_waitcnt lgkmcnt(15)
    v_mfma_f32_16x16x32_bf16 v[94:97], v[110:113], v[150:153], v[94:97]
    ds_read_b64_tr_b16 v[134:135], v41 offset:49152
    v_mfma_f32_16x16x32_bf16 v[102:105], v[114:117], v[150:153], v[102:105]
    ds_read_b64_tr_b16 v[136:137], v41 offset:50176
    buffer_load_dwordx4 v18, s[4:7], s30 offen offset:3072 lds
    s_waitcnt lgkmcnt(15)
    v_mfma_f32_16x16x32_bf16 v[98:101], v[110:113], v[154:157], v[98:101]
    ds_read_b64_tr_b16 v[138:139], v42 offset:49152
    v_mfma_f32_16x16x32_bf16 v[106:109], v[114:117], v[154:157], v[106:109]
    ds_read_b64_tr_b16 v[140:141], v42 offset:50176
    s_waitcnt lgkmcnt(0)
    s_waitcnt vmcnt(13)
    s_barrier
    v_mfma_f32_16x16x32_bf16 v[46:49], v[118:121], v[158:161], v[46:49]
    ds_read_b128 v[110:113], v23 offset:0
    s_add_u32 m0, s33, 32768
    v_mfma_f32_16x16x32_bf16 v[54:57], v[122:125], v[158:161], v[54:57]
    ds_read_b128 v[114:117], v23 offset:2048
    ds_read_b64_tr_b16 v[142:143], v27 offset:0
    v_mfma_f32_16x16x32_bf16 v[50:53], v[118:121], v[162:165], v[50:53]
    ds_read_b64_tr_b16 v[144:145], v27 offset:1024
    v_mfma_f32_16x16x32_bf16 v[58:61], v[122:125], v[162:165], v[58:61]
    buffer_load_dwordx4 v19, s[8:11], s31 offen offset:0 lds
    ds_read_b64_tr_b16 v[146:147], v28 offset:0
    v_mfma_f32_16x16x32_bf16 v[62:65], v[118:121], v[166:169], v[62:65]
    ds_read_b64_tr_b16 v[148:149], v28 offset:1024
    ds_read_b64_tr_b16 v[150:151], v29 offset:0
    v_mfma_f32_16x16x32_bf16 v[70:73], v[122:125], v[166:169], v[70:73]
    buffer_load_dwordx4 v20, s[8:11], s31 offen offset:1024 lds
    v_mfma_f32_16x16x32_bf16 v[66:69], v[118:121], v[170:173], v[66:69]
    ds_read_b64_tr_b16 v[152:153], v29 offset:1024
    ds_read_b64_tr_b16 v[154:155], v30 offset:0
    v_mfma_f32_16x16x32_bf16 v[74:77], v[122:125], v[170:173], v[74:77]
    ds_read_b64_tr_b16 v[156:157], v30 offset:1024
    v_mfma_f32_16x16x32_bf16 v[78:81], v[118:121], v[126:129], v[78:81]
    ds_read_b64_tr_b16 v[158:159], v31 offset:0
    buffer_load_dwordx4 v21, s[8:11], s31 offen offset:2048 lds
    v_mfma_f32_16x16x32_bf16 v[86:89], v[122:125], v[126:129], v[86:89]
    ds_read_b64_tr_b16 v[160:161], v31 offset:1024
    v_mfma_f32_16x16x32_bf16 v[82:85], v[118:121], v[130:133], v[82:85]
    ds_read_b64_tr_b16 v[162:163], v32 offset:0
    buffer_load_dwordx4 v22, s[8:11], s31 offen offset:3072 lds
    v_mfma_f32_16x16x32_bf16 v[90:93], v[122:125], v[130:133], v[90:93]
    ds_read_b64_tr_b16 v[164:165], v32 offset:1024
    v_mfma_f32_16x16x32_bf16 v[94:97], v[118:121], v[134:137], v[94:97]
    ds_read_b64_tr_b16 v[166:167], v33 offset:0
    v_mfma_f32_16x16x32_bf16 v[102:105], v[122:125], v[134:137], v[102:105]
    ds_read_b64_tr_b16 v[168:169], v33 offset:1024
    s_add_u32 s30, s30, 128
    s_add_u32 s31, s31, 245760
    s_cmp_eq_u32 s30, 1280
    s_cselect_b32 s30, 0, s30
    s_cselect_b32 s31, 0, s31
    v_mfma_f32_16x16x32_bf16 v[98:101], v[118:121], v[138:141], v[98:101]
    ds_read_b64_tr_b16 v[170:171], v34 offset:0
    v_mfma_f32_16x16x32_bf16 v[106:109], v[122:125], v[138:141], v[106:109]
    ds_read_b64_tr_b16 v[172:173], v34 offset:1024
    s_waitcnt lgkmcnt(14)
    v_mfma_f32_16x16x32_bf16 v[46:49], v[110:113], v[142:145], v[46:49]
    ds_read_b128 v[118:121], v24 offset:0
    s_add_u32 m0, s32, 49152
    v_mfma_f32_16x16x32_bf16 v[54:57], v[114:117], v[142:145], v[54:57]
    ds_read_b128 v[122:125], v24 offset:2048
    ds_read_b64_tr_b16 v[126:127], v35 offset:0
    s_waitcnt lgkmcnt(15)
    v_mfma_f32_16x16x32_bf16 v[50:53], v[110:113], v[146:149], v[50:53]
    buffer_load_dwordx4 v15, s[4:7], s30 offen offset:0 lds
    ds_read_b64_tr_b16 v[128:129], v35 offset:1024
    v_mfma_f32_16x16x32_bf16 v[58:61], v[114:117], v[146:149], v[58:61]
    ds_read_b64_tr_b16 v[130:131], v36 offset:0
    s_waitcnt lgkmcnt(15)
    v_mfma_f32_16x16x32_bf16 v[62:65], v[110:113], v[150:153], v[62:65]
    ds_read_b64_tr_b16 v[132:133], v36 offset:1024
    buffer_load_dwordx4 v16, s[4:7], s30 offen offset:1024 lds
    v_mfma_f32_16x16x32_bf16 v[70:73], v[114:117], v[150:153], v[70:73]
    ds_read_b64_tr_b16 v[134:135], v37 offset:0
    ds_read_b64_tr_b16 v[136:137], v37 offset:1024
    s_waitcnt lgkmcnt(15)
    v_mfma_f32_16x16x32_bf16 v[66:69], v[110:113], v[154:157], v[66:69]
    buffer_load_dwordx4 v17, s[4:7], s30 offen offset:2048 lds
    ds_read_b64_tr_b16 v[138:139], v38 offset:0
    v_mfma_f32_16x16x32_bf16 v[74:77], v[114:117], v[154:157], v[74:77]
    ds_read_b64_tr_b16 v[140:141], v38 offset:1024
    s_waitcnt lgkmcnt(15)
    v_mfma_f32_16x16x32_bf16 v[78:81], v[110:113], v[158:161], v[78:81]
    ds_read_b64_tr_b16 v[142:143], v39 offset:0
    buffer_load_dwordx4 v18, s[4:7], s30 offen offset:3072 lds
    v_mfma_f32_16x16x32_bf16 v[86:89], v[114:117], v[158:161], v[86:89]
    ds_read_b64_tr_b16 v[144:145], v39 offset:1024
    s_waitcnt lgkmcnt(15)
    v_mfma_f32_16x16x32_bf16 v[82:85], v[110:113], v[162:165], v[82:85]
    ds_read_b64_tr_b16 v[146:147], v40 offset:0
    s_add_u32 m0, s33, 49152
    v_mfma_f32_16x16x32_bf16 v[90:93], v[114:117], v[162:165], v[90:93]
    ds_read_b64_tr_b16 v[148:149], v40 offset:1024
    s_waitcnt lgkmcnt(15)
    v_mfma_f32_16x16x32_bf16 v[94:97], v[110:113], v[166:169], v[94:97]
    ds_read_b64_tr_b16 v[150:151], v41 offset:0
    buffer_load_dwordx4 v19, s[8:11], s31 offen offset:0 lds
    v_mfma_f32_16x16x32_bf16 v[102:105], v[114:117], v[166:169], v[102:105]
    ds_read_b64_tr_b16 v[152:153], v41 offset:1024
    s_waitcnt lgkmcnt(15)
    v_mfma_f32_16x16x32_bf16 v[98:101], v[110:113], v[170:173], v[98:101]
    ds_read_b64_tr_b16 v[154:155], v42 offset:0
    buffer_load_dwordx4 v20, s[8:11], s31 offen offset:1024 lds
    v_mfma_f32_16x16x32_bf16 v[106:109], v[114:117], v[170:173], v[106:109]
    ds_read_b64_tr_b16 v[156:157], v42 offset:1024
    s_waitcnt lgkmcnt(0)
    s_waitcnt vmcnt(14)
    s_barrier
    v_mfma_f32_16x16x32_bf16 v[46:49], v[118:121], v[126:129], v[46:49]
    ds_read_b128 v[110:113], v23 offset:16384
    buffer_load_dwordx4 v21, s[8:11], s31 offen offset:2048 lds
    v_mfma_f32_16x16x32_bf16 v[54:57], v[122:125], v[126:129], v[54:57]
    ds_read_b128 v[114:117], v23 offset:18432
    ds_read_b64_tr_b16 v[158:159], v27 offset:16384
    v_mfma_f32_16x16x32_bf16 v[50:53], v[118:121], v[130:133], v[50:53]
    ds_read_b64_tr_b16 v[160:161], v27 offset:17408
    v_mfma_f32_16x16x32_bf16 v[58:61], v[122:125], v[130:133], v[58:61]
    buffer_load_dwordx4 v22, s[8:11], s31 offen offset:3072 lds
    ds_read_b64_tr_b16 v[162:163], v28 offset:16384
    v_mfma_f32_16x16x32_bf16 v[62:65], v[118:121], v[134:137], v[62:65]
    ds_read_b64_tr_b16 v[164:165], v28 offset:17408
    ds_read_b64_tr_b16 v[166:167], v29 offset:16384
    v_mfma_f32_16x16x32_bf16 v[70:73], v[122:125], v[134:137], v[70:73]
    s_add_u32 s30, s30, 128
    s_add_u32 s31, s31, 245760
    s_cmp_eq_u32 s30, 1280
    s_cselect_b32 s30, 0, s30
    s_cselect_b32 s31, 0, s31
    v_mfma_f32_16x16x32_bf16 v[66:69], v[118:121], v[138:141], v[66:69]
    ds_read_b64_tr_b16 v[168:169], v29 offset:17408
    ds_read_b64_tr_b16 v[170:171], v30 offset:16384
    v_mfma_f32_16x16x32_bf16 v[74:77], v[122:125], v[138:141], v[74:77]
    ds_read_b64_tr_b16 v[172:173], v30 offset:17408
    v_mfma_f32_16x16x32_bf16 v[78:81], v[118:121], v[142:145], v[78:81]
    ds_read_b64_tr_b16 v[126:127], v31 offset:16384
    s_add_u32 m0, s32, 0
    v_mfma_f32_16x16x32_bf16 v[86:89], v[122:125], v[142:145], v[86:89]
    ds_read_b64_tr_b16 v[128:129], v31 offset:17408
    v_mfma_f32_16x16x32_bf16 v[82:85], v[118:121], v[146:149], v[82:85]
    ds_read_b64_tr_b16 v[130:131], v32 offset:16384
    buffer_load_dwordx4 v15, s[4:7], s30 offen offset:0 lds
    v_mfma_f32_16x16x32_bf16 v[90:93], v[122:125], v[146:149], v[90:93]
    ds_read_b64_tr_b16 v[132:133], v32 offset:17408
    v_mfma_f32_16x16x32_bf16 v[94:97], v[118:121], v[150:153], v[94:97]
    ds_read_b64_tr_b16 v[134:135], v33 offset:16384
    v_mfma_f32_16x16x32_bf16 v[102:105], v[122:125], v[150:153], v[102:105]
    ds_read_b64_tr_b16 v[136:137], v33 offset:17408
    buffer_load_dwordx4 v16, s[4:7], s30 offen offset:1024 lds
    v_mfma_f32_16x16x32_bf16 v[98:101], v[118:121], v[154:157], v[98:101]
    ds_read_b64_tr_b16 v[138:139], v34 offset:16384
    v_mfma_f32_16x16x32_bf16 v[106:109], v[122:125], v[154:157], v[106:109]
    ds_read_b64_tr_b16 v[140:141], v34 offset:17408
    s_waitcnt lgkmcnt(14)
    v_mfma_f32_16x16x32_bf16 v[46:49], v[110:113], v[158:161], v[46:49]
    ds_read_b128 v[118:121], v24 offset:16384
    buffer_load_dwordx4 v17, s[4:7], s30 offen offset:2048 lds
    v_mfma_f32_16x16x32_bf16 v[54:57], v[114:117], v[158:161], v[54:57]
    ds_read_b128 v[122:125], v24 offset:18432
    ds_read_b64_tr_b16 v[142:143], v35 offset:16384
    s_waitcnt lgkmcnt(15)
    v_mfma_f32_16x16x32_bf16 v[50:53], v[110:113], v[162:165], v[50:53]
    buffer_load_dwordx4 v18, s[4:7], s30 offen offset:3072 lds
    ds_read_b64_tr_b16 v[144:145], v35 offset:17408
    v_mfma_f32_16x16x32_bf16 v[58:61], v[114:117], v[162:165], v[58:61]
    ds_read_b64_tr_b16 v[146:147], v36 offset:16384
    s_waitcnt lgkmcnt(15)
    v_mfma_f32_16x16x32_bf16 v[62:65], v[110:113], v[166:169], v[62:65]
    ds_read_b64_tr_b16 v[148:149], v36 offset:17408
    s_add_u32 m0, s33, 0
    v_mfma_f32_16x16x32_bf16 v[70:73], v[114:117], v[166:169], v[70:73]
    ds_read_b64_tr_b16 v[150:151], v37 offset:16384
    ds_read_b64_tr_b16 v[152:153], v37 offset:17408
    s_waitcnt lgkmcnt(15)
    v_mfma_f32_16x16x32_bf16 v[66:69], v[110:113], v[170:173], v[66:69]
    buffer_load_dwordx4 v19, s[8:11], s31 offen offset:0 lds
    ds_read_b64_tr_b16 v[154:155], v38 offset:16384
    v_mfma_f32_16x16x32_bf16 v[74:77], v[114:117], v[170:173], v[74:77]
    ds_read_b64_tr_b16 v[156:157], v38 offset:17408
    s_waitcnt lgkmcnt(15)
    v_mfma_f32_16x16x32_bf16 v[78:81], v[110:113], v[126:129], v[78:81]
    buffer_load_dword v5, v43, s[80:83], 0 offen sc1
    ds_read_b64_tr_b16 v[158:159], v39 offset:16384
    v_mfma_f32_16x16x32_bf16 v[86:89], v[114:117], v[126:129], v[86:89]
    buffer_load_dwordx4 v20, s[8:11], s31 offen offset:1024 lds
    ds_read_b64_tr_b16 v[160:161], v39 offset:17408
    s_waitcnt lgkmcnt(15)
    v_mfma_f32_16x16x32_bf16 v[82:85], v[110:113], v[130:133], v[82:85]
    ds_read_b64_tr_b16 v[162:163], v40 offset:16384
    v_mfma_f32_16x16x32_bf16 v[90:93], v[114:117], v[130:133], v[90:93]
    buffer_load_dwordx4 v21, s[8:11], s31 offen offset:2048 lds
    ds_read_b64_tr_b16 v[164:165], v40 offset:17408
    s_waitcnt lgkmcnt(15)
    v_mfma_f32_16x16x32_bf16 v[94:97], v[110:113], v[134:137], v[94:97]
    ds_read_b64_tr_b16 v[166:167], v41 offset:16384
    buffer_load_dwordx4 v22, s[8:11], s31 offen offset:3072 lds
    v_mfma_f32_16x16x32_bf16 v[102:105], v[114:117], v[134:137], v[102:105]
    ds_read_b64_tr_b16 v[168:169], v41 offset:17408
    s_waitcnt lgkmcnt(15)
    v_mfma_f32_16x16x32_bf16 v[98:101], v[110:113], v[138:141], v[98:101]
    ds_read_b64_tr_b16 v[170:171], v42 offset:16384
    s_add_u32 s30, s30, 128
    s_add_u32 s31, s31, 245760
    s_cmp_eq_u32 s30, 1280
    s_cselect_b32 s30, 0, s30
    s_cselect_b32 s31, 0, s31
    v_mfma_f32_16x16x32_bf16 v[106:109], v[114:117], v[138:141], v[106:109]
    ds_read_b64_tr_b16 v[172:173], v42 offset:17408
    s_waitcnt lgkmcnt(0)
    s_waitcnt vmcnt(17)
    s_barrier
    v_mfma_f32_16x16x32_bf16 v[46:49], v[118:121], v[142:145], v[46:49]
    ds_read_b128 v[110:113], v23 offset:32768
    s_add_u32 m0, s32, 16384
    v_mfma_f32_16x16x32_bf16 v[54:57], v[122:125], v[142:145], v[54:57]
    ds_read_b128 v[114:117], v23 offset:34816
    ds_read_b64_tr_b16 v[126:127], v27 offset:32768
    v_mfma_f32_16x16x32_bf16 v[50:53], v[118:121], v[146:149], v[50:53]
    ds_read_b64_tr_b16 v[128:129], v27 offset:33792
    v_mfma_f32_16x16x32_bf16 v[58:61], v[122:125], v[146:149], v[58:61]
    buffer_load_dwordx4 v15, s[4:7], s30 offen offset:0 lds
    ds_read_b64_tr_b16 v[130:131], v28 offset:32768
    v_mfma_f32_16x16x32_bf16 v[62:65], v[118:121], v[150:153], v[62:65]
    ds_read_b64_tr_b16 v[132:133], v28 offset:33792
    ds_read_b64_tr_b16 v[134:135], v29 offset:32768
    v_mfma_f32_16x16x32_bf16 v[70:73], v[122:125], v[150:153], v[70:73]
    buffer_load_dwordx4 v16, s[4:7], s30 offen offset:1024 lds
    v_mfma_f32_16x16x32_bf16 v[66:69], v[118:121], v[154:157], v[66:69]
    ds_read_b64_tr_b16 v[136:137], v29 offset:33792
    ds_read_b64_tr_b16 v[138:139], v30 offset:32768
    v_mfma_f32_16x16x32_bf16 v[74:77], v[122:125], v[154:157], v[74:77]
    ds_read_b64_tr_b16 v[140:141], v30 offset:33792
    v_mfma_f32_16x16x32_bf16 v[78:81], v[118:121], v[158:161], v[78:81]
    ds_read_b64_tr_b16 v[142:143], v31 offset:32768
    buffer_load_dwordx4 v17, s[4:7], s30 offen offset:2048 lds
    v_mfma_f32_16x16x32_bf16 v[86:89], v[122:125], v[158:161], v[86:89]
    ds_read_b64_tr_b16 v[144:145], v31 offset:33792
    v_mfma_f32_16x16x32_bf16 v[82:85], v[118:121], v[162:165], v[82:85]
    ds_read_b64_tr_b16 v[146:147], v32 offset:32768
    v_mfma_f32_16x16x32_bf16 v[90:93], v[122:125], v[162:165], v[90:93]
    ds_read_b64_tr_b16 v[148:149], v32 offset:33792
    v_mfma_f32_16x16x32_bf16 v[94:97], v[118:121], v[166:169], v[94:97]
    ds_read_b64_tr_b16 v[150:151], v33 offset:32768
    buffer_load_dwordx4 v18, s[4:7], s30 offen offset:3072 lds
    v_mfma_f32_16x16x32_bf16 v[102:105], v[122:125], v[166:169], v[102:105]
    ds_read_b64_tr_b16 v[152:153], v33 offset:33792
    v_mfma_f32_16x16x32_bf16 v[98:101], v[118:121], v[170:173], v[98:101]
    ds_read_b64_tr_b16 v[154:155], v34 offset:32768
    v_mfma_f32_16x16x32_bf16 v[106:109], v[122:125], v[170:173], v[106:109]
    ds_read_b64_tr_b16 v[156:157], v34 offset:33792
    s_waitcnt lgkmcnt(14)
    v_mfma_f32_16x16x32_bf16 v[46:49], v[110:113], v[126:129], v[46:49]
    ds_read_b128 v[118:121], v24 offset:32768
    s_add_u32 m0, s33, 16384
    v_mfma_f32_16x16x32_bf16 v[54:57], v[114:117], v[126:129], v[54:57]
    ds_read_b128 v[122:125], v24 offset:34816
    ds_read_b64_tr_b16 v[158:159], v35 offset:32768
    s_waitcnt lgkmcnt(15)
    v_mfma_f32_16x16x32_bf16 v[50:53], v[110:113], v[130:133], v[50:53]
    buffer_load_dwordx4 v19, s[8:11], s31 offen offset:0 lds
    ds_read_b64_tr_b16 v[160:161], v35 offset:33792
    v_mfma_f32_16x16x32_bf16 v[58:61], v[114:117], v[130:133], v[58:61]
    ds_read_b64_tr_b16 v[162:163], v36 offset:32768
    s_waitcnt lgkmcnt(15)
    v_mfma_f32_16x16x32_bf16 v[62:65], v[110:113], v[134:137], v[62:65]
    ds_read_b64_tr_b16 v[164:165], v36 offset:33792
    buffer_load_dwordx4 v20, s[8:11], s31 offen offset:1024 lds
    v_mfma_f32_16x16x32_bf16 v[70:73], v[114:117], v[134:137], v[70:73]
    ds_read_b64_tr_b16 v[166:167], v37 offset:32768
    ds_read_b64_tr_b16 v[168:169], v37 offset:33792
    s_waitcnt lgkmcnt(15)
    v_mfma_f32_16x16x32_bf16 v[66:69], v[110:113], v[138:141], v[66:69]
    buffer_load_dwordx4 v21, s[8:11], s31 offen offset:2048 lds
    ds_read_b64_tr_b16 v[170:171], v38 offset:32768
    v_mfma_f32_16x16x32_bf16 v[74:77], v[114:117], v[138:141], v[74:77]
    ds_read_b64_tr_b16 v[172:173], v38 offset:33792
    s_waitcnt lgkmcnt(15)
    v_mfma_f32_16x16x32_bf16 v[78:81], v[110:113], v[142:145], v[78:81]
    ds_read_b64_tr_b16 v[126:127], v39 offset:32768
    buffer_load_dwordx4 v22, s[8:11], s31 offen offset:3072 lds
    v_mfma_f32_16x16x32_bf16 v[86:89], v[114:117], v[142:145], v[86:89]
    ds_read_b64_tr_b16 v[128:129], v39 offset:33792
    s_waitcnt lgkmcnt(15)
    v_mfma_f32_16x16x32_bf16 v[82:85], v[110:113], v[146:149], v[82:85]
    ds_read_b64_tr_b16 v[130:131], v40 offset:32768
    v_mfma_f32_16x16x32_bf16 v[90:93], v[114:117], v[146:149], v[90:93]
    ds_read_b64_tr_b16 v[132:133], v40 offset:33792
    s_waitcnt lgkmcnt(15)
    v_mfma_f32_16x16x32_bf16 v[94:97], v[110:113], v[150:153], v[94:97]
    ds_read_b64_tr_b16 v[134:135], v41 offset:32768
    s_add_u32 s30, s30, 128
    s_add_u32 s31, s31, 245760
    s_cmp_eq_u32 s30, 1280
    s_cselect_b32 s30, 0, s30
    s_cselect_b32 s31, 0, s31
    v_mfma_f32_16x16x32_bf16 v[102:105], v[114:117], v[150:153], v[102:105]
    ds_read_b64_tr_b16 v[136:137], v41 offset:33792
    s_waitcnt lgkmcnt(15)
    v_mfma_f32_16x16x32_bf16 v[98:101], v[110:113], v[154:157], v[98:101]
    ds_read_b64_tr_b16 v[138:139], v42 offset:32768
    v_mfma_f32_16x16x32_bf16 v[106:109], v[114:117], v[154:157], v[106:109]
    ds_read_b64_tr_b16 v[140:141], v42 offset:33792
    s_waitcnt lgkmcnt(0)
    s_waitcnt vmcnt(17)
    s_barrier
    v_mfma_f32_16x16x32_bf16 v[46:49], v[118:121], v[158:161], v[46:49]
    s_waitcnt vmcnt(11)
    v_cmp_ne_u32 vcc, v4, v5
    s_cbranch_vccz A_f1x
    s_mov_b32 s34, 0x40000
A_f1:
    buffer_load_dword v5, v43, s[80:83], 0 offen sc1
    s_sub_u32 s34, s34, 1
    s_waitcnt vmcnt(0)
    v_cmp_ne_u32 vcc, v4, v5
    s_cbranch_scc1 A_f1x
    s_cbranch_vccnz A_f1
A_f1x:
    ds_read_b128 v[110:113], v23 offset:49152
    buffer_load_dwordx2 v[204:205], v45, s[16:19], s101 offen offset:0 sc1
    v_mfma_f32_16x16x32_bf16 v[54:57], v[122:125], v[158:161], v[54:57]
    ds_read_b128 v[114:117], v23 offset:51200
    buffer_load_dwordx2 v[206:207], v45, s[16:19], s101 offen offset:2048 sc1
    v_mfma_f32_16x16x32_bf16 v[50:53], v[118:121], v[162:165], v[50:53]
    ds_read_b64_tr_b16 v[142:143], v27 offset:49152
    s_add_u32 s101, s101, 4096
    s_cmp_lt_u32 s3, 2
    s_cselect_b32 s101, s101, 805306368
    buffer_load_dwordx2 v[208:209], v45, s[16:19], s101 offen sc1
    v_mfma_f32_16x16x32_bf16 v[58:61], v[122:125], v[162:165], v[58:61]
    ds_read_b64_tr_b16 v[144:145], v27 offset:50176
    ds_read_b64_tr_b16 v[146:147], v28 offset:49152
    v_mfma_f32_16x16x32_bf16 v[62:65], v[118:121], v[166:169], v[62:65]
    buffer_load_dword v190, v44, s[16:19], s45 offen offset:0 sc1
    ds_read_b64_tr_b16 v[148:149], v28 offset:50176
    buffer_load_dword v191, v44, s[16:19], s45 offen offset:256 sc1
    v_mfma_f32_16x16x32_bf16 v[70:73], v[122:125], v[166:169], v[70:73]
    ds_read_b64_tr_b16 v[150:151], v29 offset:49152
    ds_read_b64_tr_b16 v[152:153], v29 offset:50176
    v_mfma_f32_16x16x32_bf16 v[66:69], v[118:121], v[170:173], v[66:69]
    buffer_load_dword v192, v44, s[16:19], s45 offen offset:512 sc1
    ds_read_b64_tr_b16 v[154:155], v30 offset:49152
    v_mfma_f32_16x16x32_bf16 v[74:77], v[122:125], v[170:173], v[74:77]
    buffer_load_dword v193, v44, s[16:19], s45 offen offset:768 sc1
    ds_read_b64_tr_b16 v[156:157], v30 offset:50176
    v_mfma_f32_16x16x32_bf16 v[78:81], v[118:121], v[126:129], v[78:81]
    ds_read_b64_tr_b16 v[158:159], v31 offset:49152
    ds_read_b64_tr_b16 v[160:161], v31 offset:50176
    v_mfma_f32_16x16x32_bf16 v[86:89], v[122:125], v[126:129], v[86:89]
    buffer_load_dword v194, v44, s[16:19], s45 offen offset:1024 sc1
    ds_read_b64_tr_b16 v[162:163], v32 offset:49152
    v_mfma_f32_16x16x32_bf16 v[82:85], v[118:121], v[130:133], v[82:85]
    buffer_load_dword v195, v44, s[16:19], s45 offen offset:1280 sc1
    ds_read_b64_tr_b16 v[164:165], v32 offset:50176
    v_mfma_f32_16x16x32_bf16 v[90:93], v[122:125], v[130:133], v[90:93]
    buffer_load_dword v196, v44, s[16:19], s45 offen offset:1536 sc1
    v_mfma_f32_16x16x32_bf16 v[94:97], v[118:121], v[134:137], v[94:97]
    ds_read_b64_tr_b16 v[166:167], v33 offset:49152
    buffer_load_dword v197, v44, s[16:19], s45 offen offset:1792 sc1
    v_mfma_f32_16x16x32_bf16 v[102:105], v[122:125], v[134:137], v[102:105]
    ds_read_b64_tr_b16 v[168:169], v33 offset:50176
    buffer_load_dword v198, v44, s[16:19], s45 offen offset:2048 sc1
    v_mfma_f32_16x16x32_bf16 v[98:101], v[118:121], v[138:141], v[98:101]
    ds_read_b64_tr_b16 v[170:171], v34 offset:49152
    buffer_load_dword v199, v44, s[16:19], s45 offen offset:2304 sc1
    v_mfma_f32_16x16x32_bf16 v[106:109], v[122:125], v[138:141], v[106:109]
    ds_read_b64_tr_b16 v[172:173], v34 offset:50176
    s_waitcnt lgkmcnt(14)
    v_mfma_f32_16x16x32_bf16 v[46:49], v[110:113], v[142:145], v[46:49]
    ds_read_b128 v[118:121], v24 offset:49152
    ds_read_b128 v[122:125], v24 offset:51200
    v_mfma_f32_16x16x32_bf16 v[54:57], v[114:117], v[142:145], v[54:57]
    ds_read_b64_tr_b16 v[126:127], v35 offset:49152
    s_waitcnt lgkmcnt(15)
    v_mfma_f32_16x16x32_bf16 v[50:53], v[110:113], v[146:149], v[50:53]
    ds_read_b64_tr_b16 v[128:129], v35 offset:50176
    ds_read_b64_tr_b16 v[130:131], v36 offset:49152
    v_mfma_f32_16x16x32_bf16 v[58:61], v[114:117], v[146:149], v[58:61]
    ds_read_b64_tr_b16 v[132:133], v36 offset:50176
    s_waitcnt lgkmcnt(15)
    v_mfma_f32_16x16x32_bf16 v[62:65], v[110:113], v[150:153], v[62:65]
    ds_read_b64_tr_b16 v[134:135], v37 offset:49152
    v_mfma_f32_16x16x32_bf16 v[70:73], v[114:117], v[150:153], v[70:73]
    ds_read_b64_tr_b16 v[136:137], v37 offset:50176
    ds_read_b64_tr_b16 v[138:139], v38 offset:49152
    s_waitcnt lgkmcnt(15)
    v_mfma_f32_16x16x32_bf16 v[66:69], v[110:113], v[154:157], v[66:69]
    ds_read_b64_tr_b16 v[140:141], v38 offset:50176
    v_mfma_f32_16x16x32_bf16 v[74:77], v[114:117], v[154:157], v[74:77]
    s_movk_i32 s100, 0
    buffer_load_dword v250, v251, s[88:91], s100 offen
    v_mfma_f32_16x16x32_bf16 v[78:81], v[110:113], v[158:161], v[78:81]
    ds_read_b64_tr_b16 v[142:143], v39 offset:49152
    v_mfma_f32_16x16x32_bf16 v[86:89], v[114:117], v[158:161], v[86:89]
    ds_read_b64_tr_b16 v[144:145], v39 offset:50176
    s_waitcnt lgkmcnt(15)
    v_mfma_f32_16x16x32_bf16 v[82:85], v[110:113], v[162:165], v[82:85]
    ds_read_b64_tr_b16 v[146:147], v40 offset:49152
    v_mfma_f32_16x16x32_bf16 v[90:93], v[114:117], v[162:165], v[90:93]
    ds_read_b64_tr_b16 v[148:149], v40 offset:50176
    s_waitcnt lgkmcnt(15)
    v_mfma_f32_16x16x32_bf16 v[94:97], v[110:113], v[166:169], v[94:97]
    ds_read_b64_tr_b16 v[150:151], v41 offset:49152
    v_mfma_f32_16x16x32_bf16 v[102:105], v[114:117], v[166:169], v[102:105]
    ds_read_b64_tr_b16 v[152:153], v41 offset:50176
    s_waitcnt lgkmcnt(15)
    v_mfma_f32_16x16x32_bf16 v[98:101], v[110:113], v[170:173], v[98:101]
    ds_read_b64_tr_b16 v[154:155], v42 offset:49152
    v_mfma_f32_16x16x32_bf16 v[106:109], v[114:117], v[170:173], v[106:109]
    ds_read_b64_tr_b16 v[156:157], v42 offset:50176
    s_waitcnt lgkmcnt(0)
    s_waitcnt vmcnt(22)
    s_barrier
    v_mfma_f32_16x16x32_bf16 v[46:49], v[118:121], v[126:129], v[46:49]
    ds_read_b128 v[110:113], v23 offset:0
    ds_read_b128 v[114:117], v23 offset:2048
    v_mfma_f32_16x16x32_bf16 v[54:57], v[122:125], v[126:129], v[54:57]
    ds_read_b64_tr_b16 v[158:159], v27 offset:0
    v_mfma_f32_16x16x32_bf16 v[50:53], v[118:121], v[130:133], v[50:53]
    ds_read_b64_tr_b16 v[160:161], v27 offset:1024
    ds_read_b64_tr_b16 v[162:163], v28 offset:0
    v_mfma_f32_16x16x32_bf16 v[58:61], v[122:125], v[130:133], v[58:61]
    ds_read_b64_tr_b16 v[164:165], v28 offset:1024
    v_mfma_f32_16x16x32_bf16 v[62:65], v[118:121], v[134:137], v[62:65]
    ds_read_b64_tr_b16 v[166:167], v29 offset:0
    v_mfma_f32_16x16x32_bf16 v[70:73], v[122:125], v[134:137], v[70:73]
    ds_read_b64_tr_b16 v[168:169], v29 offset:1024
    ds_read_b64_tr_b16 v[170:171], v30 offset:0
    v_mfma_f32_16x16x32_bf16 v[66:69], v[118:121], v[138:141], v[66:69]
    ds_read_b64_tr_b16 v[172:173], v30 offset:1024
    v_mfma_f32_16x16x32_bf16 v[74:77], v[122:125], v[138:141], v[74:77]
    s_movk_i32 s100, 13824
    buffer_load_dword v250, v251, s[88:91], s100 offen
    v_mfma_f32_16x16x32_bf16 v[78:81], v[118:121], v[142:145], v[78:81]
    ds_read_b64_tr_b16 v[126:127], v31 offset:0
    v_mfma_f32_16x16x32_bf16 v[86:89], v[122:125], v[142:145], v[86:89]
    ds_read_b64_tr_b16 v[128:129], v31 offset:1024
    v_mfma_f32_16x16x32_bf16 v[82:85], v[118:121], v[146:149], v[82:85]
    ds_read_b64_tr_b16 v[130:131], v32 offset:0
    v_mfma_f32_16x16x32_bf16 v[90:93], v[122:125], v[146:149], v[90:93]
    ds_read_b64_tr_b16 v[132:133], v32 offset:1024
    v_mfma_f32_16x16x32_bf16 v[94:97], v[118:121], v[150:153], v[94:97]
    ds_read_b64_tr_b16 v[134:135], v33 offset:0
    v_mfma_f32_16x16x32_bf16 v[102:105], v[122:125], v[150:153], v[102:105]
    ds_read_b64_tr_b16 v[136:137], v33 offset:1024
    v_mfma_f32_16x16x32_bf16 v[98:101], v[118:121], v[154:157], v[98:101]
    ds_read_b64_tr_b16 v[138:139], v34 offset:0
    v_mfma_f32_16x16x32_bf16 v[106:109], v[122:125], v[154:157], v[106:109]
    ds_read_b64_tr_b16 v[140:141], v34 offset:1024
    s_waitcnt lgkmcnt(14)
    v_mfma_f32_16x16x32_bf16 v[46:49], v[110:113], v[158:161], v[46:49]
    ds_read_b128 v[118:121], v24 offset:0
    ds_read_b128 v[122:125], v24 offset:2048
    v_mfma_f32_16x16x32_bf16 v[54:57], v[114:117], v[158:161], v[54:57]
    ds_read_b64_tr_b16 v[142:143], v35 offset:0
    s_waitcnt lgkmcnt(15)
    v_mfma_f32_16x16x32_bf16 v[50:53], v[110:113], v[162:165], v[50:53]
    ds_read_b64_tr_b16 v[144:145], v35 offset:1024
    v_mfma_f32_16x16x32_bf16 v[58:61], v[114:117], v[162:165], v[58:61]
    ds_read_b64_tr_b16 v[146:147], v36 offset:0
    s_waitcnt lgkmcnt(15)
    v_mfma_f32_16x16x32_bf16 v[62:65], v[110:113], v[166:169], v[62:65]
    ds_read_b64_tr_b16 v[148:149], v36 offset:1024
    ds_read_b64_tr_b16 v[150:151], v37 offset:0
    v_mfma_f32_16x16x32_bf16 v[70:73], v[114:117], v[166:169], v[70:73]
    ds_read_b64_tr_b16 v[152:153], v37 offset:1024
    s_waitcnt lgkmcnt(15)
    v_mfma_f32_16x16x32_bf16 v[66:69], v[110:113], v[170:173], v[66:69]
    ds_read_b64_tr_b16 v[154:155], v38 offset:0
    v_mfma_f32_16x16x32_bf16 v[74:77], v[114:117], v[170:173], v[74:77]
    ds_read_b64_tr_b16 v[156:157], v38 offset:1024
    s_waitcnt lgkmcnt(15)
    v_mfma_f32_16x16x32_bf16 v[78:81], v[110:113], v[126:129], v[78:81]
    ds_read_b64_tr_b16 v[158:159], v39 offset:0
    ds_read_b64_tr_b16 v[160:161], v39 offset:1024
    v_mfma_f32_16x16x32_bf16 v[86:89], v[114:117], v[126:129], v[86:89]
    s_waitcnt vmcnt(13)
    v_add_f32 v204, v204, v206
    ds_read_b64_tr_b16 v[162:163], v40 offset:0
    s_waitcnt lgkmcnt(15)
    v_mfma_f32_16x16x32_bf16 v[82:85], v[110:113], v[130:133], v[82:85]
    v_add_f32 v205, v205, v207
    v_mfma_f32_16x16x32_bf16 v[90:93], v[114:117], v[130:133], v[90:93]
    ds_read_b64_tr_b16 v[164:165], v40 offset:1024
    s_waitcnt vmcnt(12)
    v_add_f32 v186, v204, v208
    v_mfma_f32_16x16x32_bf16 v[94:97], v[110:113], v[134:137], v[94:97]
    ds_read_b64_tr_b16 v[166:167], v41 offset:0
    ds_read_b64_tr_b16 v[168:169], v41 offset:1024
    v_mfma_f32_16x16x32_bf16 v[102:105], v[114:117], v[134:137], v[102:105]
    v_add_f32 v187, v205, v209
    s_waitcnt lgkmcnt(15)
    v_mfma_f32_16x16x32_bf16 v[98:101], v[110:113], v[138:141], v[98:101]
    ds_read_b64_tr_b16 v[170:171], v42 offset:0
    ds_write_b64 v203, v[186:187]
    v_mfma_f32_16x16x32_bf16 v[106:109], v[114:117], v[138:141], v[106:109]
    ds_read_b64_tr_b16 v[172:173], v42 offset:1024
    s_waitcnt lgkmcnt(0)
    s_barrier
    v_mfma_f32_16x16x32_bf16 v[46:49], v[118:121], v[142:145], v[46:49]
    ds_read_b128 v[110:113], v23 offset:16384
    ds_read_b128 v[114:117], v23 offset:18432
    ds_read_b64 v[204:205], v242 offset:0
    v_mfma_f32_16x16x32_bf16 v[54:57], v[122:125], v[142:145], v[54:57]
    ds_read_b64 v[206:207], v242 offset:1024
    ds_read_b64_tr_b16 v[126:127], v27 offset:16384
    ds_read_b64 v[208:209], v242 offset:2048
    v_mfma_f32_16x16x32_bf16 v[50:53], v[118:121], v[146:149], v[50:53]
    ds_read_b64_tr_b16 v[128:129], v27 offset:17408
    ds_read_b64 v[210:211], v242 offset:3072
    ds_read_b64_tr_b16 v[130:131], v28 offset:16384
    v_mfma_f32_16x16x32_bf16 v[58:61], v[122:125], v[146:149], v[58:61]
    s_waitcnt vmcnt(6)
    v_add_f32 v190, v190, v195
    s_waitcnt vmcnt(5)
    v_add_f32 v191, v191, v196
    v_mfma_f32_16x16x32_bf16 v[62:65], v[118:121], v[150:153], v[62:65]
    ds_read_b64_tr_b16 v[132:133], v28 offset:17408
    s_waitcnt vmcnt(4)
    v_add_f32 v192, v192, v197
    ds_read_b64_tr_b16 v[134:135], v29 offset:16384
    v_mfma_f32_16x16x32_bf16 v[70:73], v[122:125], v[150:153], v[70:73]
    s_waitcnt vmcnt(3)
    v_add_f32 v193, v193, v198
    ds_read_b64_tr_b16 v[136:137], v29 offset:17408
    s_waitcnt vmcnt(2)
    v_add_f32 v194, v194, v199
    v_mfma_f32_16x16x32_bf16 v[66:69], v[118:121], v[154:157], v[66:69]
    v_add_f32 v190, v190, v192
    ds_read_b64_tr_b16 v[138:139], v30 offset:16384
    v_add_f32 v191, v191, v193
    v_mfma_f32_16x16x32_bf16 v[74:77], v[122:125], v[154:157], v[74:77]
    ds_read_b64_tr_b16 v[140:141], v30 offset:17408
    v_add_f32 v190, v190, v191
    v_mfma_f32_16x16x32_bf16 v[78:81], v[118:121], v[158:161], v[78:81]
    ds_read_b64_tr_b16 v[142:143], v31 offset:16384
    ds_read_b64_tr_b16 v[144:145], v31 offset:17408
    v_add_f32 v178, v190, v194
    v_mfma_f32_16x16x32_bf16 v[86:89], v[122:125], v[158:161], v[86:89]
    v_mov_b32 v182, v178
    ds_read_b64_tr_b16 v[146:147], v32 offset:16384
    v_mfma_f32_16x16x32_bf16 v[82:85], v[118:121], v[162:165], v[82:85]
    s_waitcnt lgkmcnt(11)
    v_add_f32 v204, v204, v208
    v_permlane32_swap_b32 v178, v182
    ds_read_b64_tr_b16 v[148:149], v32 offset:17408
    v_mfma_f32_16x16x32_bf16 v[90:93], v[122:125], v[162:165], v[90:93]
    v_add_f32 v205, v205, v209
    v_mul_f32 v178, 0xbacccccd, v178
    v_mfma_f32_16x16x32_bf16 v[94:97], v[118:121], v[166:169], v[94:97]
    ds_read_b64_tr_b16 v[150:151], v33 offset:16384
    s_waitcnt lgkmcnt(11)
    v_add_f32 v206, v206, v210
    ds_read_b64_tr_b16 v[152:153], v33 offset:17408
    v_mfma_f32_16x16x32_bf16 v[102:105], v[122:125], v[166:169], v[102:105]
    v_mul_f32 v182, 0x3acccccd, v182
    v_add_f32 v207, v207, v211
    v_mfma_f32_16x16x32_bf16 v[98:101], v[118:121], v[170:173], v[98:101]
    ds_read_b64_tr_b16 v[154:155], v34 offset:16384
    v_cvt_pk_bf16_f32 v236, v178, v178
    v_add_f32 v204, v204, v206
    v_mfma_f32_16x16x32_bf16 v[106:109], v[122:125], v[170:173], v[106:109]
    ds_read_b64_tr_b16 v[156:157], v34 offset:17408
    v_fma_f32 v182, -v178, v178, v182
    v_mfma_f32_16x16x32_bf16 v[46:49], v[110:113], v[126:129], v[46:49]
    ds_read_b128 v[118:121], v24 offset:16384
    ds_read_b128 v[122:125], v24 offset:18432
    v_add_f32 v205, v205, v207
    v_mfma_f32_16x16x32_bf16 v[54:57], v[114:117], v[126:129], v[54:57]
    v_and_b32 v179, 0xffff0000, v236
    ds_read_b64_tr_b16 v[158:159], v35 offset:16384
    v_cvt_pk_bf16_f32 v208, v204, v204
    s_waitcnt lgkmcnt(15)
    v_mfma_f32_16x16x32_bf16 v[50:53], v[110:113], v[130:133], v[50:53]
    ds_read_b64_tr_b16 v[160:161], v35 offset:17408
    v_max_f32 v182, 0, v182
    ds_read_b64_tr_b16 v[162:163], v36 offset:16384
    v_mfma_f32_16x16x32_bf16 v[58:61], v[114:117], v[130:133], v[58:61]
    v_sub_f32 v178, v178, v179
    v_cvt_pk_bf16_f32 v209, v205, v205
    ds_read_b64_tr_b16 v[164:165], v36 offset:17408
    s_waitcnt lgkmcnt(15)
    v_mfma_f32_16x16x32_bf16 v[62:65], v[110:113], v[134:137], v[62:65]
    v_add_f32 v182, 0x3727c5ac, v182
    ds_read_b64_tr_b16 v[166:167], v37 offset:16384
    v_and_b32 v208, 0xffff0000, v208
    v_mfma_f32_16x16x32_bf16 v[70:73], v[114:117], v[134:137], v[70:73]
    ds_read_b64_tr_b16 v[168:169], v37 offset:17408
    v_cvt_pk_bf16_f32 v237, v178, v178
    v_and_b32 v209, 0xffff0000, v209
    s_waitcnt lgkmcnt(15)
    v_mfma_f32_16x16x32_bf16 v[66:69], v[110:113], v[138:141], v[66:69]
    ds_read_b64_tr_b16 v[170:171], v38 offset:16384
    v_rsq_f32 v240, v182
    ds_read_b64_tr_b16 v[172:173], v38 offset:17408
    v_mfma_f32_16x16x32_bf16 v[74:77], v[114:117], v[138:141], v[74:77]
    v_sub_f32 v204, v204, v208
    buffer_load_dword v5, off, s[24:27], 0 sc1
    s_waitcnt lgkmcnt(15)
    v_mfma_f32_16x16x32_bf16 v[78:81], v[110:113], v[142:145], v[78:81]
    ds_read_b64_tr_b16 v[126:127], v39 offset:16384
    ds_read_b64_tr_b16 v[128:129], v39 offset:17408
    v_mov_b32 v238, v236
    v_mfma_f32_16x16x32_bf16 v[86:89], v[114:117], v[142:145], v[86:89]
    v_sub_f32 v205, v205, v209
    ds_read_b64_tr_b16 v[130:131], v40 offset:16384
    s_waitcnt lgkmcnt(15)
    v_mfma_f32_16x16x32_bf16 v[82:85], v[110:113], v[146:149], v[82:85]
    v_mov_b32 v239, v237
    ds_read_b64_tr_b16 v[132:133], v40 offset:17408
    v_mfma_f32_16x16x32_bf16 v[90:93], v[114:117], v[146:149], v[90:93]
    v_cvt_pk_bf16_f32 v204, v208, v204
    v_permlane16_swap_b32 v236, v238
    v_mfma_f32_16x16x32_bf16 v[94:97], v[110:113], v[150:153], v[94:97]
    ds_read_b64_tr_b16 v[134:135], v41 offset:16384
    v_cvt_pk_bf16_f32 v205, v209, v205
    ds_read_b64_tr_b16 v[136:137], v41 offset:17408
    v_mfma_f32_16x16x32_bf16 v[102:105], v[114:117], v[150:153], v[102:105]
    v_permlane16_swap_b32 v237, v239
    ds_write_b32 v243, v240
    s_waitcnt lgkmcnt(15)
    v_mfma_f32_16x16x32_bf16 v[98:101], v[110:113], v[154:157], v[98:101]
    ds_read_b64_tr_b16 v[138:139], v42 offset:16384
    s_mov_b32 vcc_lo, 0xffff
    s_mov_b32 vcc_hi, 0x0
    v_cndmask_b32 v220, 0, v204, vcc
    v_cndmask_b32 v221, 0, v204, vcc
    v_cndmask_b32 v228, 0, v205, vcc
    v_cndmask_b32 v229, 0, v205, vcc
    v_mfma_f32_16x16x32_bf16 v[106:109], v[114:117], v[154:157], v[106:109]
    ds_read_b64_tr_b16 v[140:141], v42 offset:17408
    s_mov_b32 vcc_lo, 0xffff0000
    s_mov_b32 vcc_hi, 0x0
    v_cndmask_b32 v222, 0, v204, vcc
    v_cndmask_b32 v223, 0, v204, vcc
    v_cndmask_b32 v230, 0, v205, vcc
    v_cndmask_b32 v231, 0, v205, vcc
    s_waitcnt lgkmcnt(15)
    v_mfma_f32_16x16x32_bf16 v[46:49], v[118:121], v[158:161], v[46:49]
    s_mov_b32 vcc_lo, 0x0
    s_mov_b32 vcc_hi, 0xffff
    v_cndmask_b32 v224, 0, v204, vcc
    v_cndmask_b32 v225, 0, v204, vcc
    v_cndmask_b32 v232, 0, v205, vcc
    v_cndmask_b32 v233, 0, v205, vcc
    v_mfma_f32_16x16x32_bf16 v[54:57], v[122:125], v[158:161], v[54:57]
    s_waitcnt lgkmcnt(13)
    v_mfma_f32_16x16x32_bf16 v[50:53], v[118:121], v[162:165], v[50:53]
    v_mfma_f32_16x16x32_bf16 v[58:61], v[122:125], v[162:165], v[58:61]
    s_waitcnt lgkmcnt(11)
    v_mfma_f32_16x16x32_bf16 v[62:65], v[118:121], v[166:169], v[62:65]
    s_mov_b32 vcc_lo, 0x0
    s_mov_b32 vcc_hi, 0xffff0000
    v_cndmask_b32 v226, 0, v204, vcc
    v_cndmask_b32 v227, 0, v204, vcc
    v_cndmask_b32 v234, 0, v205, vcc
    v_cndmask_b32 v235, 0, v205, vcc
    v_mfma_f32_16x16x32_bf16 v[70:73], v[122:125], v[166:169], v[70:73]
    s_waitcnt lgkmcnt(9)
    v_mfma_f32_16x16x32_bf16 v[66:69], v[118:121], v[170:173], v[66:69]
    v_mfma_f32_16x16x32_bf16 v[74:77], v[122:125], v[170:173], v[74:77]
    v_mfma_f32_16x16x16_bf16 v[46:49], v[236:237], v[220:221], v[46:49]
    ds_read_b128 v[212:215], v244 offset:0
    v_mfma_f32_16x16x16_bf16 v[54:57], v[238:239], v[220:221], v[54:57]
    v_mfma_f32_16x16x16_bf16 v[78:81], v[236:237], v[228:229], v[78:81]
    v_mfma_f32_16x16x16_bf16 v[86:89], v[238:239], v[228:229], v[86:89]
    v_mfma_f32_16x16x16_bf16 v[50:53], v[236:237], v[222:223], v[50:53]
    ds_read_b128 v[216:219], v244 offset:64
    v_mfma_f32_16x16x16_bf16 v[58:61], v[238:239], v[222:223], v[58:61]
    v_mfma_f32_16x16x16_bf16 v[82:85], v[236:237], v[230:231], v[82:85]
    v_mfma_f32_16x16x16_bf16 v[90:93], v[238:239], v[230:231], v[90:93]
    s_waitcnt lgkmcnt(9)
    v_mfma_f32_16x16x32_bf16 v[78:81], v[118:121], v[126:129], v[78:81]
    v_mfma_f32_16x16x32_bf16 v[86:89], v[122:125], v[126:129], v[86:89]
    s_waitcnt lgkmcnt(7)
    v_mfma_f32_16x16x32_bf16 v[82:85], v[118:121], v[130:133], v[82:85]
    v_mfma_f32_16x16x32_bf16 v[90:93], v[122:125], v[130:133], v[90:93]
    s_waitcnt lgkmcnt(5)
    v_mfma_f32_16x16x32_bf16 v[94:97], v[118:121], v[134:137], v[94:97]
    v_mfma_f32_16x16x32_bf16 v[102:105], v[122:125], v[134:137], v[102:105]
    s_waitcnt lgkmcnt(2)
    v_mfma_f32_16x16x32_bf16 v[98:101], v[118:121], v[138:141], v[98:101]
    v_mfma_f32_16x16x32_bf16 v[106:109], v[122:125], v[138:141], v[106:109]
    v_mfma_f32_16x16x16_bf16 v[62:65], v[236:237], v[224:225], v[62:65]
    v_mfma_f32_16x16x16_bf16 v[70:73], v[238:239], v[224:225], v[70:73]
    v_mfma_f32_16x16x16_bf16 v[94:97], v[236:237], v[232:233], v[94:97]
    v_mfma_f32_16x16x16_bf16 v[102:105], v[238:239], v[232:233], v[102:105]
    v_mfma_f32_16x16x16_bf16 v[66:69], v[236:237], v[226:227], v[66:69]
    v_mfma_f32_16x16x16_bf16 v[74:77], v[238:239], v[226:227], v[74:77]
    v_mfma_f32_16x16x16_bf16 v[98:101], v[236:237], v[234:235], v[98:101]
    v_mfma_f32_16x16x16_bf16 v[106:109], v[238:239], v[234:235], v[106:109]
    s_waitcnt lgkmcnt(1)
    v_pk_mul_f32 v[46:47], v[46:47], v[212:213]
    v_pk_mul_f32 v[48:49], v[48:49], v[214:215]
    v_pk_mul_f32 v[50:51], v[50:51], v[212:213]
    v_pk_mul_f32 v[52:53], v[52:53], v[214:215]
    s_waitcnt lgkmcnt(0)
    v_pk_mul_f32 v[54:55], v[54:55], v[216:217]
    v_pk_mul_f32 v[56:57], v[56:57], v[218:219]
    v_pk_mul_f32 v[58:59], v[58:59], v[216:217]
    v_pk_mul_f32 v[60:61], v[60:61], v[218:219]
    v_cvt_pk_bf16_f32 v126, v46, v47
    v_cvt_pk_bf16_f32 v127, v48, v49
    v_cvt_pk_bf16_f32 v128, v50, v51
    v_cvt_pk_bf16_f32 v129, v52, v53
    s_nop 0
    v_permlane16_swap_b32 v126, v128
    v_permlane16_swap_b32 v127, v129
    buffer_store_dwordx4 v[126:129], v245, s[12:15], s42 offen offset:0 sc1
    v_cvt_pk_bf16_f32 v130, v54, v55
    v_cvt_pk_bf16_f32 v131, v56, v57
    v_cvt_pk_bf16_f32 v132, v58, v59
    v_cvt_pk_bf16_f32 v133, v60, v61
    s_nop 0
    v_permlane16_swap_b32 v130, v132
    v_permlane16_swap_b32 v131, v133
    buffer_store_dwordx4 v[130:133], v245, s[12:15], s42 offen offset:640 sc1
    v_pk_mul_f32 v[62:63], v[62:63], v[212:213]
    v_pk_mul_f32 v[64:65], v[64:65], v[214:215]
    v_pk_mul_f32 v[66:67], v[66:67], v[212:213]
    v_pk_mul_f32 v[68:69], v[68:69], v[214:215]
    v_pk_mul_f32 v[70:71], v[70:71], v[216:217]
    v_pk_mul_f32 v[72:73], v[72:73], v[218:219]
    v_pk_mul_f32 v[74:75], v[74:75], v[216:217]
    v_pk_mul_f32 v[76:77], v[76:77], v[218:219]
    v_cvt_pk_bf16_f32 v134, v62, v63
    v_cvt_pk_bf16_f32 v135, v64, v65
    v_cvt_pk_bf16_f32 v136, v66, v67
    v_cvt_pk_bf16_f32 v137, v68, v69
    s_nop 0
    v_permlane16_swap_b32 v134, v136
    v_permlane16_swap_b32 v135, v137
    buffer_store_dwordx4 v[134:137], v246, s[12:15], s42 offen offset:0 sc1
    v_cvt_pk_bf16_f32 v138, v70, v71
    v_cvt_pk_bf16_f32 v139, v72, v73
    v_cvt_pk_bf16_f32 v140, v74, v75
    v_cvt_pk_bf16_f32 v141, v76, v77
    s_nop 0
    v_permlane16_swap_b32 v138, v140
    v_permlane16_swap_b32 v139, v141
    buffer_store_dwordx4 v[138:141], v246, s[12:15], s42 offen offset:640 sc1
    v_pk_mul_f32 v[78:79], v[78:79], v[212:213]
    v_pk_mul_f32 v[80:81], v[80:81], v[214:215]
    v_pk_mul_f32 v[82:83], v[82:83], v[212:213]
    v_pk_mul_f32 v[84:85], v[84:85], v[214:215]
    v_pk_mul_f32 v[86:87], v[86:87], v[216:217]
    v_pk_mul_f32 v[88:89], v[88:89], v[218:219]
    v_pk_mul_f32 v[90:91], v[90:91], v[216:217]
    v_pk_mul_f32 v[92:93], v[92:93], v[218:219]
    v_cvt_pk_bf16_f32 v142, v78, v79
    v_cvt_pk_bf16_f32 v143, v80, v81
    v_cvt_pk_bf16_f32 v144, v82, v83
    v_cvt_pk_bf16_f32 v145, v84, v85
    s_nop 0
    v_permlane16_swap_b32 v142, v144
    v_permlane16_swap_b32 v143, v145
    buffer_store_dwordx4 v[142:145], v247, s[12:15], s42 offen offset:0 sc1
    v_cvt_pk_bf16_f32 v146, v86, v87
    v_cvt_pk_bf16_f32 v147, v88, v89
    v_cvt_pk_bf16_f32 v148, v90, v91
    v_cvt_pk_bf16_f32 v149, v92, v93
    s_nop 0
    v_permlane16_swap_b32 v146, v148
    v_permlane16_swap_b32 v147, v149
    buffer_store_dwordx4 v[146:149], v247, s[12:15], s42 offen offset:640 sc1
    v_pk_mul_f32 v[94:95], v[94:95], v[212:213]
    v_pk_mul_f32 v[96:97], v[96:97], v[214:215]
    v_pk_mul_f32 v[98:99], v[98:99], v[212:213]
    v_pk_mul_f32 v[100:101], v[100:101], v[214:215]
    v_pk_mul_f32 v[102:103], v[102:103], v[216:217]
    v_pk_mul_f32 v[104:105], v[104:105], v[218:219]
    v_pk_mul_f32 v[106:107], v[106:107], v[216:217]
    v_pk_mul_f32 v[108:109], v[108:109], v[218:219]
    v_cvt_pk_bf16_f32 v150, v94, v95
    v_cvt_pk_bf16_f32 v151, v96, v97
    v_cvt_pk_bf16_f32 v152, v98, v99
    v_cvt_pk_bf16_f32 v153, v100, v101
    s_nop 0
    v_permlane16_swap_b32 v150, v152
    v_permlane16_swap_b32 v151, v153
    buffer_store_dwordx4 v[150:153], v248, s[12:15], s42 offen offset:0 sc1
    v_cvt_pk_bf16_f32 v154, v102, v103
    v_cvt_pk_bf16_f32 v155, v104, v105
    v_cvt_pk_bf16_f32 v156, v106, v107
    v_cvt_pk_bf16_f32 v157, v108, v109
    s_nop 0
    v_permlane16_swap_b32 v154, v156
    v_permlane16_swap_b32 v155, v157
    buffer_store_dwordx4 v[154:157], v248, s[12:15], s42 offen offset:640 sc1
    s_branch A_done
A_prep:
    s_sub_u32 s35, s85, 30
    s_lshl1_add_u32 s28, s84, s35
    s_waitcnt lgkmcnt(0)
    s_mov_b32 s4, s40
    s_mov_b32 s5, s41
    s_mov_b32 s6, 0xc8000
    s_mov_b32 s7, 0x20000
    s_add_u32 s8, s86, 0x1100000
    s_addc_u32 s9, s87, 0
    s_mov_b32 s10, 0xc8000
    s_mov_b32 s11, 0x20000
    s_add_u32 s12, s86, 0x11d0000
    s_addc_u32 s13, s87, 0
    s_mov_b32 s14, 0x20000
    s_mov_b32 s15, 0x20000
    s_add_u32 s80, s86, 0x1200000
    s_addc_u32 s81, s87, 0
    s_mov_b32 s82, 0x40000
    s_mov_b32 s83, 0x20000
    s_mov_b32 s26, 0x100
    s_mov_b32 s27, 0x20000
    v_mov_b32 v20, 0
    v_mov_b32 v24, 0
    v_mov_b32 v25, 0
    v_mov_b32 v26, 0
    v_mov_b32 v27, 0
    s_cmp_lg_u32 s3, 0
    s_cbranch_scc1 A_p1
    s_lshl_b32 s34, s28, 11
    s_add_u32 s34, s34, 98304
    v_lshlrev_b32 v10, 6, v1
    buffer_store_dwordx4 v[24:27], v2, s[80:83], s34 offen offset:0 sc1
    buffer_store_dwordx4 v[24:27], v2, s[80:83], s34 offen offset:1024 sc1
    s_mov_b64 exec, 1
    s_waitcnt vmcnt(0)
    buffer_atomic_add v4, off, s[24:27], 0 offset:128 sc1
    s_mov_b64 exec, -1
A_p1:
    s_mul_i32 s30, s3, 13312
    s_mul_i32 s31, s28, 51200
    s_add_u32 s31, s31, s30
    s_add_u32 m0, s30, 0
    s_add_u32 s34, s31, 0
    buffer_load_dwordx4 v2, s[4:7], s34 offen offset:0 lds
    buffer_load_dwordx4 v2, s[4:7], s34 offen offset:1024 lds
    buffer_load_dwordx4 v2, s[4:7], s34 offen offset:2048 lds
    buffer_load_dwordx4 v2, s[4:7], s34 offen offset:3072 lds
    s_add_u32 m0, s30, 4096
    s_add_u32 s34, s31, 4096
    buffer_load_dwordx4 v2, s[4:7], s34 offen offset:0 lds
    buffer_load_dwordx4 v2, s[4:7], s34 offen offset:1024 lds
    buffer_load_dwordx4 v2, s[4:7], s34 offen offset:2048 lds
    buffer_load_dwordx4 v2, s[4:7], s34 offen offset:3072 lds
    s_add_u32 m0, s30, 8192
    s_add_u32 s34, s31, 8192
    buffer_load_dwordx4 v2, s[4:7], s34 offen offset:0 lds
    buffer_load_dwordx4 v2, s[4:7], s34 offen offset:1024 lds
    buffer_load_dwordx4 v2, s[4:7], s34 offen offset:2048 lds
    buffer_load_dwordx4 v2, s[4:7], s34 offen offset:3072 lds
    s_add_u32 m0, s30, 12288
    s_add_u32 s34, s31, 12288
    buffer_load_dwordx4 v2, s[4:7], s34 offen offset:0 lds
    v_mov_b32 v21, -1.0
    v_mov_b32 v22, 0
    v_mov_b32 v23, -1.0
    s_lshl2_add_u32 s34, s28, s3
    s_lshl_b32 s34, s34, 11
    buffer_store_dwordx4 v[20:23], v2, s[12:15], s34 offen sc1
    buffer_store_dwordx4 v[20:23], v2, s[12:15], s34 offen offset:1024 sc1
    s_lshl_b32 s34, s34, 1
    s_lshr_b32 s35, s28, 1
    s_cmp_eq_u32 s35, 3
    s_cselect_b32 s34, 805306368, s34
    v_lshlrev_b32 v10, 6, v1
    buffer_store_dwordx4 v[24:27], v2, s[80:83], s34 offen offset:0 sc1
    buffer_store_dwordx4 v[24:27], v2, s[80:83], s34 offen offset:1024 sc1
    buffer_store_dwordx4 v[24:27], v2, s[80:83], s34 offen offset:2048 sc1
    buffer_store_dwordx4 v[24:27], v2, s[80:83], s34 offen offset:3072 sc1
    s_mov_b32 s90, 0x6c0000
    s_mov_b32 s91, 0x20000
    s_mov_b32 s22, 0x6c0000
    s_mov_b32 s23, 0x20000
    s_and_b32 s34, s84, 0
    s_lshl_b32 s34, s34, 3
    s_lshr_b32 s35, s84, 0
    s_and_b32 s95, s85, 7
    s_add_u32 s95, s95, s34
    s_lshl_b32 s94, s35, 5
    s_add_u32 s94, s94, s85
    s_lshr_b32 s94, s94, 3
    s_mul_i32 s99, s35, 27
    s_add_u32 s99, s99, s85
    s_and_b32 s98, s99, 7
    s_add_u32 s98, s98, s34
    s_lshr_b32 s99, s99, 3
    s_lshl_b32 s93, s3, 12
    v_min_u32 v251, 26, v1
    s_mul_i32 s34, s2, 216
    v_add_u32 v251, s34, v251
    s_mul_i32 s34, s3, 27
    v_add_lshl_u32 v251, v251, s34, 7
    s_and_b32 s34, s85, 1
    s_lshl_b32 s34, s34, 15
    v_lshlrev_b32 v11, 7, v0
    v_add_u32 v11, s34, v11
    v_add_u32 v10, 26112, v11
    v_min_u32 v10, 50176, v10
    global_load_dword v76, v10, s[44:45]
    v_lshrrev_b32 v11, 4, v1
    v_bfe_u32 v10, v1, 2, 2
    v_and_b32 v13, 3, v1
    v_mul_u32_u24 v16, 1280, v10
    v_lshl_add_u32 v16, v13, 3, v16
    v_lshrrev_b32 v10, 1, v11
    v_mul_u32_u24 v10, 25600, v10
    v_and_b32 v13, 1, v11
    v_mul_u32_u24 v13, 5120, v13
    v_add3_u32 v15, v16, v10, v13
    s_mul_i32 s34, s3, 320
    v_add_u32 v15, s34, v15
    s_lshl_b32 s34, s3, 2
    v_add_u32 v11, s34, v11
    v_lshl_add_u32 v16, v11, 5, v16
    v_and_b32 v10, 15, v1
    v_lshlrev_b32 v10, 4, v10
    v_add_u32 v13, 0, v11
    v_mul_u32_u24 v17, 13108, v13
    v_lshrrev_b32 v17, 16, v17
    v_mul_u32_u24 v17, 95, v17
    v_add_u32 v17, v17, v13
    v_lshl_add_u32 v17, v17, 10, v10
    v_add_u32 v13, 16, v11
    v_mul_u32_u24 v18, 13108, v13
    v_lshrrev_b32 v18, 16, v18
    v_mul_u32_u24 v18, 95, v18
    v_add_u32 v18, v18, v13
    v_lshl_add_u32 v18, v18, 10, v10
    v_add_u32 v13, 32, v11
    v_mul_u32_u24 v19, 13108, v13
    v_lshrrev_b32 v19, 16, v19
    v_mul_u32_u24 v19, 95, v19
    v_add_u32 v19, v19, v13
    v_lshl_add_u32 v19, v19, 10, v10
    s_mul_i32 s30, s3, 200
    s_mul_i32 s34, s28, 5
    s_add_u32 s30, s30, s34
    s_lshl_b32 s30, s30, 10
    s_lshr_b32 s31, s28, 2
    s_add_u32 s31, s31, 16
    s_mul_i32 s31, s31, 5120
    s_and_b32 s34, s28, 3
    s_lshl_b32 s34, s34, 8
    s_add_u32 s31, s31, s34
    s_waitcnt vmcnt(7)
    s_barrier
    ds_read_b64_tr_b16 v[24:25], v15 offset:0
    ds_read_b64_tr_b16 v[26:27], v15 offset:10240
    ds_read_b64_tr_b16 v[28:29], v15 offset:32
    ds_read_b64_tr_b16 v[30:31], v15 offset:10272
    ds_read_b64_tr_b16 v[32:33], v15 offset:64
    ds_read_b64_tr_b16 v[34:35], v15 offset:10304
    ds_read_b64_tr_b16 v[36:37], v15 offset:96
    ds_read_b64_tr_b16 v[38:39], v15 offset:10336
    ds_read_b64_tr_b16 v[40:41], v15 offset:128
    ds_read_b64_tr_b16 v[42:43], v15 offset:10368
    s_add_u32 s34, s30, 0
    s_waitcnt lgkmcnt(8)
    buffer_store_dwordx4 v[24:27], v2, s[8:11], s34 offen sc1
    s_add_u32 s34, s30, 1024
    s_waitcnt lgkmcnt(6)
    buffer_store_dwordx4 v[28:31], v2, s[8:11], s34 offen sc1
    s_add_u32 s34, s30, 2048
    s_waitcnt lgkmcnt(4)
    buffer_store_dwordx4 v[32:35], v2, s[8:11], s34 offen sc1
    s_add_u32 s34, s30, 3072
    s_waitcnt lgkmcnt(2)
    buffer_store_dwordx4 v[36:39], v2, s[8:11], s34 offen sc1
    s_add_u32 s34, s30, 4096
    s_waitcnt lgkmcnt(0)
    buffer_store_dwordx4 v[40:43], v2, s[8:11], s34 offen sc1
    ds_read_b64_tr_b16 v[44:45], v15 offset:160
    ds_read_b64_tr_b16 v[46:47], v15 offset:10400
    ds_read_b64_tr_b16 v[48:49], v15 offset:192
    ds_read_b64_tr_b16 v[50:51], v15 offset:10432
    ds_read_b64_tr_b16 v[52:53], v15 offset:224
    ds_read_b64_tr_b16 v[54:55], v15 offset:10464
    ds_read_b64_tr_b16 v[56:57], v15 offset:256
    ds_read_b64_tr_b16 v[58:59], v15 offset:10496
    ds_read_b64_tr_b16 v[60:61], v15 offset:288
    ds_read_b64_tr_b16 v[62:63], v15 offset:10528
    s_add_u32 s34, s30, 102400
    s_waitcnt lgkmcnt(8)
    buffer_store_dwordx4 v[44:47], v2, s[8:11], s34 offen sc1
    s_add_u32 s34, s30, 103424
    s_waitcnt lgkmcnt(6)
    buffer_store_dwordx4 v[48:51], v2, s[8:11], s34 offen sc1
    s_add_u32 s34, s30, 104448
    s_waitcnt lgkmcnt(4)
    buffer_store_dwordx4 v[52:55], v2, s[8:11], s34 offen sc1
    s_add_u32 s34, s30, 105472
    s_waitcnt lgkmcnt(2)
    buffer_store_dwordx4 v[56:59], v2, s[8:11], s34 offen sc1
    s_add_u32 s34, s30, 106496
    s_waitcnt lgkmcnt(0)
    buffer_store_dwordx4 v[60:63], v2, s[8:11], s34 offen sc1
    ds_read_b64_tr_b16 v[64:65], v16 offset:20480
    ds_read_b64_tr_b16 v[66:67], v16 offset:46080
    ds_read_b64_tr_b16 v[68:69], v16 offset:20992
    ds_read_b64_tr_b16 v[70:71], v16 offset:46592
    ds_read_b64_tr_b16 v[72:73], v16 offset:21504
    ds_read_b64_tr_b16 v[74:75], v16 offset:47104
    s_waitcnt lgkmcnt(4)
    buffer_store_dwordx4 v[64:67], v17, s[8:11], s31 offen sc1
    s_waitcnt lgkmcnt(2)
    buffer_store_dwordx4 v[68:71], v18, s[8:11], s31 offen sc1
    s_waitcnt lgkmcnt(0)
    buffer_store_dwordx4 v[72:75], v19, s[8:11], s31 offen sc1
    s_waitcnt vmcnt(0)
    s_barrier
    s_cmp_eq_u32 s3, 0
    s_cselect_b32 s34, 0, 805306368
    s_mov_b32 s47, 805306368
    v_mov_b32 v5, 0
    s_mov_b64 exec, 1
    buffer_atomic_add v4, off, s[24:27], s34 sc1
    s_mov_b64 exec, -1
    v_mov_b32 v12, 0x3f803f80
    v_accvgpr_write_b32 a0, v12
    v_accvgpr_write_b32 a1, v12
    v_accvgpr_write_b32 a2, v12
    v_accvgpr_write_b32 a3, v12
    v_accvgpr_write_b32 a4, v12
    v_accvgpr_write_b32 a5, v12
    v_accvgpr_write_b32 a6, v12
    v_accvgpr_write_b32 a7, v12
    v_accvgpr_write_b32 a8, v12
    v_accvgpr_write_b32 a9, v12
    v_accvgpr_write_b32 a10, v12
    v_accvgpr_write_b32 a11, v12
    v_accvgpr_write_b32 a12, v12
    v_accvgpr_write_b32 a13, v12
    v_accvgpr_write_b32 a14, v12
    v_accvgpr_write_b32 a15, v12
    v_accvgpr_write_b32 a16, v12
    v_accvgpr_write_b32 a17, v12
    v_accvgpr_write_b32 a18, v12
    v_accvgpr_write_b32 a19, v12
    v_accvgpr_write_b32 a20, v12
    v_accvgpr_write_b32 a21, v12
    v_accvgpr_write_b32 a22, v12
    v_accvgpr_write_b32 a23, v12
    v_accvgpr_write_b32 a24, v12
    v_accvgpr_write_b32 a25, v12
    v_accvgpr_write_b32 a26, v12
    v_accvgpr_write_b32 a27, v12
    v_accvgpr_write_b32 a28, v12
    v_accvgpr_write_b32 a29, v12
    v_accvgpr_write_b32 a30, v12
    v_accvgpr_write_b32 a31, v12
    v_accvgpr_write_b32 a32, v12
    v_accvgpr_write_b32 a33, v12
    v_accvgpr_write_b32 a34, v12
    v_accvgpr_write_b32 a35, v12
    v_accvgpr_write_b32 a36, v12
    v_accvgpr_write_b32 a37, v12
    v_accvgpr_write_b32 a38, v12
    v_accvgpr_write_b32 a39, v12
    v_accvgpr_write_b32 a40, v12
    v_accvgpr_write_b32 a41, v12
    v_accvgpr_write_b32 a42, v12
    v_accvgpr_write_b32 a43, v12
    v_accvgpr_write_b32 a44, v12
    v_accvgpr_write_b32 a45, v12
    v_accvgpr_write_b32 a46, v12
    v_accvgpr_write_b32 a47, v12
    v_accvgpr_write_b32 a48, v12
    v_accvgpr_write_b32 a49, v12
    v_accvgpr_write_b32 a50, v12
    v_accvgpr_write_b32 a51, v12
    v_accvgpr_write_b32 a52, v12
    v_accvgpr_write_b32 a53, v12
    v_accvgpr_write_b32 a54, v12
    v_accvgpr_write_b32 a55, v12
    v_accvgpr_write_b32 a56, v12
    v_accvgpr_write_b32 a57, v12
    v_accvgpr_write_b32 a58, v12
    v_accvgpr_write_b32 a59, v12
    v_accvgpr_write_b32 a60, v12
    v_accvgpr_write_b32 a61, v12
    v_accvgpr_write_b32 a62, v12
    v_accvgpr_write_b32 a63, v12
    v_accvgpr_write_b32 a64, v12
    v_accvgpr_write_b32 a65, v12
    v_accvgpr_write_b32 a66, v12
    v_accvgpr_write_b32 a67, v12
    v_accvgpr_write_b32 a68, v12
    v_accvgpr_write_b32 a69, v12
    v_accvgpr_write_b32 a70, v12
    v_accvgpr_write_b32 a71, v12
    v_accvgpr_write_b32 a72, v12
    v_accvgpr_write_b32 a73, v12
    v_accvgpr_write_b32 a74, v12
    v_accvgpr_write_b32 a75, v12
    v_accvgpr_write_b32 a76, v12
    v_accvgpr_write_b32 a77, v12
    v_accvgpr_write_b32 a78, v12
    v_accvgpr_write_b32 a79, v12
    v_accvgpr_write_b32 a106, 0
    v_accvgpr_write_b32 a151, 0
    v_accvgpr_write_b32 a139, 0
    v_accvgpr_write_b32 a127, 0
    v_accvgpr_write_b32 a115, 0
    v_accvgpr_write_b32 a107, 0
    v_mov_b32 v12, 0x3f80
    v_accvgpr_write_b32 a170, v12
    v_accvgpr_write_b32 a171, 0
    v_accvgpr_write_b32 a174, v12
    v_accvgpr_write_b32 a175, 0
    v_accvgpr_write_b32 a98, v12
    v_accvgpr_write_b32 a99, 0
    v_accvgpr_write_b32 a102, v12
    v_accvgpr_write_b32 a103, 0
    v_mov_b32 v12, 0xbf00bf00
    v_accvgpr_write_b32 a80, v12
    v_accvgpr_write_b32 a81, v12
    s_mov_b32 s48, 0xffffffff
    s_mov_b32 s49, 0xfffffff0
    s_mov_b32 s50, 0xfffffffe
    s_mov_b32 s51, 0xffffffe0
    s_mov_b32 s52, 0xfffffffc
    s_mov_b32 s53, 0xffffffc0
    s_mov_b32 s54, 0xfffffff8
    s_mov_b32 s55, 0xffffff80
    s_mov_b32 s56, 0xffffff00
    s_mov_b32 s57, 0xfffff000
    s_mov_b32 s58, 0xfffffe00
    s_mov_b32 s59, 0xffffe000
    s_mov_b32 s60, 0xfffffc00
    s_mov_b32 s61, 0xffffc000
    s_mov_b32 s62, 0xfffff800
    s_mov_b32 s63, 0xffff8000
    s_mov_b32 s64, 0xffff0000
    s_mov_b32 s65, 0xfff00000
    s_mov_b32 s66, 0xfffe0000
    s_mov_b32 s67, 0xffe00000
    s_mov_b32 s68, 0xfffc0000
    s_mov_b32 s69, 0xffc00000
    s_mov_b32 s70, 0xfff80000
    s_mov_b32 s71, 0xff800000
    s_mov_b32 s72, 0xff000000
    s_mov_b32 s73, 0xf0000000
    s_mov_b32 s74, 0xfe000000
    s_mov_b32 s75, 0xe0000000
    s_mov_b32 s76, 0xfc000000
    s_mov_b32 s77, 0xc0000000
    s_mov_b32 s78, 0xf8000000
    s_mov_b32 s79, 0x80000000
    s_movk_i32 s100, 0
    buffer_load_dword v250, v251, s[88:91], s100 offen
    s_movk_i32 s100, 13824
    buffer_load_dword v250, v251, s[88:91], s100 offen
    s_lshr_b32 s34, s28, 2
    s_mul_i32 s34, s34, 224
    s_and_b32 s35, s28, 3
    s_lshl2_add_u32 s35, s35, s3
    s_add_u32 s34, s34, s35
    s_lshl_b32 s34, s34, 13
    v_lshl_add_u32 v10, v1, 7, s34
    buffer_load_dword v250, v10, s[20:23], 0 offen
    v_add_u32 v10, 131072, v10
    buffer_load_dword v250, v10, s[20:23], 0 offen
    v_add_u32 v10, 131072, v10
A_done:
    s_nop 1
    s_mov_b32 s4, s36
    s_mov_b32 s5, s37
    s_mov_b32 s6, 0x280000
    s_mov_b32 s7, 0x20000
    s_add_u32 s8, s86, 0x800000
    s_addc_u32 s9, s87, 0
    s_mov_b32 s10, 0x280000
    s_mov_b32 s11, 0x20000
    s_mov_b32 s12, s86
    s_mov_b32 s13, s87
    s_mov_b32 s14, 0x780000
    s_mov_b32 s15, 0x20000
    s_add_u32 s16, s86, 0x1100000
    s_addc_u32 s17, s87, 0
    s_mov_b32 s18, 0xc8000
    s_mov_b32 s19, 0x20000
    s_and_b32 s28, s85, 3
    s_lshl2_add_u32 s28, s84, s28
    s_lshr_b32 s30, s85, 2
    s_lshr_b32 s40, s3, 1
    s_lshl1_add_u32 s40, s30, s40
    s_lshl1_add_u32 s35, s30, s3
    s_sub_u32 s35, s35, 2
    s_cselect_b32 s29, s40, s35
    s_cselect_b32 s44, 805306368, 0
    s_cselect_b32 s35, 0, s35
    v_and_b32 v230, 1, v1
    v_mul_u32_u24 v230, 19, v230
    s_mul_i32 s33, s28, 20
    v_add_u32 v230, s33, v230
    v_and_b32 v230, 0x380, v230
    v_lshrrev_b32 v231, 1, v1
    v_mul_u32_u24 v231, 640, v231
    s_lshl_b32 s29, s29, 11
    s_lshl_b32 s40, s40, 11
    v_mov_b32 v232, s29
    v_writelane_b32 v232, s40, 0
    v_writelane_b32 v232, s40, 1
    v_add3_u32 v235, v230, v231, v232
    s_mul_i32 s31, s28, 245760
    s_add_u32 s44, s44, s31
    s_mul_i32 s38, s35, 5120
    s_add_u32 s38, s38, s44
    s_add_u32 s38, s38, 131072
    s_lshl_b32 s39, s35, 10
    s_lshl2_add_u32 s35, s39, s44
    s_add_u32 s35, s35, 65536
    s_add_u32 s39, s39, s44
    s_add_u32 s39, s39, 229376
    s_lshl2_add_u32 s29, s30, s3
    s_lshl_b32 s41, s29, 9
    s_lshl2_add_u32 s40, s41, s31
    s_add_u32 s41, s41, s31
    s_add_u32 s41, s41, 212992
    v_lshrrev_b32 v230, 5, v1
    v_and_b32 v231, 31, v1
    v_lshlrev_b32 v233, 30, v230
    v_lshl_add_u32 v233, v231, 3, v233
    v_xor_b32 v234, 0x40000000, v233
    s_lshl_b32 s33, s3, 11
    v_add_u32 v10, s33, v2
    s_lshl_b32 s33, s3, 9
    s_add_u32 s33, s33, 36864
    v_lshl_add_u32 v11, v1, 3, s33
    s_mul_i32 s33, s3, 2560
    s_add_u32 s33, s33, 16384
    v_mul_u32_u24 v12, 320, v230
    v_lshl_add_u32 v12, v231, 4, v12
    v_add_u32 v12, s33, v12
    v_add_u32 v232, 0, v1
    v_mul_u32_u24 v232, 5462, v232
    v_lshrrev_b32 v232, 16, v232
    v_mul_u32_u24 v232, 1088, v232
    v_add_u32 v236, v2, v232
    v_add_u32 v232, 64, v1
    v_mul_u32_u24 v232, 5462, v232
    v_lshrrev_b32 v232, 16, v232
    v_mul_u32_u24 v232, 1088, v232
    v_add_u32 v237, v2, v232
    v_add_u32 v232, 128, v1
    v_mul_u32_u24 v232, 5462, v232
    v_lshrrev_b32 v232, 16, v232
    v_mul_u32_u24 v232, 1088, v232
    v_add_u32 v238, v2, v232
    s_mul_i32 s43, s95, 160
    s_andn2_b32 s43, s43, 32
    s_lshl2_add_u32 s33, s94, s3
    s_mul_i32 s33, s33, 20480
    s_add_u32 s43, s43, s33
    s_mul_i32 s42, s95, 102400
    s_add_u32 s42, s42, s93
    s_cmp_ge_u32 s29, 4
    s_cselect_b32 s33, 0, 0xf149
    v_accvgpr_write_b32 a150, s33
    s_cmp_ge_u32 s29, 3
    s_cselect_b32 s33, 0, 0xf149
    v_accvgpr_write_b32 a138, s33
    s_cmp_ge_u32 s29, 2
    s_cselect_b32 s33, 0, 0xf149
    v_accvgpr_write_b32 a126, s33
    s_cmp_ge_u32 s29, 1
    s_cselect_b32 s33, 0, 0xf149
    v_accvgpr_write_b32 a114, s33
    s_waitcnt vmcnt(0)
    v_cmp_gt_u32 vcc, 16, v5
    s_cbranch_vccz B_ready
    s_mov_b32 s46, 0x40000
B_ask:
    buffer_load_dword v5, off, s[24:27], 0 sc1
    s_sub_u32 s46, s46, 1
    s_waitcnt vmcnt(0)
    v_cmp_gt_u32 vcc, 16, v5
    s_cbranch_scc1 B_ready
    s_cbranch_vccnz B_ask
B_ready:
    s_barrier
    s_mov_b64 exec, 1
    buffer_store_dword v4, off, s[80:83], s47 sc1
    s_mov_b64 exec, -1
    s_mul_i32 s46, s3, 3072
    s_add_u32 m0, s46, 49152
    s_nop 0
    buffer_load_dwordx4 v236, s[4:7], s43 offen offset:0 lds
    buffer_load_dwordx4 v237, s[4:7], s43 offen offset:1024 lds
    buffer_load_dwordx4 v238, s[4:7], s43 offen offset:2048 lds
    s_add_u32 m0, s93, 61440
    s_nop 0
    buffer_load_dwordx4 v2, s[16:19], s42 offen offset:0 sc1 lds
    buffer_load_dwordx4 v2, s[16:19], s42 offen offset:1024 sc1 lds
    buffer_load_dwordx4 v2, s[16:19], s42 offen offset:2048 sc1 lds
    buffer_load_dwordx4 v2, s[16:19], s42 offen offset:3072 sc1 lds
    s_add_u32 s42, s42, 16384
    s_add_u32 m0, s93, 77824
    s_nop 0
    buffer_load_dwordx4 v2, s[16:19], s42 offen offset:0 sc1 lds
    buffer_load_dwordx4 v2, s[16:19], s42 offen offset:1024 sc1 lds
    buffer_load_dwordx4 v2, s[16:19], s42 offen offset:2048 sc1 lds
    buffer_load_dwordx4 v2, s[16:19], s42 offen offset:3072 sc1 lds
    s_add_u32 s42, s42, 16384
    v_mov_b32 v232, 0xffff
    v_mov_b32 v23, 0xffff0000
    v_cndmask_b32 v15, 0, v232, s[48:49]
    v_cndmask_b32 v13, 0, v23, s[50:51]
    v_or_b32 v15, v15, v13
    v_cndmask_b32 v16, 0, v232, s[52:53]
    v_cndmask_b32 v13, 0, v23, s[54:55]
    v_or_b32 v16, v16, v13
    v_cndmask_b32 v17, 0, v232, s[56:57]
    v_cndmask_b32 v13, 0, v23, s[58:59]
    v_or_b32 v17, v17, v13
    v_cndmask_b32 v18, 0, v232, s[60:61]
    v_cndmask_b32 v13, 0, v23, s[62:63]
    v_or_b32 v18, v18, v13
    v_cndmask_b32 v19, 0, v232, s[64:65]
    v_cndmask_b32 v13, 0, v23, s[66:67]
    v_or_b32 v19, v19, v13
    v_cndmask_b32 v20, 0, v232, s[68:69]
    v_cndmask_b32 v13, 0, v23, s[70:71]
    v_or_b32 v20, v20, v13
    v_cndmask_b32 v21, 0, v232, s[72:73]
    v_cndmask_b32 v13, 0, v23, s[74:75]
    v_or_b32 v21, v21, v13
    v_cndmask_b32 v22, 0, v232, s[76:77]
    v_cndmask_b32 v13, 0, v23, s[78:79]
    v_or_b32 v22, v22, v13
    v_bfe_u32 v13, v1, 4, 1
    v_mul_u32_u24 v13, 20480, v13
    v_and_b32 v231, 15, v1
    v_lshl_add_u32 v14, v231, 3, v13
    v_lshl_add_u32 v13, v231, 4, v13
    v_lshl_add_u32 v14, v230, 30, v14
    v_lshl_add_u32 v13, v230, 8, v13
    s_mul_i32 s31, s29, 81920
    s_lshr_b32 s33, s28, 1
    s_lshl_b32 s33, s33, 8
    s_and_b32 s34, s28, 1
    s_lshl_b32 s34, s34, 7
    s_add_u32 s33, s34, s33
    s_add_u32 s33, s33, s31
    s_add_u32 s33, s33, 16384
    s_add_u32 s34, s33, 40960
    s_lshl_b32 s32, s28, 9
    s_add_u32 s31, s31, s32
    s_add_u32 s32, s31, 40960
    s_lshl_b32 s47, s29, 5
    s_add_u32 s47, s47, s28
    s_add_u32 s47, s47, 1024
    s_lshl_b32 s47, s47, 7
    s_mov_b32 s44, 0xfffff
    s_mov_b32 s45, 0xfffff
    v_lshrrev_b32 v230, 3, v1
    v_mul_u32_u24 v230, 3456, v230
    v_lshrrev_b32 v231, 4, v1
    v_lshlrev_b32 v232, 1, v231
    v_xor_b32 v232, v232, v1
    v_and_b32 v232, 7, v232
    v_lshl_add_u32 v6, v232, 4, v230
    s_mul_i32 s30, s3, 1769472
    v_add_u32 v6, s30, v6
    s_lshl_b32 s30, s99, 7
    v_add_u32 v6, s30, v6
    v_add_u32 v7, 26624, v6
    v_add_u32 v8, 53248, v6
    v_add_u32 v9, 79872, v6
    s_mul_i32 s30, s99, 0
    s_bfe_u32 s30, s30, 0x40004
    s_mul_i32 s92, s30, 110592
    s_cmp_ge_u32 s85, 27
    s_cselect_b32 s90, 0, s90
    v_bfe_u32 v230, v1, 2, 3
    v_lshrrev_b32 v232, 5, v1
    v_lshl_add_u32 v232, v232, 4, v230
    v_lshlrev_b32 v232, 7, v232
    v_lshrrev_b32 v230, 1, v230
    v_xor_b32 v230, s3, v230
    v_lshl_add_u32 v232, v230, 5, v232
    v_and_b32 v230, 3, v1
    v_lshl_add_u32 v232, v230, 3, v232
    v_add_u32 v252, s93, v232
    v_xor_b32 v253, 32, v252
    v_xor_b32 v254, 64, v252
    v_xor_b32 v255, 96, v252
    s_mov_b32 exec_lo, 63
    s_mov_b32 exec_hi, 0
    s_mov_b32 s46, 0x40000
poll0:
    buffer_load_dword v5, v235, s[80:83], 0 offen sc1
    s_sub_u32 s46, s46, 1
    s_waitcnt vmcnt(0)
    v_cmp_ne_u32 vcc, v4, v5
    s_cbranch_scc1 pollx0
    s_cbranch_vccnz poll0
pollx0:
    s_mov_b64 exec, -1
    s_mov_b32 m0, s93
    s_nop 0
    buffer_load_dwordx4 v2, s[12:15], s35 offen offset:0 sc1 lds
    buffer_load_dwordx4 v2, s[12:15], s35 offen offset:1024 sc1 lds
    buffer_load_dwordx4 v2, s[12:15], s35 offen offset:2048 sc1 lds
    buffer_load_dwordx4 v2, s[12:15], s35 offen offset:3072 sc1 lds
    s_lshl_b32 s46, s3, 10
    s_add_u32 m0, s46, 36864
    s_nop 0
    buffer_load_dwordx4 v2, s[12:15], s39 offen sc1 lds
    buffer_load_dwordx4 a[164:167], v2, s[12:15], s40 offen offset:0 sc1
    buffer_load_dwordx2 a[168:169], v233, s[12:15], s41 offen offset:0 sc1
    buffer_load_dwordx2 a[172:173], v234, s[12:15], s41 offen offset:0 sc1
    s_mul_i32 s46, s3, 5120
    s_add_u32 m0, s46, 16384
    s_nop 0
    buffer_load_dwordx4 v2, s[12:15], s38 offen offset:0 sc1 lds
    buffer_load_dwordx4 v2, s[12:15], s38 offen offset:1024 sc1 lds
    buffer_load_dwordx4 v2, s[12:15], s38 offen offset:2048 sc1 lds
    buffer_load_dwordx4 v2, s[12:15], s38 offen offset:3072 sc1 lds
    s_add_u32 m0, s46, 20480
    s_add_u32 s38, s38, 4096
    buffer_load_dwordx4 v2, s[12:15], s38 offen sc1 lds
    buffer_load_dwordx4 a[92:95], v2, s[12:15], s40 offen offset:1024 sc1
    buffer_load_dwordx2 a[96:97], v233, s[12:15], s41 offen offset:256 sc1
    buffer_load_dwordx2 a[100:101], v234, s[12:15], s41 offen offset:256 sc1
    s_waitcnt vmcnt(11)
    s_barrier
    ds_read_b128 a[108:111], v10 offset:8192
    ds_read_b64 a[104:105], v11 offset:2048
    ds_read_b128 a[160:163], v10 offset:0
    ds_read_b64 a[148:149], v11 offset:0
    ds_read_b128 a[152:155], v10 offset:1024
    ds_read_b128 a[144:147], v10 offset:2048
    ds_read_b64 a[136:137], v11 offset:512
    ds_read_b128 a[140:143], v10 offset:3072
    ds_read_b128 a[132:135], v10 offset:4096
    ds_read_b64 a[124:125], v11 offset:1024
    ds_read_b128 a[128:131], v10 offset:5120
    ds_read_b128 a[120:123], v10 offset:6144
    ds_read_b64 a[112:113], v11 offset:1536
    ds_read_b128 a[116:119], v10 offset:7168
    ds_read_b128 a[156:159], v10 offset:9216
    s_waitcnt vmcnt(10) lgkmcnt(14)
    v_mfma_f32_32x32x16_bf16 v[74:89], a[108:111], a[164:167], 0
    s_waitcnt vmcnt(9) lgkmcnt(13)
    v_mfma_f32_32x32x16_bf16 v[74:89], a[104:107], a[168:171], v[74:89]
    s_waitcnt lgkmcnt(12)
    v_mfma_f32_32x32x16_bf16 v[90:105], a[160:163], a[164:167], 0
    s_waitcnt lgkmcnt(11)
    v_mfma_f32_32x32x16_bf16 v[90:105], a[148:151], a[168:171], v[90:105]
    s_waitcnt lgkmcnt(10)
    v_mfma_f32_32x32x16_bf16 v[106:121], a[152:155], a[164:167], 0
    s_waitcnt vmcnt(8)
    v_mfma_f32_32x32x16_bf16 v[106:121], a[148:151], a[172:175], v[106:121]
    s_waitcnt lgkmcnt(9)
    v_mfma_f32_32x32x16_bf16 v[122:137], a[144:147], a[164:167], 0
    s_nop 5
    v_cndmask_b32 v74, v90, v74, s[48:49]
    v_cndmask_b32 v75, v91, v75, s[50:51]
    v_cndmask_b32 v76, v92, v76, s[52:53]
    v_cndmask_b32 v77, v93, v77, s[54:55]
    s_waitcnt lgkmcnt(8)
    v_mfma_f32_32x32x16_bf16 v[122:137], a[136:139], a[168:171], v[122:137]
    v_cndmask_b32 v78, v94, v78, s[56:57]
    v_cndmask_b32 v79, v95, v79, s[58:59]
    v_cndmask_b32 v80, v96, v80, s[60:61]
    v_cndmask_b32 v81, v97, v81, s[62:63]
    v_cndmask_b32 v82, v98, v82, s[64:65]
    s_waitcnt lgkmcnt(7)
    v_mfma_f32_32x32x16_bf16 v[138:153], a[140:143], a[164:167], 0
    v_cndmask_b32 v83, v99, v83, s[66:67]
    v_cndmask_b32 v84, v100, v84, s[68:69]
    v_cndmask_b32 v85, v101, v85, s[70:71]
    v_cndmask_b32 v86, v102, v86, s[72:73]
    v_cndmask_b32 v87, v103, v87, s[74:75]
    v_mfma_f32_32x32x16_bf16 v[138:153], a[136:139], a[172:175], v[138:153]
    v_cndmask_b32 v88, v104, v88, s[76:77]
    v_cndmask_b32 v89, v105, v89, s[78:79]
    v_max_f32 v24, v74, v75
    v_max_f32 v25, v76, v77
    v_max3_f32 v24, v24, v78, v79
    s_waitcnt lgkmcnt(6)
    v_mfma_f32_32x32x16_bf16 v[154:169], a[132:135], a[164:167], 0
    s_waitcnt vmcnt(3)
    s_barrier
    s_mov_b64 exec, s[44:45]
    ds_read_b128 a[8:11], v12 offset:1280
    ds_read_b128 a[12:15], v12 offset:1920
    ds_read_b128 a[16:19], v12 offset:2560
    ds_read_b128 a[20:23], v12 offset:3200
    s_mov_b64 exec, -1
    s_waitcnt lgkmcnt(9)
    v_mfma_f32_32x32x16_bf16 v[154:169], a[124:127], a[168:171], v[154:169]
    v_max3_f32 v25, v25, v80, v81
    v_max3_f32 v24, v24, v82, v83
    v_max3_f32 v25, v25, v84, v85
    v_max3_f32 v24, v24, v86, v87
    v_max3_f32 v25, v25, v88, v89
    s_waitcnt lgkmcnt(8)
    v_mfma_f32_32x32x16_bf16 v[170:185], a[128:131], a[164:167], 0
    s_mov_b64 exec, s[44:45]
    ds_read_b128 a[24:27], v12 offset:3840
    ds_read_b128 a[28:31], v12 offset:4480
    ds_read_b128 a[32:35], v12 offset:5120
    ds_read_b128 a[36:39], v12 offset:5760
    s_mov_b64 exec, -1
    v_mfma_f32_32x32x16_bf16 v[170:185], a[124:127], a[172:175], v[170:185]
    v_max3_f32 v24, v24, v106, v107
    v_max3_f32 v25, v25, v108, v109
    v_max3_f32 v24, v24, v110, v111
    v_max3_f32 v25, v25, v112, v113
    v_max3_f32 v24, v24, v114, v115
    s_waitcnt lgkmcnt(11)
    v_mfma_f32_32x32x16_bf16 v[186:201], a[120:123], a[164:167], 0
    v_max3_f32 v25, v25, v116, v117
    s_mov_b64 exec, s[44:45]
    ds_read_b128 a[40:43], v12 offset:6400
    ds_read_b128 a[44:47], v12 offset:7040
    ds_read_b128 a[48:51], v12 offset:7680
    ds_read_b128 a[52:55], v12 offset:8320
    s_mov_b64 exec, -1
    s_waitcnt lgkmcnt(14)
    v_mfma_f32_32x32x16_bf16 v[186:201], a[112:115], a[168:171], v[186:201]
    v_max3_f32 v24, v24, v118, v119
    v_max3_f32 v25, v25, v120, v121
    v_max3_f32 v24, v24, v122, v123
    v_max3_f32 v25, v25, v124, v125
    v_max3_f32 v24, v24, v126, v127
    s_waitcnt lgkmcnt(13)
    v_mfma_f32_32x32x16_bf16 v[202:217], a[116:119], a[164:167], 0
    v_max3_f32 v25, v25, v128, v129
    s_mov_b64 exec, s[44:45]
    ds_read_b128 a[56:59], v12 offset:8960
    ds_read_b128 a[60:63], v12 offset:9600
    ds_read_b128 a[0:3], v12 offset:0
    ds_read_b128 a[4:7], v12 offset:640
    s_mov_b64 exec, -1
    v_mfma_f32_32x32x16_bf16 v[202:217], a[112:115], a[172:175], v[202:217]
    v_max3_f32 v24, v24, v130, v131
    v_max3_f32 v25, v25, v132, v133
    v_max3_f32 v24, v24, v134, v135
    v_max3_f32 v25, v25, v136, v137
    v_max3_f32 v24, v24, v138, v139
    s_waitcnt vmcnt(2) lgkmcnt(15)
    v_mfma_f32_32x32x16_bf16 v[218:233], a[156:159], a[92:95], 0
    v_max3_f32 v25, v25, v140, v141
    v_max3_f32 v24, v24, v142, v143
    s_mov_b64 exec, s[44:45]
    ds_read_b128 a[64:67], v12 offset:10240
    ds_read_b128 a[68:71], v12 offset:10880
    ds_read_b128 a[72:75], v12 offset:11520
    ds_read_b128 a[76:79], v12 offset:12160
    s_mov_b64 exec, -1
    s_waitcnt vmcnt(0)
    v_mfma_f32_32x32x16_bf16 v[218:233], a[104:107], a[100:103], v[218:233]
    s_add_u32 m0, s93, 94208
    s_nop 0
    buffer_load_dwordx4 v2, s[16:19], s42 offen offset:0 sc1 lds
    buffer_load_dwordx4 v2, s[16:19], s42 offen offset:1024 sc1 lds
    buffer_load_dwordx4 v2, s[16:19], s42 offen offset:2048 sc1 lds
    buffer_load_dwordx4 v2, s[16:19], s42 offen offset:3072 sc1 lds
    s_add_u32 s42, s42, 16384
    v_mfma_f32_32x32x16_bf16 v[234:249], a[152:155], a[92:95], 0
    v_max3_f32 v25, v25, v144, v145
    v_max3_f32 v24, v24, v146, v147
    v_max3_f32 v25, v25, v148, v149
    v_max3_f32 v24, v24, v150, v151
    v_max3_f32 v25, v25, v152, v153
    v_mfma_f32_32x32x16_bf16 v[234:249], a[148:151], a[100:103], v[234:249]
    s_waitcnt lgkmcnt(0)
    s_barrier
    s_add_u32 m0, s93, 0
    s_nop 0
    buffer_load_dwordx4 v6, s[88:91], s92 offen offset:0 lds
    buffer_load_dwordx4 v7, s[88:91], s92 offen offset:1024 lds
    buffer_load_dwordx4 v8, s[88:91], s92 offen offset:2048 lds
    buffer_load_dwordx4 v9, s[88:91], s92 offen offset:3072 lds
    s_add_u32 s92, s92, 110592
    s_cmp_eq_u32 s92, 1769472
    s_cselect_b32 s92, 0, s92
    v_mfma_f32_32x32x16_bf16 v[90:105], a[144:147], a[92:95], 0
    v_max3_f32 v24, v24, v154, v155
    v_max3_f32 v25, v25, v156, v157
    v_max3_f32 v24, v24, v158, v159
    v_max3_f32 v25, v25, v160, v161
    v_max3_f32 v24, v24, v162, v163
    v_mfma_f32_32x32x16_bf16 v[90:105], a[136:139], a[96:99], v[90:105]
    v_max3_f32 v25, v25, v164, v165
    v_max3_f32 v24, v24, v166, v167
    v_max3_f32 v25, v25, v168, v169
    v_max3_f32 v24, v24, v170, v171
    v_max3_f32 v25, v25, v172, v173
    v_max3_f32 v24, v24, v174, v175
    v_max3_f32 v25, v25, v176, v177
    v_max3_f32 v24, v24, v178, v179
    v_max3_f32 v25, v25, v180, v181
    v_max3_f32 v24, v24, v182, v183
    v_max3_f32 v25, v25, v184, v185
    v_max3_f32 v24, v24, v186, v187
    v_max3_f32 v25, v25, v188, v189
    v_max3_f32 v24, v24, v190, v191
    v_max3_f32 v25, v25, v192, v193
    v_max3_f32 v24, v24, v194, v195
    v_max3_f32 v25, v25, v196, v197
    v_max3_f32 v24, v24, v198, v199
    v_max3_f32 v25, v25, v200, v201
    v_max3_f32 v24, v24, v202, v203
    v_max3_f32 v25, v25, v204, v205
    v_max3_f32 v24, v24, v206, v207
    v_max3_f32 v25, v25, v208, v209
    v_max3_f32 v24, v24, v210, v211
    v_max3_f32 v25, v25, v212, v213
    v_max3_f32 v24, v24, v214, v215
    v_max3_f32 v25, v25, v216, v217
    v_cndmask_b32 v218, v234, v218, s[48:49]
    v_max_f32 v24, v24, v25
    v_cndmask_b32 v219, v235, v219, s[50:51]
    v_mov_b32 v25, v24
    v_cndmask_b32 v220, v236, v220, s[52:53]
    s_add_u32 m0, s93, 16384
    s_nop 0
    buffer_load_dwordx4 v6, s[88:91], s92 offen offset:0 lds
    buffer_load_dwordx4 v7, s[88:91], s92 offen offset:1024 lds
    buffer_load_dwordx4 v8, s[88:91], s92 offen offset:2048 lds
    buffer_load_dwordx4 v9, s[88:91], s92 offen offset:3072 lds
    s_add_u32 s92, s92, 110592
    s_cmp_eq_u32 s92, 1769472
    s_cselect_b32 s92, 0, s92
    v_permlane32_swap_b32 v24, v25
    v_cndmask_b32 v221, v237, v221, s[54:55]
    v_max_f32 v24, v24, v25
    v_cndmask_b32 v222, v238, v222, s[56:57]
    v_and_b32 v28, v23, v24
    v_cndmask_b32 v223, v239, v223, s[58:59]
    v_sub_f32 v24, v24, v28
    v_cndmask_b32 v224, v240, v224, s[60:61]
    v_and_b32 v25, v23, v24
    v_cndmask_b32 v225, v241, v225, s[62:63]
    v_sub_f32 v24, v24, v25
    v_cvt_pk_bf16_f32 v28, v28, v25
    v_cvt_pk_bf16_f32 v29, v24, 0
    v_cndmask_b32 v226, v242, v226, s[64:65]
    v_cndmask_b32 v227, v243, v227, s[66:67]
    v_mfma_f32_32x32x8_bf16 v[106:121], a[80:81], v[28:29], v[106:121]
    v_cndmask_b32 v228, v244, v228, s[68:69]
    v_cndmask_b32 v229, v245, v229, s[70:71]
    v_cndmask_b32 v230, v246, v230, s[72:73]
    v_cndmask_b32 v231, v247, v231, s[74:75]
    v_cndmask_b32 v232, v248, v232, s[76:77]
    v_mfma_f32_32x32x8_bf16 v[122:137], a[80:81], v[28:29], v[122:137]
    v_cndmask_b32 v233, v249, v233, s[78:79]
    v_max_f32 v26, v218, v219
    v_max_f32 v27, v220, v221
    v_max3_f32 v26, v26, v222, v223
    v_max3_f32 v27, v27, v224, v225
    v_mfma_f32_32x32x8_bf16 v[138:153], a[80:81], v[28:29], v[138:153]
    v_max3_f32 v26, v26, v226, v227
    v_max3_f32 v27, v27, v228, v229
    v_max3_f32 v26, v26, v230, v231
    v_max3_f32 v27, v27, v232, v233
    v_max3_f32 v26, v26, v90, v91
    v_mfma_f32_32x32x8_bf16 v[154:169], a[80:81], v[28:29], v[154:169]
    v_max3_f32 v27, v27, v92, v93
    v_max3_f32 v26, v26, v94, v95
    v_max3_f32 v27, v27, v96, v97
    v_max3_f32 v26, v26, v98, v99
    v_max3_f32 v27, v27, v100, v101
    v_mfma_f32_32x32x8_bf16 v[170:185], a[80:81], v[28:29], v[170:185]
    s_add_u32 m0, s93, 32768
    s_nop 0
    buffer_load_dwordx4 v6, s[88:91], s92 offen offset:0 lds
    buffer_load_dwordx4 v7, s[88:91], s92 offen offset:1024 lds
    buffer_load_dwordx4 v8, s[88:91], s92 offen offset:2048 lds
    buffer_load_dwordx4 v9, s[88:91], s92 offen offset:3072 lds
    s_add_u32 s92, s92, 110592
    s_cmp_eq_u32 s92, 1769472
    s_cselect_b32 s92, 0, s92
    v_mfma_f32_32x32x8_bf16 v[186:201], a[80:81], v[28:29], v[186:201]
    v_max3_f32 v26, v26, v102, v103
    v_max3_f32 v27, v27, v104, v105
    v_exp_f32 v106, v106
    v_exp_f32 v107, v107
    v_mfma_f32_32x32x8_bf16 v[202:217], a[80:81], v[28:29], v[202:217]
    v_cvt_pk_bf16_f32 v34, v106, v107
    v_exp_f32 v108, v108
    v_exp_f32 v109, v109
    v_exp_f32 v110, v110
    v_mfma_f32_32x32x8_bf16 v[74:89], a[80:81], v[28:29], v[74:89]
    v_cvt_pk_bf16_f32 v35, v108, v109
    v_exp_f32 v111, v111
    v_exp_f32 v112, v112
    v_cvt_pk_bf16_f32 v36, v110, v111
    v_mfma_f32_32x32x16_bf16 v[234:249], a[140:143], a[92:95], 0
    v_exp_f32 v113, v113
    v_exp_f32 v114, v114
    v_cvt_pk_bf16_f32 v37, v112, v113
    v_exp_f32 v115, v115
    v_mfma_f32_32x32x16_bf16 v[234:249], a[136:139], a[100:103], v[234:249]
    v_cvt_pk_bf16_f32 v38, v114, v115
    v_exp_f32 v116, v116
    v_exp_f32 v117, v117
    v_exp_f32 v118, v118
    v_mfma_f32_32x32x16_bf16 v[58:73], a[8:11], v[34:37], 0
    s_add_u32 m0, s93, 110592
    s_nop 0
    buffer_load_dwordx4 v2, s[16:19], s42 offen offset:0 sc1 lds
    buffer_load_dwordx4 v2, s[16:19], s42 offen offset:1024 sc1 lds
    buffer_load_dwordx4 v2, s[16:19], s42 offen offset:2048 sc1 lds
    buffer_load_dwordx4 v2, s[16:19], s42 offen offset:3072 sc1 lds
    s_add_u32 s42, s42, 16384
    v_cvt_pk_bf16_f32 v39, v116, v117
    v_exp_f32 v119, v119
    v_exp_f32 v120, v120
    v_cvt_pk_bf16_f32 v40, v118, v119
    v_exp_f32 v121, v121
    v_exp_f32 v122, v122
    v_max3_f32 v26, v26, v234, v235
    v_max3_f32 v27, v27, v236, v237
    v_max3_f32 v26, v26, v238, v239
    v_max3_f32 v27, v27, v240, v241
    v_max3_f32 v26, v26, v242, v243
    v_max3_f32 v27, v27, v244, v245
    v_max3_f32 v26, v26, v246, v247
    v_max3_f32 v27, v27, v248, v249
    v_cvt_pk_bf16_f32 v41, v120, v121
    v_mfma_f32_32x32x16_bf16 v[106:121], a[132:135], a[92:95], 0
    v_exp_f32 v123, v123
    v_exp_f32 v124, v124
    v_cvt_pk_bf16_f32 v42, v122, v123
    v_exp_f32 v125, v125
    v_mfma_f32_32x32x16_bf16 v[58:73], a[12:15], v[38:41], v[58:73]
    v_cvt_pk_bf16_f32 v43, v124, v125
    v_exp_f32 v126, v126
    v_exp_f32 v127, v127
    v_exp_f32 v128, v128
    v_mfma_f32_32x32x16_bf16 v[106:121], a[124:127], a[96:99], v[106:121]
    v_cvt_pk_bf16_f32 v44, v126, v127
    v_exp_f32 v129, v129
    v_exp_f32 v130, v130
    v_cvt_pk_bf16_f32 v45, v128, v129
    v_exp_f32 v131, v131
    v_exp_f32 v132, v132
    v_mfma_f32_32x32x16_bf16 v[58:73], a[16:19], v[42:45], v[58:73]
    s_add_u32 m0, s93, 126976
    s_nop 0
    buffer_load_dwordx4 v2, s[16:19], s42 offen offset:0 sc1 lds
    buffer_load_dwordx4 v2, s[16:19], s42 offen offset:1024 sc1 lds
    buffer_load_dwordx4 v2, s[16:19], s42 offen offset:2048 sc1 lds
    buffer_load_dwordx4 v2, s[16:19], s42 offen offset:3072 sc1 lds
    s_add_u32 s42, s42, 16384
    v_cvt_pk_bf16_f32 v46, v130, v131
    v_exp_f32 v133, v133
    v_exp_f32 v134, v134
    v_cvt_pk_bf16_f32 v47, v132, v133
    v_max3_f32 v26, v26, v106, v107
    v_max3_f32 v27, v27, v108, v109
    v_max3_f32 v26, v26, v110, v111
    v_max3_f32 v27, v27, v112, v113
    v_max3_f32 v26, v26, v114, v115
    v_max3_f32 v27, v27, v116, v117
    v_max3_f32 v26, v26, v118, v119
    v_max3_f32 v27, v27, v120, v121
    v_exp_f32 v135, v135
    v_exp_f32 v136, v136
    v_cvt_pk_bf16_f32 v48, v134, v135
    v_exp_f32 v137, v137
    v_exp_f32 v138, v138
    v_cvt_pk_bf16_f32 v49, v136, v137
    v_mfma_f32_32x32x16_bf16 v[122:137], a[128:131], a[92:95], 0
    v_exp_f32 v139, v139
    v_exp_f32 v140, v140
    v_cvt_pk_bf16_f32 v50, v138, v139
    v_exp_f32 v141, v141
    v_mfma_f32_32x32x16_bf16 v[58:73], a[20:23], v[46:49], v[58:73]
    v_cvt_pk_bf16_f32 v51, v140, v141
    v_exp_f32 v142, v142
    v_exp_f32 v143, v143
    v_exp_f32 v144, v144
    v_mfma_f32_32x32x16_bf16 v[122:137], a[124:127], a[100:103], v[122:137]
    v_cvt_pk_bf16_f32 v52, v142, v143
    v_exp_f32 v145, v145
    s_add_u32 m0, s93, 143360
    s_nop 0
    buffer_load_dwordx4 v2, s[16:19], s42 offen offset:0 sc1 lds
    buffer_load_dwordx4 v2, s[16:19], s42 offen offset:1024 sc1 lds
    buffer_load_dwordx4 v2, s[16:19], s42 offen offset:2048 sc1 lds
    buffer_load_dwordx4 v2, s[16:19], s42 offen offset:3072 sc1 lds
    s_add_u32 s42, s42, 16384
    v_cvt_pk_bf16_f32 v53, v144, v145
    v_exp_f32 v146, v146
    v_exp_f32 v147, v147
    v_mfma_f32_32x32x16_bf16 v[58:73], a[24:27], v[50:53], v[58:73]
    v_cvt_pk_bf16_f32 v54, v146, v147
    v_exp_f32 v148, v148
    v_exp_f32 v149, v149
    v_exp_f32 v150, v150
    v_cvt_pk_bf16_f32 v55, v148, v149
    v_max3_f32 v26, v26, v122, v123
    v_max3_f32 v27, v27, v124, v125
    v_max3_f32 v26, v26, v126, v127
    v_max3_f32 v27, v27, v128, v129
    v_max3_f32 v26, v26, v130, v131
    v_max3_f32 v27, v27, v132, v133
    v_max3_f32 v26, v26, v134, v135
    v_max3_f32 v27, v27, v136, v137
    v_exp_f32 v151, v151
    v_exp_f32 v152, v152
    v_cvt_pk_bf16_f32 v56, v150, v151
    v_exp_f32 v153, v153
    v_exp_f32 v154, v154
    v_cvt_pk_bf16_f32 v57, v152, v153
    v_mfma_f32_32x32x16_bf16 v[138:153], a[120:123], a[92:95], 0
    v_exp_f32 v155, v155
    v_exp_f32 v156, v156
    v_cvt_pk_bf16_f32 v34, v154, v155
    v_exp_f32 v157, v157
    v_mfma_f32_32x32x16_bf16 v[58:73], a[28:31], v[54:57], v[58:73]
    v_cvt_pk_bf16_f32 v35, v156, v157
    v_exp_f32 v158, v158
    s_waitcnt vmcnt(20)
    ds_read_b64_tr_b16 a[240:241], v252 offset:0
    ds_read_b64_tr_b16 a[242:243], v252 offset:1024
    ds_read_b64_tr_b16 a[244:245], v253 offset:0
    ds_read_b64_tr_b16 a[246:247], v253 offset:1024
    ds_read_b64_tr_b16 a[248:249], v254 offset:0
    ds_read_b64_tr_b16 a[250:251], v254 offset:1024
    ds_read_b64_tr_b16 a[252:253], v255 offset:0
    ds_read_b64_tr_b16 a[254:255], v255 offset:1024
    v_mfma_f32_32x32x16_bf16 v[138:153], a[112:115], a[96:99], v[138:153]
    v_exp_f32 v159, v159
    v_exp_f32 v160, v160
    v_cvt_pk_bf16_f32 v36, v158, v159
    v_exp_f32 v161, v161
    v_exp_f32 v162, v162
    v_cvt_pk_bf16_f32 v37, v160, v161
    v_exp_f32 v163, v163
    v_exp_f32 v164, v164
    v_mfma_f32_32x32x16_bf16 v[58:73], a[32:35], v[34:37], v[58:73]
    v_cvt_pk_bf16_f32 v38, v162, v163
    v_exp_f32 v165, v165
    s_waitcnt lgkmcnt(0)
    s_add_u32 m0, s93, 0
    s_nop 0
    buffer_load_dwordx4 v6, s[88:91], s92 offen offset:0 lds
    buffer_load_dwordx4 v7, s[88:91], s92 offen offset:1024 lds
    buffer_load_dwordx4 v8, s[88:91], s92 offen offset:2048 lds
    buffer_load_dwordx4 v9, s[88:91], s92 offen offset:3072 lds
    s_add_u32 s92, s92, 110592
    s_cmp_eq_u32 s92, 1769472
    s_cselect_b32 s92, 0, s92
    v_max3_f32 v26, v26, v138, v139
    v_max3_f32 v27, v27, v140, v141
    v_max3_f32 v26, v26, v142, v143
    v_max3_f32 v27, v27, v144, v145
    v_max3_f32 v26, v26, v146, v147
    v_max3_f32 v27, v27, v148, v149
    v_max3_f32 v26, v26, v150, v151
    v_max3_f32 v27, v27, v152, v153
    v_cvt_pk_bf16_f32 v39, v164, v165
    v_exp_f32 v166, v166
    v_exp_f32 v167, v167
    v_exp_f32 v168, v168
    v_cvt_pk_bf16_f32 v40, v166, v167
    v_exp_f32 v169, v169
    v_exp_f32 v170, v170
    v_cvt_pk_bf16_f32 v41, v168, v169
    v_mfma_f32_32x32x16_bf16 v[154:169], a[116:119], a[92:95], 0
    v_exp_f32 v171, v171
    v_exp_f32 v172, v172
    v_cvt_pk_bf16_f32 v42, v170, v171
    v_exp_f32 v173, v173
    v_mfma_f32_32x32x16_bf16 v[58:73], a[36:39], v[38:41], v[58:73]
    v_cvt_pk_bf16_f32 v43, v172, v173
    v_exp_f32 v174, v174
    v_exp_f32 v175, v175
    v_exp_f32 v176, v176
    v_mfma_f32_32x32x16_bf16 v[154:169], a[112:115], a[100:103], v[154:169]
    v_cvt_pk_bf16_f32 v44, v174, v175
    v_exp_f32 v177, v177
    v_exp_f32 v178, v178
    s_waitcnt vmcnt(20)
    ds_read_b64_tr_b16 a[224:225], v252 offset:16384
    ds_read_b64_tr_b16 a[226:227], v252 offset:17408
    ds_read_b64_tr_b16 a[228:229], v253 offset:16384
    ds_read_b64_tr_b16 a[230:231], v253 offset:17408
    ds_read_b64_tr_b16 a[232:233], v254 offset:16384
    ds_read_b64_tr_b16 a[234:235], v254 offset:17408
    ds_read_b64_tr_b16 a[236:237], v255 offset:16384
    ds_read_b64_tr_b16 a[238:239], v255 offset:17408
    v_cvt_pk_bf16_f32 v45, v176, v177
    v_exp_f32 v179, v179
    v_exp_f32 v180, v180
    v_mfma_f32_32x32x16_bf16 v[58:73], a[40:43], v[42:45], v[58:73]
    v_cvt_pk_bf16_f32 v46, v178, v179
    v_exp_f32 v181, v181
    v_exp_f32 v182, v182
    v_cvt_pk_bf16_f32 v47, v180, v181
    v_max3_f32 v26, v26, v154, v155
    v_max3_f32 v27, v27, v156, v157
    v_max3_f32 v26, v26, v158, v159
    v_max3_f32 v27, v27, v160, v161
    v_max3_f32 v26, v26, v162, v163
    v_max3_f32 v27, v27, v164, v165
    v_max3_f32 v26, v26, v166, v167
    s_waitcnt lgkmcnt(0)
    s_add_u32 m0, s93, 16384
    s_nop 0
    buffer_load_dwordx4 v6, s[88:91], s92 offen offset:0 lds
    buffer_load_dwordx4 v7, s[88:91], s92 offen offset:1024 lds
    buffer_load_dwordx4 v8, s[88:91], s92 offen offset:2048 lds
    buffer_load_dwordx4 v9, s[88:91], s92 offen offset:3072 lds
    s_add_u32 s92, s92, 110592
    s_cmp_eq_u32 s92, 1769472
    s_cselect_b32 s92, 0, s92
    v_max3_f32 v27, v27, v168, v169
    v_exp_f32 v183, v183
    v_exp_f32 v184, v184
    v_cvt_pk_bf16_f32 v48, v182, v183
    v_exp_f32 v185, v185
    v_exp_f32 v186, v186
    v_cvt_pk_bf16_f32 v49, v184, v185
    v_mfma_f32_32x32x16_bf16 v[170:185], a[108:111], a[92:95], 0
    v_exp_f32 v187, v187
    v_exp_f32 v188, v188
    v_cvt_pk_bf16_f32 v50, v186, v187
    v_exp_f32 v189, v189
    v_mfma_f32_32x32x16_bf16 v[58:73], a[44:47], v[46:49], v[58:73]
    v_cvt_pk_bf16_f32 v51, v188, v189
    v_exp_f32 v190, v190
    v_exp_f32 v191, v191
    v_exp_f32 v192, v192
    v_mfma_f32_32x32x16_bf16 v[170:185], a[104:107], a[96:99], v[170:185]
    v_cvt_pk_bf16_f32 v52, v190, v191
    v_exp_f32 v193, v193
    v_exp_f32 v194, v194
    v_cvt_pk_bf16_f32 v53, v192, v193
    v_exp_f32 v195, v195
    v_exp_f32 v196, v196
    v_mfma_f32_32x32x16_bf16 v[58:73], a[48:51], v[50:53], v[58:73]
    v_cvt_pk_bf16_f32 v54, v194, v195
    v_exp_f32 v197, v197
    v_exp_f32 v198, v198
    s_waitcnt vmcnt(20)
    ds_read_b64_tr_b16 a[208:209], v252 offset:32768
    ds_read_b64_tr_b16 a[210:211], v252 offset:33792
    ds_read_b64_tr_b16 a[212:213], v253 offset:32768
    ds_read_b64_tr_b16 a[214:215], v253 offset:33792
    ds_read_b64_tr_b16 a[216:217], v254 offset:32768
    ds_read_b64_tr_b16 a[218:219], v254 offset:33792
    ds_read_b64_tr_b16 a[220:221], v255 offset:32768
    ds_read_b64_tr_b16 a[222:223], v255 offset:33792
    v_cvt_pk_bf16_f32 v55, v196, v197
    v_max3_f32 v26, v26, v170, v171
    v_max3_f32 v27, v27, v172, v173
    v_max3_f32 v26, v26, v174, v175
    v_max3_f32 v27, v27, v176, v177
    v_max3_f32 v26, v26, v178, v179
    v_max3_f32 v27, v27, v180, v181
    v_max3_f32 v26, v26, v182, v183
    v_max3_f32 v27, v27, v184, v185
    v_exp_f32 v199, v199
    v_max_f32 v26, v26, v27
    v_cvt_pk_bf16_f32 v56, v198, v199
    v_mov_b32 v27, v26
    v_exp_f32 v200, v200
    v_exp_f32 v201, v201
    s_waitcnt lgkmcnt(0)
    s_add_u32 m0, s93, 32768
    s_nop 0
    buffer_load_dwordx4 v6, s[88:91], s92 offen offset:0 lds
    buffer_load_dwordx4 v7, s[88:91], s92 offen offset:1024 lds
    buffer_load_dwordx4 v8, s[88:91], s92 offen offset:2048 lds
    buffer_load_dwordx4 v9, s[88:91], s92 offen offset:3072 lds
    s_add_u32 s92, s92, 110592
    s_cmp_eq_u32 s92, 1769472
    s_cselect_b32 s92, 0, s92
    v_permlane32_swap_b32 v26, v27
    v_cvt_pk_bf16_f32 v57, v200, v201
    v_max_f32 v26, v26, v27
    v_exp_f32 v202, v202
    v_mfma_f32_32x32x16_bf16 v[58:73], a[52:55], v[54:57], v[58:73]
    v_and_b32 v30, v23, v26
    v_exp_f32 v203, v203
    v_sub_f32 v26, v26, v30
    v_cvt_pk_bf16_f32 v34, v202, v203
    v_and_b32 v27, v23, v26
    v_exp_f32 v204, v204
    v_sub_f32 v26, v26, v27
    v_cvt_pk_bf16_f32 v30, v30, v27
    v_cvt_pk_bf16_f32 v31, v26, 0
    v_exp_f32 v205, v205
    v_exp_f32 v206, v206
    v_mfma_f32_32x32x8_bf16 v[90:105], a[80:81], v[30:31], v[90:105]
    v_cvt_pk_bf16_f32 v35, v204, v205
    v_exp_f32 v207, v207
    v_exp_f32 v208, v208
    v_cvt_pk_bf16_f32 v36, v206, v207
    v_mfma_f32_32x32x8_bf16 v[218:233], a[80:81], v[30:31], v[218:233]
    v_exp_f32 v209, v209
    v_exp_f32 v210, v210
    v_cvt_pk_bf16_f32 v37, v208, v209
    v_exp_f32 v211, v211
    v_mfma_f32_32x32x8_bf16 v[234:249], a[80:81], v[30:31], v[234:249]
    v_cvt_pk_bf16_f32 v38, v210, v211
    v_exp_f32 v212, v212
    v_exp_f32 v213, v213
    v_exp_f32 v214, v214
    v_mfma_f32_32x32x16_bf16 v[58:73], a[56:59], v[34:37], v[58:73]
    s_mul_i32 s46, s3, 3072
    s_sub_u32 s42, s42, s46
    s_lshl_b32 s46, s3, 10
    s_add_u32 m0, s46, 159744
    s_nop 0
    buffer_load_dwordx4 v2, s[16:19], s42 offen sc1 lds
    v_cvt_pk_bf16_f32 v39, v212, v213
    v_mfma_f32_32x32x8_bf16 v[106:121], a[80:81], v[30:31], v[106:121]
    v_exp_f32 v215, v215
    v_exp_f32 v216, v216
    v_cvt_pk_bf16_f32 v40, v214, v215
    v_exp_f32 v217, v217
    v_mfma_f32_32x32x8_bf16 v[122:137], a[80:81], v[30:31], v[122:137]
    v_cvt_pk_bf16_f32 v41, v216, v217
    v_exp_f32 v74, v74
    v_exp_f32 v75, v75
    v_exp_f32 v76, v76
    v_mfma_f32_32x32x16_bf16 v[58:73], a[60:63], v[38:41], v[58:73]
    v_cvt_pk_bf16_f32 v42, v74, v75
    v_exp_f32 v77, v77
    v_and_b32 v50, v42, v15
    v_cvt_pk_bf16_f32 v43, v76, v77
    v_xor_b32 v42, v42, v50
    v_mfma_f32_32x32x8_bf16 v[138:153], a[80:81], v[30:31], v[138:153]
    v_and_b32 v51, v43, v16
    v_exp_f32 v78, v78
    v_xor_b32 v43, v43, v51
    v_exp_f32 v79, v79
    v_mfma_f32_32x32x8_bf16 v[154:169], a[80:81], v[30:31], v[154:169]
    v_cvt_pk_bf16_f32 v44, v78, v79
    v_exp_f32 v80, v80
    v_and_b32 v52, v44, v17
    v_exp_f32 v81, v81
    v_mfma_f32_32x32x8_bf16 v[170:185], a[80:81], v[30:31], v[170:185]
    v_cvt_pk_bf16_f32 v45, v80, v81
    s_waitcnt vmcnt(9)
    ds_read_b64_tr_b16 a[192:193], v252 offset:0
    ds_read_b64_tr_b16 a[194:195], v252 offset:1024
    ds_read_b64_tr_b16 a[196:197], v253 offset:0
    ds_read_b64_tr_b16 a[198:199], v253 offset:1024
    ds_read_b64_tr_b16 a[200:201], v254 offset:0
    ds_read_b64_tr_b16 a[202:203], v254 offset:1024
    ds_read_b64_tr_b16 a[204:205], v255 offset:0
    ds_read_b64_tr_b16 a[206:207], v255 offset:1024
    v_xor_b32 v44, v44, v52
    v_and_b32 v53, v45, v18
    v_exp_f32 v82, v82
    v_xor_b32 v45, v45, v53
    v_mfma_f32_32x32x16_bf16 v[58:73], a[64:67], v[50:53], v[58:73]
    v_exp_f32 v83, v83
    v_exp_f32 v84, v84
    v_cvt_pk_bf16_f32 v46, v82, v83
    v_exp_f32 v85, v85
    v_and_b32 v54, v46, v19
    v_cvt_pk_bf16_f32 v47, v84, v85
    v_xor_b32 v46, v46, v54
    v_and_b32 v55, v47, v20
    v_exp_f32 v86, v86
    s_waitcnt lgkmcnt(0)
    s_add_u32 m0, s93, 0
    s_nop 0
    buffer_load_dwordx4 v6, s[88:91], s92 offen offset:0 lds
    buffer_load_dwordx4 v7, s[88:91], s92 offen offset:1024 lds
    buffer_load_dwordx4 v8, s[88:91], s92 offen offset:2048 lds
    buffer_load_dwordx4 v9, s[88:91], s92 offen offset:3072 lds
    s_add_u32 s92, s92, 110592
    s_cmp_eq_u32 s92, 1769472
    s_cselect_b32 s92, 0, s92
    v_xor_b32 v47, v47, v55
    v_exp_f32 v87, v87
    v_exp_f32 v88, v88
    v_cvt_pk_bf16_f32 v48, v86, v87
    v_exp_f32 v89, v89
    v_and_b32 v56, v48, v21
    v_cvt_pk_bf16_f32 v49, v88, v89
    v_xor_b32 v48, v48, v56
    v_and_b32 v57, v49, v22
    v_exp_f32 v90, v90
    v_xor_b32 v49, v49, v57
    v_mfma_f32_32x32x16_bf16 v[58:73], a[68:71], v[54:57], v[58:73]
    v_exp_f32 v91, v91
    v_exp_f32 v92, v92
    v_cvt_pk_bf16_f32 v34, v90, v91
    v_exp_f32 v93, v93
    v_mfma_f32_32x32x16_bf16 v[58:73], a[0:3], v[42:45], v[58:73]
    v_cvt_pk_bf16_f32 v35, v92, v93
    v_exp_f32 v94, v94
    v_exp_f32 v95, v95
    v_exp_f32 v96, v96
    v_mfma_f32_32x32x16_bf16 v[58:73], a[4:7], v[46:49], v[58:73]
    v_cvt_pk_bf16_f32 v36, v94, v95
    v_exp_f32 v97, v97
    v_exp_f32 v98, v98
    v_cvt_pk_bf16_f32 v37, v96, v97
    v_exp_f32 v99, v99
    v_exp_f32 v100, v100
    v_mfma_f32_32x32x16_bf16 v[186:201], a[16:19], v[34:37], 0
    s_waitcnt vmcnt(9)
    ds_read_b64_tr_b16 a[176:177], v252 offset:16384
    ds_read_b64_tr_b16 a[178:179], v252 offset:17408
    ds_read_b64_tr_b16 a[180:181], v253 offset:16384
    ds_read_b64_tr_b16 a[182:183], v253 offset:17408
    ds_read_b64_tr_b16 a[184:185], v254 offset:16384
    ds_read_b64_tr_b16 a[186:187], v254 offset:17408
    ds_read_b64_tr_b16 a[188:189], v255 offset:16384
    ds_read_b64_tr_b16 a[190:191], v255 offset:17408
    v_cvt_pk_bf16_f32 v38, v98, v99
    v_exp_f32 v101, v101
    v_exp_f32 v102, v102
    v_cvt_pk_bf16_f32 v39, v100, v101
    v_rcp_f32 v32, v70
    v_exp_f32 v103, v103
    v_mul_f32 v58, v58, v32
    v_mul_f32 v59, v59, v32
    v_mul_f32 v60, v60, v32
    v_mul_f32 v61, v61, v32
    v_mul_f32 v62, v62, v32
    v_mul_f32 v63, v63, v32
    v_mul_f32 v64, v64, v32
    v_mul_f32 v65, v65, v32
    v_mul_f32 v66, v66, v32
    s_waitcnt lgkmcnt(0)
    s_add_u32 m0, s93, 16384
    s_nop 0
    buffer_load_dwordx4 v6, s[88:91], s92 offen offset:0 lds
    buffer_load_dwordx4 v7, s[88:91], s92 offen offset:1024 lds
    buffer_load_dwordx4 v8, s[88:91], s92 offen offset:2048 lds
    buffer_load_dwordx4 v9, s[88:91], s92 offen offset:3072 lds
    s_add_u32 s92, s92, 110592
    s_cmp_eq_u32 s92, 1769472
    s_cselect_b32 s92, 0, s92
    v_mul_f32 v67, v67, v32
    v_mul_f32 v68, v68, v32
    v_mul_f32 v69, v69, v32
    v_cvt_pk_bf16_f32 v58, v58, v59
    v_cvt_pk_bf16_f32 v59, v60, v61
    v_cvt_pk_bf16_f32 v60, v62, v63
    v_cvt_pk_bf16_f32 v61, v64, v65
    v_cvt_pk_bf16_f32 v62, v66, v67
    v_cvt_pk_bf16_f32 v63, v68, v69
    v_cvt_pk_bf16_f32 v40, v102, v103
    v_exp_f32 v104, v104
    v_exp_f32 v105, v105
    v_exp_f32 v218, v218
    v_cvt_pk_bf16_f32 v41, v104, v105
    v_exp_f32 v219, v219
    v_exp_f32 v220, v220
    v_mfma_f32_32x32x16_bf16 v[186:201], a[20:23], v[38:41], v[186:201]
    v_cvt_pk_bf16_f32 v42, v218, v219
    v_exp_f32 v221, v221
    v_and_b32 v50, v42, v15
    v_cvt_pk_bf16_f32 v43, v220, v221
    v_xor_b32 v42, v42, v50
    v_and_b32 v51, v43, v16
    v_exp_f32 v222, v222
    v_xor_b32 v43, v43, v51
    v_exp_f32 v223, v223
    v_exp_f32 v224, v224
    v_cvt_pk_bf16_f32 v44, v222, v223
    v_exp_f32 v225, v225
    v_and_b32 v52, v44, v17
    v_cvt_pk_bf16_f32 v45, v224, v225
    v_xor_b32 v44, v44, v52
    v_and_b32 v53, v45, v18
    v_exp_f32 v226, v226
    s_waitcnt vmcnt(9)
    ds_read_b64_tr_b16 a[160:161], v252 offset:32768
    ds_read_b64_tr_b16 a[162:163], v252 offset:33792
    ds_read_b64_tr_b16 a[164:165], v253 offset:32768
    ds_read_b64_tr_b16 a[166:167], v253 offset:33792
    ds_read_b64_tr_b16 a[168:169], v254 offset:32768
    ds_read_b64_tr_b16 a[170:171], v254 offset:33792
    ds_read_b64_tr_b16 a[172:173], v255 offset:32768
    ds_read_b64_tr_b16 a[174:175], v255 offset:33792
    v_mfma_f32_32x32x16_bf16 v[186:201], a[72:75], v[50:53], v[186:201]
    v_xor_b32 v45, v45, v53
    v_exp_f32 v227, v227
    v_exp_f32 v228, v228
    v_cvt_pk_bf16_f32 v46, v226, v227
    v_exp_f32 v229, v229
    v_and_b32 v54, v46, v19
    v_cvt_pk_bf16_f32 v47, v228, v229
    v_xor_b32 v46, v46, v54
    v_and_b32 v55, v47, v20
    v_exp_f32 v230, v230
    v_xor_b32 v47, v47, v55
    v_exp_f32 v231, v231
    v_exp_f32 v232, v232
    s_waitcnt lgkmcnt(0)
    s_add_u32 m0, s93, 32768
    s_nop 0
    buffer_load_dwordx4 v6, s[88:91], s92 offen offset:0 lds
    buffer_load_dwordx4 v7, s[88:91], s92 offen offset:1024 lds
    buffer_load_dwordx4 v8, s[88:91], s92 offen offset:2048 lds
    buffer_load_dwordx4 v9, s[88:91], s92 offen offset:3072 lds
    s_add_u32 s92, s92, 110592
    s_cmp_eq_u32 s92, 1769472
    s_cselect_b32 s92, 0, s92
    v_cvt_pk_bf16_f32 v48, v230, v231
    v_exp_f32 v233, v233
    v_and_b32 v56, v48, v21
    v_cvt_pk_bf16_f32 v49, v232, v233
    v_xor_b32 v48, v48, v56
    v_and_b32 v57, v49, v22
    v_exp_f32 v234, v234
    v_xor_b32 v49, v49, v57
    v_mfma_f32_32x32x16_bf16 v[186:201], a[76:79], v[54:57], v[186:201]
    v_exp_f32 v235, v235
    v_exp_f32 v236, v236
    v_cvt_pk_bf16_f32 v34, v234, v235
    v_exp_f32 v237, v237
    v_mfma_f32_32x32x16_bf16 v[186:201], a[8:11], v[42:45], v[186:201]
    v_cvt_pk_bf16_f32 v35, v236, v237
    v_exp_f32 v238, v238
    v_exp_f32 v239, v239
    v_exp_f32 v240, v240
    v_mfma_f32_32x32x16_bf16 v[186:201], a[12:15], v[46:49], v[186:201]
    v_cvt_pk_bf16_f32 v36, v238, v239
    v_exp_f32 v241, v241
    v_exp_f32 v242, v242
    v_cvt_pk_bf16_f32 v37, v240, v241
    v_exp_f32 v243, v243
    v_exp_f32 v244, v244
    v_mfma_f32_32x32x16_bf16 v[186:201], a[24:27], v[34:37], v[186:201]
    v_cvt_pk_bf16_f32 v38, v242, v243
    v_exp_f32 v245, v245
    v_exp_f32 v246, v246
    s_waitcnt vmcnt(8)
    ds_read_b64_tr_b16 a[144:145], v252 offset:0
    ds_read_b64_tr_b16 a[146:147], v252 offset:1024
    ds_read_b64_tr_b16 a[148:149], v253 offset:0
    ds_read_b64_tr_b16 a[150:151], v253 offset:1024
    ds_read_b64_tr_b16 a[152:153], v254 offset:0
    ds_read_b64_tr_b16 a[154:155], v254 offset:1024
    ds_read_b64_tr_b16 a[156:157], v255 offset:0
    ds_read_b64_tr_b16 a[158:159], v255 offset:1024
    v_cvt_pk_bf16_f32 v39, v244, v245
    v_exp_f32 v247, v247
    v_exp_f32 v248, v248
    v_cvt_pk_bf16_f32 v40, v246, v247
    v_exp_f32 v249, v249
    v_exp_f32 v106, v106
    v_cvt_pk_bf16_f32 v41, v248, v249
    v_exp_f32 v107, v107
    v_exp_f32 v108, v108
    v_mfma_f32_32x32x16_bf16 v[186:201], a[28:31], v[38:41], v[186:201]
    v_cvt_pk_bf16_f32 v42, v106, v107
    v_exp_f32 v109, v109
    s_waitcnt lgkmcnt(0)
    s_add_u32 m0, s93, 0
    s_nop 0
    buffer_load_dwordx4 v6, s[88:91], s92 offen offset:0 lds
    buffer_load_dwordx4 v7, s[88:91], s92 offen offset:1024 lds
    buffer_load_dwordx4 v8, s[88:91], s92 offen offset:2048 lds
    buffer_load_dwordx4 v9, s[88:91], s92 offen offset:3072 lds
    s_add_u32 s92, s92, 110592
    s_cmp_eq_u32 s92, 1769472
    s_cselect_b32 s92, 0, s92
    buffer_store_dwordx4 v[58:61], v13, s[8:11], s31 offen sc1
    buffer_store_dwordx2 v[62:63], v14, s[8:11], s33 offen sc1
    v_cvt_pk_bf16_f32 v43, v108, v109
    v_exp_f32 v110, v110
    v_exp_f32 v111, v111
    v_exp_f32 v112, v112
    v_cvt_pk_bf16_f32 v44, v110, v111
    v_exp_f32 v113, v113
    v_exp_f32 v114, v114
    v_cvt_pk_bf16_f32 v45, v112, v113
    v_exp_f32 v115, v115
    v_exp_f32 v116, v116
    v_mfma_f32_32x32x16_bf16 v[186:201], a[32:35], v[42:45], v[186:201]
    v_cvt_pk_bf16_f32 v46, v114, v115
    v_exp_f32 v117, v117
    v_exp_f32 v118, v118
    v_cvt_pk_bf16_f32 v47, v116, v117
    v_exp_f32 v119, v119
    v_exp_f32 v120, v120
    v_cvt_pk_bf16_f32 v48, v118, v119
    v_exp_f32 v121, v121
    v_exp_f32 v122, v122
    v_cvt_pk_bf16_f32 v49, v120, v121
    v_exp_f32 v123, v123
    v_exp_f32 v124, v124
    v_mfma_f32_32x32x16_bf16 v[186:201], a[36:39], v[46:49], v[186:201]
    v_cvt_pk_bf16_f32 v50, v122, v123
    v_exp_f32 v125, v125
    s_waitcnt vmcnt(10)
    ds_read_b64_tr_b16 a[128:129], v252 offset:16384
    ds_read_b64_tr_b16 a[130:131], v252 offset:17408
    ds_read_b64_tr_b16 a[132:133], v253 offset:16384
    ds_read_b64_tr_b16 a[134:135], v253 offset:17408
    ds_read_b64_tr_b16 a[136:137], v254 offset:16384
    ds_read_b64_tr_b16 a[138:139], v254 offset:17408
    ds_read_b64_tr_b16 a[140:141], v255 offset:16384
    ds_read_b64_tr_b16 a[142:143], v255 offset:17408
    v_cvt_pk_bf16_f32 v51, v124, v125
    v_exp_f32 v126, v126
    v_exp_f32 v127, v127
    v_exp_f32 v128, v128
    v_cvt_pk_bf16_f32 v52, v126, v127
    v_exp_f32 v129, v129
    v_exp_f32 v130, v130
    v_cvt_pk_bf16_f32 v53, v128, v129
    v_exp_f32 v131, v131
    v_exp_f32 v132, v132
    v_mfma_f32_32x32x16_bf16 v[186:201], a[40:43], v[50:53], v[186:201]
    v_cvt_pk_bf16_f32 v54, v130, v131
    s_waitcnt lgkmcnt(0)
    s_add_u32 m0, s93, 16384
    s_nop 0
    buffer_load_dwordx4 v6, s[88:91], s92 offen offset:0 lds
    buffer_load_dwordx4 v7, s[88:91], s92 offen offset:1024 lds
    buffer_load_dwordx4 v8, s[88:91], s92 offen offset:2048 lds
    buffer_load_dwordx4 v9, s[88:91], s92 offen offset:3072 lds
    s_add_u32 s92, s92, 110592
    s_cmp_eq_u32 s92, 1769472
    s_cselect_b32 s92, 0, s92
    v_exp_f32 v133, v133
    v_exp_f32 v134, v134
    v_cvt_pk_bf16_f32 v55, v132, v133
    v_exp_f32 v135, v135
    v_exp_f32 v136, v136
    v_cvt_pk_bf16_f32 v56, v134, v135
    v_exp_f32 v137, v137
    v_exp_f32 v138, v138
    v_cvt_pk_bf16_f32 v57, v136, v137
    v_exp_f32 v139, v139
    v_exp_f32 v140, v140
    v_mfma_f32_32x32x16_bf16 v[186:201], a[44:47], v[54:57], v[186:201]
    v_cvt_pk_bf16_f32 v34, v138, v139
    v_exp_f32 v141, v141
    v_exp_f32 v142, v142
    v_cvt_pk_bf16_f32 v35, v140, v141
    v_exp_f32 v143, v143
    v_exp_f32 v144, v144
    v_cvt_pk_bf16_f32 v36, v142, v143
    v_exp_f32 v145, v145
    v_exp_f32 v146, v146
    v_cvt_pk_bf16_f32 v37, v144, v145
    v_exp_f32 v147, v147
    v_exp_f32 v148, v148
    v_mfma_f32_32x32x16_bf16 v[186:201], a[48:51], v[34:37], v[186:201]
    v_cvt_pk_bf16_f32 v38, v146, v147
    v_exp_f32 v149, v149
    v_exp_f32 v150, v150
    s_waitcnt vmcnt(10)
    ds_read_b64_tr_b16 a[112:113], v252 offset:32768
    ds_read_b64_tr_b16 a[114:115], v252 offset:33792
    ds_read_b64_tr_b16 a[116:117], v253 offset:32768
    ds_read_b64_tr_b16 a[118:119], v253 offset:33792
    ds_read_b64_tr_b16 a[120:121], v254 offset:32768
    ds_read_b64_tr_b16 a[122:123], v254 offset:33792
    ds_read_b64_tr_b16 a[124:125], v255 offset:32768
    ds_read_b64_tr_b16 a[126:127], v255 offset:33792
    v_cvt_pk_bf16_f32 v39, v148, v149
    v_exp_f32 v151, v151
    v_exp_f32 v152, v152
    v_cvt_pk_bf16_f32 v40, v150, v151
    v_exp_f32 v153, v153
    v_exp_f32 v154, v154
    v_cvt_pk_bf16_f32 v41, v152, v153
    v_exp_f32 v155, v155
    v_exp_f32 v156, v156
    v_mfma_f32_32x32x16_bf16 v[186:201], a[52:55], v[38:41], v[186:201]
    v_cvt_pk_bf16_f32 v42, v154, v155
    v_exp_f32 v157, v157
    s_waitcnt lgkmcnt(0)
    s_add_u32 m0, s93, 32768
    s_nop 0
    buffer_load_dwordx4 v6, s[88:91], s92 offen offset:0 lds
    buffer_load_dwordx4 v7, s[88:91], s92 offen offset:1024 lds
    buffer_load_dwordx4 v8, s[88:91], s92 offen offset:2048 lds
    buffer_load_dwordx4 v9, s[88:91], s92 offen offset:3072 lds
    s_add_u32 s92, s92, 110592
    s_cmp_eq_u32 s92, 1769472
    s_cselect_b32 s92, 0, s92
    v_cvt_pk_bf16_f32 v43, v156, v157
    v_exp_f32 v158, v158
    v_exp_f32 v159, v159
    v_exp_f32 v160, v160
    v_cvt_pk_bf16_f32 v44, v158, v159
    v_exp_f32 v161, v161
    v_exp_f32 v162, v162
    v_cvt_pk_bf16_f32 v45, v160, v161
    v_exp_f32 v163, v163
    v_exp_f32 v164, v164
    v_mfma_f32_32x32x16_bf16 v[186:201], a[56:59], v[42:45], v[186:201]
    v_cvt_pk_bf16_f32 v46, v162, v163
    v_exp_f32 v165, v165
    v_exp_f32 v166, v166
    v_cvt_pk_bf16_f32 v47, v164, v165
    v_exp_f32 v167, v167
    v_exp_f32 v168, v168
    v_cvt_pk_bf16_f32 v48, v166, v167
    v_exp_f32 v169, v169
    v_exp_f32 v170, v170
    v_cvt_pk_bf16_f32 v49, v168, v169
    v_exp_f32 v171, v171
    v_exp_f32 v172, v172
    v_mfma_f32_32x32x16_bf16 v[186:201], a[60:63], v[46:49], v[186:201]
    v_cvt_pk_bf16_f32 v50, v170, v171
    v_exp_f32 v173, v173
    v_exp_f32 v174, v174
    v_cvt_pk_bf16_f32 v51, v172, v173
    v_exp_f32 v175, v175
    v_exp_f32 v176, v176
    v_cvt_pk_bf16_f32 v52, v174, v175
    v_exp_f32 v177, v177
    v_exp_f32 v178, v178
    v_cvt_pk_bf16_f32 v53, v176, v177
    v_exp_f32 v179, v179
    v_exp_f32 v180, v180
    v_mfma_f32_32x32x16_bf16 v[186:201], a[64:67], v[50:53], v[186:201]
    v_cvt_pk_bf16_f32 v54, v178, v179
    v_exp_f32 v181, v181
    v_exp_f32 v182, v182
    v_cvt_pk_bf16_f32 v55, v180, v181
    v_exp_f32 v183, v183
    v_exp_f32 v184, v184
    v_cvt_pk_bf16_f32 v56, v182, v183
    v_exp_f32 v185, v185
    s_nop 0
    v_cvt_pk_bf16_f32 v57, v184, v185
    s_nop 1
    v_mfma_f32_32x32x16_bf16 v[186:201], a[68:71], v[54:57], v[186:201]
    s_nop 11
    v_rcp_f32 v32, v198
    s_nop 0
    v_mul_f32 v186, v186, v32
    v_mul_f32 v187, v187, v32
    v_mul_f32 v188, v188, v32
    v_mul_f32 v189, v189, v32
    v_mul_f32 v190, v190, v32
    v_mul_f32 v191, v191, v32
    v_mul_f32 v192, v192, v32
    v_mul_f32 v193, v193, v32
    v_mul_f32 v194, v194, v32
    v_mul_f32 v195, v195, v32
    v_mul_f32 v196, v196, v32
    v_mul_f32 v197, v197, v32
    v_cvt_pk_bf16_f32 v186, v186, v187
    v_cvt_pk_bf16_f32 v187, v188, v189
    v_cvt_pk_bf16_f32 v188, v190, v191
    v_cvt_pk_bf16_f32 v189, v192, v193
    v_cvt_pk_bf16_f32 v190, v194, v195
    v_cvt_pk_bf16_f32 v191, v196, v197
    buffer_store_dwordx4 v[186:189], v13, s[8:11], s32 offen sc1
    buffer_store_dwordx2 v[190:191], v14, s[8:11], s34 offen sc1
    s_lshl2_add_u32 s34, s94, s3
    s_mul_i32 s30, s34, 20480
    v_add_u32 v22, 61440, v2
    v_add_u32 v23, 112640, v2
    s_lshl_b32 s28, s94, 12
    s_add_u32 s28, s28, 131072
    v_lshl_add_u32 v25, v1, 7, s28
    s_mul_i32 s28, s95, 160
    s_and_b32 s29, s28, 32
    s_mul_i32 s28, s3, 3072
    s_add_u32 s29, s29, s28
    s_add_u32 s29, s29, 49152
    v_lshrrev_b32 v20, 2, v1
    v_mul_u32_u24 v24, 192, v20
    v_and_b32 v21, 3, v1
    v_lshl_add_u32 v24, v21, 3, v24
    v_add_u32 v24, s29, v24
    v_lshlrev_b32 v20, 3, v20
    v_lshl_add_u32 v27, v21, 7, v20
    v_lshl_add_u32 v26, v21, 28, v20
    v_lshrrev_b32 v20, 5, v1
    v_and_b32 v21, 31, v1
    v_lshlrev_b32 v21, 4, v21
    v_lshl_add_u32 v29, v20, 10, v21
    v_lshl_add_u32 v28, v20, 30, v21
    s_lshr_b32 s33, s34, 1
    s_mul_i32 s33, s33, 40960
    s_mul_i32 s29, s95, 5120
    s_add_u32 s33, s33, s29
    s_and_b32 s29, s34, 1
    s_lshl_b32 s29, s29, 9
    s_add_u32 s33, s33, s29
    s_add_u32 s31, s33, 4096
    s_lshl_b32 s32, s34, 10
    s_lshl_b32 s29, s95, 7
    s_add_u32 s29, s29, s32
    s_add_u32 s16, s86, 0xb00000
    s_addc_u32 s17, s87, 0
    s_mov_b32 s18, 0x280000
    s_mov_b32 s19, 0x20000
    s_add_u32 s12, s86, 0x11d0000
    s_addc_u32 s13, s87, 0
    s_mov_b32 s14, 0x20000
    s_mov_b32 s15, 0x20000
    ds_read_b64_tr_b16 v[10:11], v24 offset:0
    ds_read_b64_tr_b16 v[12:13], v24 offset:32
    ds_read_b64_tr_b16 v[14:15], v24 offset:64
    ds_read_b64_tr_b16 v[16:17], v24 offset:96
    ds_read_b64_tr_b16 v[18:19], v24 offset:128
    s_waitcnt lgkmcnt(4)
    v_lshlrev_b32 v30, 16, v10
    v_and_b32 v31, 0xffff0000, v10
    v_lshlrev_b32 v32, 16, v11
    v_and_b32 v33, 0xffff0000, v11
    s_waitcnt lgkmcnt(3)
    v_lshlrev_b32 v34, 16, v12
    v_and_b32 v35, 0xffff0000, v12
    v_lshlrev_b32 v36, 16, v13
    v_and_b32 v37, 0xffff0000, v13
    s_waitcnt lgkmcnt(2)
    v_lshlrev_b32 v38, 16, v14
    v_and_b32 v39, 0xffff0000, v14
    v_lshlrev_b32 v40, 16, v15
    v_and_b32 v41, 0xffff0000, v15
    s_waitcnt lgkmcnt(1)
    v_lshlrev_b32 v42, 16, v16
    v_and_b32 v43, 0xffff0000, v16
    v_lshlrev_b32 v44, 16, v17
    v_and_b32 v45, 0xffff0000, v17
    s_waitcnt lgkmcnt(0)
    v_lshlrev_b32 v46, 16, v18
    v_and_b32 v47, 0xffff0000, v18
    v_lshlrev_b32 v48, 16, v19
    v_and_b32 v49, 0xffff0000, v19
    v_and_b32 v24, 15, v1
    v_lshlrev_b32 v24, 3, v24
    v_sub_u32 v24, v2, v24
    s_waitcnt vmcnt(0)
    s_mov_b64 exec, 1
    buffer_store_dword v4, off, s[80:83], s47 sc1
    s_mov_b64 exec, -1
    s_barrier
    s_lshl3_add_u32 s47, s94, s95
    s_add_u32 s47, s47, 256
    s_lshl_b32 s47, s47, 7
    s_cmp_eq_u32 s3, 0
    s_cselect_b32 s47, s47, 805306368
    ds_read_b64_tr_b16 a[96:97], v252 offset:0
    ds_read_b64_tr_b16 a[98:99], v252 offset:1024
    ds_read_b64_tr_b16 a[100:101], v253 offset:0
    ds_read_b64_tr_b16 a[102:103], v253 offset:1024
    ds_read_b64_tr_b16 a[104:105], v254 offset:0
    ds_read_b64_tr_b16 a[106:107], v254 offset:1024
    ds_read_b64_tr_b16 a[108:109], v255 offset:0
    ds_read_b64_tr_b16 a[110:111], v255 offset:1024
    ds_read_b64_tr_b16 a[80:81], v252 offset:16384
    ds_read_b64_tr_b16 a[82:83], v252 offset:17408
    ds_read_b64_tr_b16 a[84:85], v253 offset:16384
    ds_read_b64_tr_b16 a[86:87], v253 offset:17408
    ds_read_b64_tr_b16 a[88:89], v254 offset:16384
    ds_read_b64_tr_b16 a[90:91], v254 offset:17408
    ds_read_b64_tr_b16 a[92:93], v255 offset:16384
    ds_read_b64_tr_b16 a[94:95], v255 offset:17408
    s_waitcnt lgkmcnt(8)
    s_add_u32 m0, s93, 0
    s_nop 0
    buffer_load_dwordx4 v6, s[88:91], s92 offen offset:0 lds
    buffer_load_dwordx4 v7, s[88:91], s92 offen offset:1024 lds
    buffer_load_dwordx4 v8, s[88:91], s92 offen offset:2048 lds
    buffer_load_dwordx4 v9, s[88:91], s92 offen offset:3072 lds
    s_add_u32 s92, s92, 110592
    s_cmp_eq_u32 s92, 1769472
    s_cselect_b32 s92, 0, s92
    s_waitcnt lgkmcnt(0)
    s_add_u32 m0, s93, 16384
    s_nop 0
    buffer_load_dwordx4 v6, s[88:91], s92 offen offset:0 lds
    buffer_load_dwordx4 v7, s[88:91], s92 offen offset:1024 lds
    buffer_load_dwordx4 v8, s[88:91], s92 offen offset:2048 lds
    buffer_load_dwordx4 v9, s[88:91], s92 offen offset:3072 lds
    s_add_u32 s92, s92, 110592
    s_cmp_eq_u32 s92, 1769472
    s_cselect_b32 s92, 0, s92
    ds_read_b128 v[50:53], v22 offset:0
    ds_read_b128 v[54:57], v22 offset:1024
    ds_read_b128 v[58:61], v22 offset:2048
    ds_read_b128 v[62:65], v22 offset:3072
    ds_read_b128 v[66:69], v22 offset:4096
    ds_read_b128 v[70:73], v22 offset:5120
    ds_read_b128 v[74:77], v22 offset:6144
    ds_read_b128 v[78:81], v22 offset:7168
    ds_read_b128 v[82:85], v22 offset:8192
    ds_read_b128 v[86:89], v22 offset:9216
    ds_read_b128 v[90:93], v22 offset:10240
    ds_read_b128 v[94:97], v22 offset:11264
    ds_read_b128 v[98:101], v22 offset:12288
    ds_read_b128 v[102:105], v22 offset:13312
    ds_read_b128 v[106:109], v22 offset:14336
    ds_read_b128 v[110:113], v22 offset:15360
    ds_read_b128 v[114:117], v22 offset:16384
    ds_read_b128 v[118:121], v22 offset:17408
    ds_read_b128 v[122:125], v22 offset:18432
    ds_read_b128 v[126:129], v22 offset:19456
    ds_read_b128 v[130:133], v22 offset:20480
    ds_read_b128 v[134:137], v22 offset:21504
    ds_read_b128 v[138:141], v22 offset:22528
    ds_read_b128 v[142:145], v22 offset:23552
    ds_read_b128 v[146:149], v22 offset:24576
    ds_read_b128 v[150:153], v22 offset:25600
    ds_read_b128 v[154:157], v22 offset:26624
    ds_read_b128 v[158:161], v22 offset:27648
    ds_read_b128 v[162:165], v22 offset:28672
    ds_read_b128 v[166:169], v22 offset:29696
    ds_read_b128 v[170:173], v22 offset:30720
    ds_read_b128 v[174:177], v22 offset:31744
    ds_read_b128 v[178:181], v22 offset:32768
    ds_read_b128 v[182:185], v22 offset:33792
    ds_read_b128 v[186:189], v22 offset:34816
    ds_read_b128 v[190:193], v22 offset:35840
    ds_read_b128 v[194:197], v22 offset:36864
    ds_read_b128 v[198:201], v22 offset:37888
    ds_read_b128 v[202:205], v22 offset:38912
    ds_read_b128 v[206:209], v22 offset:39936
    ds_read_b128 v[210:213], v22 offset:40960
    ds_read_b128 v[214:217], v22 offset:41984
    ds_read_b128 v[218:221], v22 offset:43008
    ds_read_b128 v[222:225], v22 offset:44032
    ds_read_b128 v[226:229], v22 offset:45056
    ds_read_b128 v[230:233], v22 offset:46080
    ds_read_b128 v[234:237], v22 offset:47104
    ds_read_b128 v[238:241], v22 offset:48128
    ds_read_b128 v[242:245], v22 offset:49152
    ds_read_b128 v[246:249], v22 offset:50176
    s_mov_b32 exec_lo, 4294967295
    s_mov_b32 exec_hi, 0
    s_mov_b32 s46, 0x40000
poll1:
    buffer_load_dword v5, v25, s[80:83], 0 offen sc1
    s_sub_u32 s46, s46, 1
    s_waitcnt vmcnt(0)
    v_cmp_ne_u32 vcc, v4, v5
    s_cbranch_scc1 pollx1
    s_cbranch_vccnz poll1
pollx1:
    s_mov_b64 exec, -1
    buffer_load_dwordx4 a[0:3], v2, s[8:11], s30 offen offset:0 sc1
    buffer_load_dwordx4 a[4:7], v2, s[8:11], s30 offen offset:1024 sc1
    buffer_load_dwordx4 a[8:11], v2, s[8:11], s30 offen offset:2048 sc1
    buffer_load_dwordx4 a[12:15], v2, s[8:11], s30 offen offset:3072 sc1
    s_add_u32 s30, s30, 4096
    buffer_load_dwordx4 a[16:19], v2, s[8:11], s30 offen offset:0 sc1
    buffer_load_dwordx4 a[20:23], v2, s[8:11], s30 offen offset:1024 sc1
    buffer_load_dwordx4 a[24:27], v2, s[8:11], s30 offen offset:2048 sc1
    buffer_load_dwordx4 a[28:31], v2, s[8:11], s30 offen offset:3072 sc1
    s_waitcnt vmcnt(7) lgkmcnt(15)
    v_mfma_f32_16x16x32_bf16 v[30:33], a[0:3], v[50:53], v[30:33]
    s_add_u32 s30, s30, 4096
    buffer_load_dwordx4 a[32:35], v2, s[8:11], s30 offen offset:0 sc1
    v_mfma_f32_16x16x32_bf16 v[34:37], a[0:3], v[54:57], v[34:37]
    v_mfma_f32_16x16x32_bf16 v[38:41], a[0:3], v[58:61], v[38:41]
    v_mfma_f32_16x16x32_bf16 v[42:45], a[0:3], v[62:65], v[42:45]
    v_mfma_f32_16x16x32_bf16 v[46:49], a[0:3], v[66:69], v[46:49]
    s_waitcnt vmcnt(7)
    v_mfma_f32_16x16x32_bf16 v[30:33], a[4:7], v[70:73], v[30:33]
    buffer_load_dwordx4 a[36:39], v2, s[8:11], s30 offen offset:1024 sc1
    ds_read_b128 v[50:53], v23 offset:0
    v_mfma_f32_16x16x32_bf16 v[34:37], a[4:7], v[74:77], v[34:37]
    ds_read_b128 v[54:57], v23 offset:1024
    v_mfma_f32_16x16x32_bf16 v[38:41], a[4:7], v[78:81], v[38:41]
    ds_read_b128 v[58:61], v23 offset:2048
    v_mfma_f32_16x16x32_bf16 v[42:45], a[4:7], v[82:85], v[42:45]
    ds_read_b128 v[62:65], v23 offset:3072
    v_mfma_f32_16x16x32_bf16 v[46:49], a[4:7], v[86:89], v[46:49]
    ds_read_b128 v[66:69], v23 offset:4096
    s_waitcnt vmcnt(7)
    v_mfma_f32_16x16x32_bf16 v[30:33], a[8:11], v[90:93], v[30:33]
    buffer_load_dwordx4 a[40:43], v2, s[8:11], s30 offen offset:2048 sc1
    ds_read_b128 v[70:73], v23 offset:5120
    v_mfma_f32_16x16x32_bf16 v[34:37], a[8:11], v[94:97], v[34:37]
    ds_read_b128 v[74:77], v23 offset:6144
    v_mfma_f32_16x16x32_bf16 v[38:41], a[8:11], v[98:101], v[38:41]
    ds_read_b128 v[78:81], v23 offset:7168
    v_mfma_f32_16x16x32_bf16 v[42:45], a[8:11], v[102:105], v[42:45]
    ds_read_b128 v[82:85], v23 offset:8192
    v_mfma_f32_16x16x32_bf16 v[46:49], a[8:11], v[106:109], v[46:49]
    ds_read_b128 v[86:89], v23 offset:9216
    s_waitcnt vmcnt(7)
    v_mfma_f32_16x16x32_bf16 v[30:33], a[12:15], v[110:113], v[30:33]
    buffer_load_dwordx4 a[44:47], v2, s[8:11], s30 offen offset:3072 sc1
    ds_read_b128 v[90:93], v23 offset:10240
    v_mfma_f32_16x16x32_bf16 v[34:37], a[12:15], v[114:117], v[34:37]
    ds_read_b128 v[94:97], v23 offset:11264
    v_mfma_f32_16x16x32_bf16 v[38:41], a[12:15], v[118:121], v[38:41]
    ds_read_b128 v[98:101], v23 offset:12288
    v_mfma_f32_16x16x32_bf16 v[42:45], a[12:15], v[122:125], v[42:45]
    ds_read_b128 v[102:105], v23 offset:13312
    v_mfma_f32_16x16x32_bf16 v[46:49], a[12:15], v[126:129], v[46:49]
    ds_read_b128 v[106:109], v23 offset:14336
    s_waitcnt vmcnt(7)
    v_mfma_f32_16x16x32_bf16 v[30:33], a[16:19], v[130:133], v[30:33]
    s_add_u32 s30, s30, 4096
    buffer_load_dwordx4 a[48:51], v2, s[8:11], s30 offen offset:0 sc1
    ds_read_b128 v[110:113], v23 offset:15360
    v_mfma_f32_16x16x32_bf16 v[34:37], a[16:19], v[134:137], v[34:37]
    ds_read_b128 v[114:117], v23 offset:16384
    v_mfma_f32_16x16x32_bf16 v[38:41], a[16:19], v[138:141], v[38:41]
    ds_read_b128 v[118:121], v23 offset:17408
    v_mfma_f32_16x16x32_bf16 v[42:45], a[16:19], v[142:145], v[42:45]
    ds_read_b128 v[122:125], v23 offset:18432
    v_mfma_f32_16x16x32_bf16 v[46:49], a[16:19], v[146:149], v[46:49]
    ds_read_b128 v[126:129], v23 offset:19456
    s_waitcnt vmcnt(7)
    v_mfma_f32_16x16x32_bf16 v[30:33], a[20:23], v[150:153], v[30:33]
    buffer_load_dwordx4 a[52:55], v2, s[8:11], s30 offen offset:1024 sc1
    ds_read_b128 v[130:133], v23 offset:20480
    v_mfma_f32_16x16x32_bf16 v[34:37], a[20:23], v[154:157], v[34:37]
    ds_read_b128 v[134:137], v23 offset:21504
    v_mfma_f32_16x16x32_bf16 v[38:41], a[20:23], v[158:161], v[38:41]
    ds_read_b128 v[138:141], v23 offset:22528
    v_mfma_f32_16x16x32_bf16 v[42:45], a[20:23], v[162:165], v[42:45]
    ds_read_b128 v[142:145], v23 offset:23552
    v_mfma_f32_16x16x32_bf16 v[46:49], a[20:23], v[166:169], v[46:49]
    ds_read_b128 v[146:149], v23 offset:24576
    s_waitcnt vmcnt(7)
    v_mfma_f32_16x16x32_bf16 v[30:33], a[24:27], v[170:173], v[30:33]
    buffer_load_dwordx4 a[56:59], v2, s[8:11], s30 offen offset:2048 sc1
    ds_read_b128 v[150:153], v23 offset:25600
    v_mfma_f32_16x16x32_bf16 v[34:37], a[24:27], v[174:177], v[34:37]
    ds_read_b128 v[154:157], v23 offset:26624
    v_mfma_f32_16x16x32_bf16 v[38:41], a[24:27], v[178:181], v[38:41]
    ds_read_b128 v[158:161], v23 offset:27648
    v_mfma_f32_16x16x32_bf16 v[42:45], a[24:27], v[182:185], v[42:45]
    ds_read_b128 v[162:165], v23 offset:28672
    v_mfma_f32_16x16x32_bf16 v[46:49], a[24:27], v[186:189], v[46:49]
    ds_read_b128 v[166:169], v23 offset:29696
    s_waitcnt vmcnt(7) lgkmcnt(15)
    v_mfma_f32_16x16x32_bf16 v[30:33], a[28:31], v[190:193], v[30:33]
    buffer_load_dwordx4 a[60:63], v2, s[8:11], s30 offen offset:3072 sc1
    ds_read_b128 v[170:173], v23 offset:30720
    v_mfma_f32_16x16x32_bf16 v[34:37], a[28:31], v[194:197], v[34:37]
    ds_read_b128 v[174:177], v23 offset:31744
    v_mfma_f32_16x16x32_bf16 v[38:41], a[28:31], v[198:201], v[38:41]
    ds_read_b128 v[178:181], v23 offset:32768
    v_mfma_f32_16x16x32_bf16 v[42:45], a[28:31], v[202:205], v[42:45]
    ds_read_b128 v[182:185], v23 offset:33792
    v_mfma_f32_16x16x32_bf16 v[46:49], a[28:31], v[206:209], v[46:49]
    ds_read_b128 v[186:189], v23 offset:34816
    s_waitcnt vmcnt(7)
    v_mfma_f32_16x16x32_bf16 v[30:33], a[32:35], v[210:213], v[30:33]
    s_add_u32 s30, s30, 4096
    buffer_load_dwordx2 a[64:65], v24, s[8:11], s30 offen offset:0 sc1
    buffer_load_dwordx2 a[66:67], v24, s[8:11], s30 offen offset:128 sc1
    ds_read_b128 v[190:193], v23 offset:35840
    v_mfma_f32_16x16x32_bf16 v[34:37], a[32:35], v[214:217], v[34:37]
    ds_read_b128 v[194:197], v23 offset:36864
    v_mfma_f32_16x16x32_bf16 v[38:41], a[32:35], v[218:221], v[38:41]
    ds_read_b128 v[198:201], v23 offset:37888
    v_mfma_f32_16x16x32_bf16 v[42:45], a[32:35], v[222:225], v[42:45]
    ds_read_b128 v[202:205], v23 offset:38912
    v_mfma_f32_16x16x32_bf16 v[46:49], a[32:35], v[226:229], v[46:49]
    ds_read_b128 v[206:209], v23 offset:39936
    s_waitcnt vmcnt(8)
    v_mfma_f32_16x16x32_bf16 v[30:33], a[36:39], v[230:233], v[30:33]
    buffer_load_dwordx2 a[68:69], v24, s[8:11], s30 offen offset:1024 sc1
    buffer_load_dwordx2 a[70:71], v24, s[8:11], s30 offen offset:1152 sc1
    ds_read_b128 v[210:213], v23 offset:40960
    v_mfma_f32_16x16x32_bf16 v[34:37], a[36:39], v[234:237], v[34:37]
    ds_read_b128 v[214:217], v23 offset:41984
    v_mfma_f32_16x16x32_bf16 v[38:41], a[36:39], v[238:241], v[38:41]
    ds_read_b128 v[218:221], v23 offset:43008
    v_mfma_f32_16x16x32_bf16 v[42:45], a[36:39], v[242:245], v[42:45]
    ds_read_b128 v[222:225], v23 offset:44032
    v_mfma_f32_16x16x32_bf16 v[46:49], a[36:39], v[246:249], v[46:49]
    ds_read_b128 v[226:229], v23 offset:45056
    s_waitcnt vmcnt(9)
    v_mfma_f32_16x16x32_bf16 v[30:33], a[40:43], v[50:53], v[30:33]
    buffer_load_dwordx2 a[72:73], v24, s[8:11], s30 offen offset:2048 sc1
    buffer_load_dwordx2 a[74:75], v24, s[8:11], s30 offen offset:2176 sc1
    ds_read_b128 v[230:233], v23 offset:46080
    v_mfma_f32_16x16x32_bf16 v[34:37], a[40:43], v[54:57], v[34:37]
    ds_read_b128 v[234:237], v23 offset:47104
    v_mfma_f32_16x16x32_bf16 v[38:41], a[40:43], v[58:61], v[38:41]
    ds_read_b128 v[238:241], v23 offset:48128
    v_mfma_f32_16x16x32_bf16 v[42:45], a[40:43], v[62:65], v[42:45]
    ds_read_b128 v[242:245], v23 offset:49152
    v_mfma_f32_16x16x32_bf16 v[46:49], a[40:43], v[66:69], v[46:49]
    ds_read_b128 v[246:249], v23 offset:50176
    s_waitcnt vmcnt(10)
    v_mfma_f32_16x16x32_bf16 v[30:33], a[44:47], v[70:73], v[30:33]
    buffer_load_dwordx2 a[76:77], v24, s[8:11], s30 offen offset:3072 sc1
    buffer_load_dwordx2 a[78:79], v24, s[8:11], s30 offen offset:3200 sc1
    v_mfma_f32_16x16x32_bf16 v[34:37], a[44:47], v[74:77], v[34:37]
    v_mfma_f32_16x16x32_bf16 v[38:41], a[44:47], v[78:81], v[38:41]
    v_mfma_f32_16x16x32_bf16 v[42:45], a[44:47], v[82:85], v[42:45]
    v_mfma_f32_16x16x32_bf16 v[46:49], a[44:47], v[86:89], v[46:49]
    s_waitcnt vmcnt(11)
    v_mfma_f32_16x16x32_bf16 v[30:33], a[48:51], v[90:93], v[30:33]
    v_mfma_f32_16x16x32_bf16 v[34:37], a[48:51], v[94:97], v[34:37]
    v_mfma_f32_16x16x32_bf16 v[38:41], a[48:51], v[98:101], v[38:41]
    v_mfma_f32_16x16x32_bf16 v[42:45], a[48:51], v[102:105], v[42:45]
    v_mfma_f32_16x16x32_bf16 v[46:49], a[48:51], v[106:109], v[46:49]
    s_waitcnt vmcnt(10) lgkmcnt(15)
    v_mfma_f32_16x16x32_bf16 v[30:33], a[52:55], v[110:113], v[30:33]
    v_mfma_f32_16x16x32_bf16 v[34:37], a[52:55], v[114:117], v[34:37]
    v_mfma_f32_16x16x32_bf16 v[38:41], a[52:55], v[118:121], v[38:41]
    v_mfma_f32_16x16x32_bf16 v[42:45], a[52:55], v[122:125], v[42:45]
    v_mfma_f32_16x16x32_bf16 v[46:49], a[52:55], v[126:129], v[46:49]
    s_waitcnt vmcnt(9)
    v_mfma_f32_16x16x32_bf16 v[30:33], a[56:59], v[130:133], v[30:33]
    v_mfma_f32_16x16x32_bf16 v[34:37], a[56:59], v[134:137], v[34:37]
    v_mfma_f32_16x16x32_bf16 v[38:41], a[56:59], v[138:141], v[38:41]
    v_mfma_f32_16x16x32_bf16 v[42:45], a[56:59], v[142:145], v[42:45]
    v_mfma_f32_16x16x32_bf16 v[46:49], a[56:59], v[146:149], v[46:49]
    s_waitcnt vmcnt(8)
    v_mfma_f32_16x16x32_bf16 v[30:33], a[60:63], v[150:153], v[30:33]
    v_mfma_f32_16x16x32_bf16 v[34:37], a[60:63], v[154:157], v[34:37]
    v_mfma_f32_16x16x32_bf16 v[38:41], a[60:63], v[158:161], v[38:41]
    v_mfma_f32_16x16x32_bf16 v[42:45], a[60:63], v[162:165], v[42:45]
    v_mfma_f32_16x16x32_bf16 v[46:49], a[60:63], v[166:169], v[46:49]
    s_waitcnt vmcnt(6)
    v_mfma_f32_16x16x32_bf16 v[30:33], a[64:67], v[170:173], v[30:33]
    v_mfma_f32_16x16x32_bf16 v[34:37], a[64:67], v[174:177], v[34:37]
    v_mfma_f32_16x16x32_bf16 v[38:41], a[64:67], v[178:181], v[38:41]
    v_mfma_f32_16x16x32_bf16 v[42:45], a[64:67], v[182:185], v[42:45]
    v_mfma_f32_16x16x32_bf16 v[46:49], a[64:67], v[186:189], v[46:49]
    s_waitcnt vmcnt(4) lgkmcnt(14)
    v_mfma_f32_16x16x32_bf16 v[30:33], a[68:71], v[190:193], v[30:33]
    s_waitcnt lgkmcnt(13)
    v_mfma_f32_16x16x32_bf16 v[34:37], a[68:71], v[194:197], v[34:37]
    s_waitcnt lgkmcnt(12)
    v_mfma_f32_16x16x32_bf16 v[38:41], a[68:71], v[198:201], v[38:41]
    s_waitcnt lgkmcnt(11)
    v_mfma_f32_16x16x32_bf16 v[42:45], a[68:71], v[202:205], v[42:45]
    s_waitcnt lgkmcnt(10)
    v_mfma_f32_16x16x32_bf16 v[46:49], a[68:71], v[206:209], v[46:49]
    s_waitcnt vmcnt(2) lgkmcnt(9)
    v_mfma_f32_16x16x32_bf16 v[30:33], a[72:75], v[210:213], v[30:33]
    s_waitcnt lgkmcnt(8)
    v_mfma_f32_16x16x32_bf16 v[34:37], a[72:75], v[214:217], v[34:37]
    s_waitcnt lgkmcnt(7)
    v_mfma_f32_16x16x32_bf16 v[38:41], a[72:75], v[218:221], v[38:41]
    s_waitcnt lgkmcnt(6)
    v_mfma_f32_16x16x32_bf16 v[42:45], a[72:75], v[222:225], v[42:45]
    s_waitcnt lgkmcnt(5)
    v_mfma_f32_16x16x32_bf16 v[46:49], a[72:75], v[226:229], v[46:49]
    s_waitcnt vmcnt(0) lgkmcnt(4)
    v_mfma_f32_16x16x32_bf16 v[30:33], a[76:79], v[230:233], v[30:33]
    s_waitcnt lgkmcnt(3)
    v_mfma_f32_16x16x32_bf16 v[34:37], a[76:79], v[234:237], v[34:37]
    s_waitcnt lgkmcnt(2)
    v_mfma_f32_16x16x32_bf16 v[38:41], a[76:79], v[238:241], v[38:41]
    s_waitcnt lgkmcnt(1)
    v_mfma_f32_16x16x32_bf16 v[42:45], a[76:79], v[242:245], v[42:45]
    s_waitcnt lgkmcnt(0)
    v_mfma_f32_16x16x32_bf16 v[46:49], a[76:79], v[246:249], v[46:49]
    s_nop 1
    v_add_f32 v50, v30, v34
    v_mul_f32 v54, v30, v30
    v_add_f32 v51, v31, v35
    v_mul_f32 v55, v31, v31
    v_add_f32 v52, v32, v36
    v_mul_f32 v56, v32, v32
    v_add_f32 v53, v33, v37
    v_mul_f32 v57, v33, v33
    v_fmac_f32 v54, v34, v34
    v_fmac_f32 v55, v35, v35
    v_fmac_f32 v56, v36, v36
    v_fmac_f32 v57, v37, v37
    v_add_f32 v50, v50, v38
    v_fmac_f32 v54, v38, v38
    v_add_f32 v51, v51, v39
    v_fmac_f32 v55, v39, v39
    v_add_f32 v52, v52, v40
    v_fmac_f32 v56, v40, v40
    v_add_f32 v53, v53, v41
    v_fmac_f32 v57, v41, v41
    v_add_f32 v50, v50, v42
    v_fmac_f32 v54, v42, v42
    v_add_f32 v51, v51, v43
    v_fmac_f32 v55, v43, v43
    v_add_f32 v52, v52, v44
    v_fmac_f32 v56, v44, v44
    v_add_f32 v53, v53, v45
    v_fmac_f32 v57, v45, v45
    v_add_f32 v50, v50, v46
    v_fmac_f32 v54, v46, v46
    v_add_f32 v51, v51, v47
    v_fmac_f32 v55, v47, v47
    v_add_f32 v52, v52, v48
    v_fmac_f32 v56, v48, v48
    v_add_f32 v53, v53, v49
    v_fmac_f32 v57, v49, v49
    v_add_f32_dpp v58, v50, v50 row_ror:8 row_mask:0xf bank_mask:0xf
    v_add_f32_dpp v60, v54, v54 row_ror:8 row_mask:0xf bank_mask:0xf
    v_add_f32_dpp v59, v51, v51 row_ror:8 row_mask:0xf bank_mask:0xf
    v_add_f32_dpp v61, v55, v55 row_ror:8 row_mask:0xf bank_mask:0xf
    v_add_f32_dpp v58, v52, v52 row_ror:8 row_mask:0xf bank_mask:0xc
    v_add_f32_dpp v60, v56, v56 row_ror:8 row_mask:0xf bank_mask:0xc
    v_add_f32_dpp v59, v53, v53 row_ror:8 row_mask:0xf bank_mask:0xc
    v_add_f32_dpp v61, v57, v57 row_ror:8 row_mask:0xf bank_mask:0xc
    v_add_f32_dpp v62, v58, v58 row_half_mirror row_mask:0xf bank_mask:0xf
    v_add_f32_dpp v63, v60, v60 row_half_mirror row_mask:0xf bank_mask:0xf
    v_cvt_pk_bf16_f32 v10, v30, v31
    v_add_f32_dpp v62, v59, v59 row_half_mirror row_mask:0xf bank_mask:0xa
    v_add_f32_dpp v63, v61, v61 row_half_mirror row_mask:0xf bank_mask:0xa
    v_cvt_pk_bf16_f32 v11, v32, v33
    v_add_f32_dpp v62, v62, v62 quad_perm:[1,0,3,2] row_mask:0xf bank_mask:0xf
    v_add_f32_dpp v63, v63, v63 quad_perm:[1,0,3,2] row_mask:0xf bank_mask:0xf
    v_cvt_pk_bf16_f32 v12, v34, v35
    v_add_f32_dpp v62, v62, v62 quad_perm:[2,3,0,1] row_mask:0xf bank_mask:0xf
    v_add_f32_dpp v63, v63, v63 quad_perm:[2,3,0,1] row_mask:0xf bank_mask:0xf
    buffer_store_dwordx2 v[62:63], v26, s[12:15], s29 offen sc1
    v_cvt_pk_bf16_f32 v13, v36, v37
    v_cvt_pk_bf16_f32 v14, v38, v39
    v_cvt_pk_bf16_f32 v15, v40, v41
    v_cvt_pk_bf16_f32 v16, v42, v43
    v_cvt_pk_bf16_f32 v17, v44, v45
    v_cvt_pk_bf16_f32 v18, v46, v47
    v_cvt_pk_bf16_f32 v19, v48, v49
    s_barrier
    s_add_u32 m0, s93, 49152
    s_nop 0
    buffer_load_dwordx4 v6, s[88:91], s92 offen offset:0 lds
    buffer_load_dwordx4 v7, s[88:91], s92 offen offset:1024 lds
    buffer_load_dwordx4 v8, s[88:91], s92 offen offset:2048 lds
    buffer_load_dwordx4 v9, s[88:91], s92 offen offset:3072 lds
    s_add_u32 s92, s92, 110592
    s_cmp_eq_u32 s92, 1769472
    s_cselect_b32 s92, 0, s92
    s_mov_b32 s28, 0x40000
C_poll:
    buffer_load_dwordx2 v[90:91], v27, s[12:15], s32 offen sc1
    buffer_load_dwordx2 v[92:93], v27, s[12:15], s32 offen offset:512 sc1
    s_sub_u32 s28, s28, 1
    s_waitcnt vmcnt(1)
    v_cmp_eq_u32 vcc, -1.0, v91
    s_waitcnt vmcnt(0)
    v_cmp_eq_u32 s[40:41], -1.0, v93
    s_cbranch_scc1 C_go
    s_or_b64 vcc, vcc, s[40:41]
    s_cbranch_scc1 C_poll
C_go:
    v_add_f32 v90, v90, v92
    v_add_f32 v91, v91, v93
    s_nop 0
    v_add_f32_dpp v90, v90, v90 quad_perm:[1,0,3,2] row_mask:0xf bank_mask:0xf
    v_add_f32_dpp v91, v91, v91 quad_perm:[1,0,3,2] row_mask:0xf bank_mask:0xf
    s_nop 0
    v_add_f32_dpp v90, v90, v90 quad_perm:[2,3,0,1] row_mask:0xf bank_mask:0xf
    v_add_f32_dpp v91, v91, v91 quad_perm:[2,3,0,1] row_mask:0xf bank_mask:0xf
    v_mul_f32 v90, 0xbacccccd, v90
    v_mul_f32 v91, 0x3acccccd, v91
    v_fma_f32 v91, -v90, v90, v91
    v_max_f32 v91, 0, v91
    v_add_f32 v92, 0x3727c5ac, v91
    v_rsq_f32 v92, v92
    v_mov_b32 v20, 0x3727c5ac
    v_mul_f32 v91, v91, v92
    v_fmac_f32 v20, v91, v92
    v_rsq_f32 v20, v20
    s_nop 0
    v_mul_f32 v91, v92, v20
    v_mul_f32 v90, v90, v91
    s_nop 0
    v_mov_b32_dpp v94, v91 row_newbcast:0 row_mask:0xf bank_mask:0xf
    v_mov_b32_dpp v95, v91 row_newbcast:4 row_mask:0xf bank_mask:0xf
    v_mov_b32_dpp v96, v91 row_newbcast:8 row_mask:0xf bank_mask:0xf
    v_mov_b32_dpp v97, v91 row_newbcast:12 row_mask:0xf bank_mask:0xf
    v_mov_b32_dpp v98, v90 row_newbcast:0 row_mask:0xf bank_mask:0xf
    v_mov_b32_dpp v99, v90 row_newbcast:4 row_mask:0xf bank_mask:0xf
    v_mov_b32_dpp v100, v90 row_newbcast:8 row_mask:0xf bank_mask:0xf
    v_mov_b32_dpp v101, v90 row_newbcast:12 row_mask:0xf bank_mask:0xf
    v_pk_fma_f32 v[30:31], v[30:31], v[94:95], v[98:99]
    v_pk_fma_f32 v[32:33], v[32:33], v[96:97], v[100:101]
    v_pk_fma_f32 v[34:35], v[34:35], v[94:95], v[98:99]
    v_pk_fma_f32 v[36:37], v[36:37], v[96:97], v[100:101]
    v_pk_fma_f32 v[38:39], v[38:39], v[94:95], v[98:99]
    v_pk_fma_f32 v[40:41], v[40:41], v[96:97], v[100:101]
    v_pk_fma_f32 v[42:43], v[42:43], v[94:95], v[98:99]
    v_pk_fma_f32 v[44:45], v[44:45], v[96:97], v[100:101]
    v_pk_fma_f32 v[46:47], v[46:47], v[94:95], v[98:99]
    v_pk_fma_f32 v[48:49], v[48:49], v[96:97], v[100:101]
    v_cvt_pk_bf16_f32 v70, v30, v31
    v_cvt_pk_bf16_f32 v71, v32, v33
    v_cvt_pk_bf16_f32 v72, v34, v35
    v_cvt_pk_bf16_f32 v73, v36, v37
    v_cvt_pk_bf16_f32 v74, v38, v39
    v_cvt_pk_bf16_f32 v75, v40, v41
    v_cvt_pk_bf16_f32 v76, v42, v43
    v_cvt_pk_bf16_f32 v77, v44, v45
    v_cvt_pk_bf16_f32 v78, v46, v47
    v_cvt_pk_bf16_f32 v79, v48, v49
    v_permlane32_swap_b32 v70, v72
    v_permlane32_swap_b32 v71, v73
    buffer_store_dwordx4 v[70:73], v29, s[16:19], s33 offen offset:0 sc1
    v_permlane32_swap_b32 v74, v76
    v_permlane32_swap_b32 v75, v77
    buffer_store_dwordx4 v[74:77], v29, s[16:19], s33 offen offset:2048 sc1
    v_permlane32_swap_b32 v78, v80
    v_permlane32_swap_b32 v79, v81
    buffer_store_dwordx4 v[78:81], v28, s[16:19], s31 offen sc1
    s_load_dwordx2 s[4:5], s[0:1], 40
    s_load_dwordx2 s[24:25], s[0:1], 56
    s_load_dwordx2 s[36:37], s[0:1], 64
    s_add_u32 m0, s93, 65536
    s_nop 0
    buffer_load_dwordx4 v6, s[88:91], s92 offen offset:0 lds
    buffer_load_dwordx4 v7, s[88:91], s92 offen offset:1024 lds
    buffer_load_dwordx4 v8, s[88:91], s92 offen offset:2048 lds
    buffer_load_dwordx4 v9, s[88:91], s92 offen offset:3072 lds
    s_add_u32 s92, s92, 110592
    s_cmp_eq_u32 s92, 1769472
    s_cselect_b32 s92, 0, s92
    v_lshrrev_b32 v20, 3, v1
    v_mul_u32_u24 v20, 4096, v20
    v_lshrrev_b32 v21, 4, v1
    v_lshlrev_b32 v22, 1, v21
    v_xor_b32 v22, v22, v1
    v_and_b32 v22, 7, v22
    v_lshl_add_u32 v27, v22, 4, v20
    s_mul_i32 s28, s3, 1835008
    v_add_u32 v27, s28, v27
    s_lshl_b32 s28, s94, 7
    v_add_u32 v27, s28, v27
    v_add_u32 v28, 31744, v27
    v_add_u32 v29, 63488, v27
    v_add_u32 v30, 95232, v27
    v_xor_b32 v31, 65536, v252
    v_xor_b32 v32, 65536, v253
    v_xor_b32 v33, 65536, v254
    v_xor_b32 v34, 65536, v255
    v_xor_b32 v35, 131072, v252
    v_xor_b32 v36, 131072, v253
    v_xor_b32 v37, 131072, v254
    v_xor_b32 v38, 131072, v255
    s_add_u32 s28, s93, 32768
    v_add_u32 v39, s28, v2
    s_mul_i32 s28, s94, 0
    s_bfe_u32 s28, s28, 0x40004
    s_min_u32 s28, s28, 13
    s_lshl_b32 s31, s28, 17
    s_mul_i32 s34, s28, 40960
    s_mul_i32 s28, s99, 0
    s_bfe_u32 s28, s28, 0x40004
    s_mul_i32 s30, s28, 40960
    s_mul_i32 s28, s3, 655360
    s_mul_i32 s29, s98, 5120
    s_add_u32 s28, s28, s29
    v_add_u32 v23, s28, v2
    v_add_u32 v24, 4096, v23
    s_lshl_b32 s28, s3, 6
    s_add_u32 s28, s28, s98
    s_add_u32 s28, s28, 256
    s_lshl_b32 s28, s28, 7
    v_lshl_add_u32 v25, v1, 10, s28
    v_xor_b32 v40, 4096, v39
    v_xor_b32 v41, 8192, v39
    v_xor_b32 v42, 12288, v39
    s_mov_b32 s6, 0xd80
    s_mov_b32 s7, 0x20000
    s_mov_b32 s26, 0x1000
    s_mov_b32 s27, 0x20000
    s_add_u32 s8, s86, 0xe00000
    s_addc_u32 s9, s87, 0
    s_mov_b32 s10, 0x21c000
    s_mov_b32 s11, 0x20000
    s_waitcnt lgkmcnt(0)
    s_mov_b32 s12, s36
    s_mov_b32 s13, s37
    s_mov_b32 s14, 0x280000
    s_mov_b32 s15, 0x20000
    s_waitcnt vmcnt(4)
    s_barrier
    s_mov_b64 exec, 1
    buffer_store_dword v4, off, s[80:83], s47 sc1
    s_mov_b64 exec, -1
    s_cmp_ge_u32 s85, 27
    s_cbranch_scc1 D_skip
    s_lshl_b32 s28, s99, 7
    s_lshl_b32 s29, s3, 5
    s_add_u32 s28, s28, s29
    v_lshlrev_b32 v26, 3, v21
    buffer_load_dwordx2 v[48:49], v26, s[4:7], s28 offen
    s_add_u32 m0, s93, 81920
    s_nop 0
    buffer_load_dwordx4 v27, s[20:23], s31 offen offset:0 lds
    buffer_load_dwordx4 v28, s[20:23], s31 offen offset:1024 lds
    buffer_load_dwordx4 v29, s[20:23], s31 offen offset:2048 lds
    buffer_load_dwordx4 v30, s[20:23], s31 offen offset:3072 lds
    s_add_u32 s31, s31, 131072
    s_cmp_eq_u32 s31, 1835008
    s_cselect_b32 s31, 0, s31
    s_add_u32 m0, s93, 98304
    s_nop 0
    buffer_load_dwordx4 v27, s[20:23], s31 offen offset:0 lds
    buffer_load_dwordx4 v28, s[20:23], s31 offen offset:1024 lds
    buffer_load_dwordx4 v29, s[20:23], s31 offen offset:2048 lds
    buffer_load_dwordx4 v30, s[20:23], s31 offen offset:3072 lds
    s_add_u32 s31, s31, 131072
    s_cmp_eq_u32 s31, 1835008
    s_cselect_b32 s31, 0, s31
    ds_read_b64_tr_b16 v[210:211], v252 offset:32768
    ds_read_b64_tr_b16 v[212:213], v252 offset:33792
    ds_read_b64_tr_b16 v[214:215], v253 offset:32768
    ds_read_b64_tr_b16 v[216:217], v253 offset:33792
    ds_read_b64_tr_b16 v[218:219], v254 offset:32768
    ds_read_b64_tr_b16 v[220:221], v254 offset:33792
    ds_read_b64_tr_b16 v[222:223], v255 offset:32768
    ds_read_b64_tr_b16 v[224:225], v255 offset:33792
    ds_read_b64_tr_b16 v[226:227], v252 offset:0
    ds_read_b64_tr_b16 v[228:229], v252 offset:1024
    ds_read_b64_tr_b16 v[230:231], v253 offset:0
    ds_read_b64_tr_b16 v[232:233], v253 offset:1024
    ds_read_b64_tr_b16 v[234:235], v254 offset:0
    ds_read_b64_tr_b16 v[236:237], v254 offset:1024
    ds_read_b64_tr_b16 v[238:239], v255 offset:0
    ds_read_b64_tr_b16 v[240:241], v255 offset:1024
    s_lshr_b32 s28, s3, 1
    s_lshl1_add_u32 s28, s99, s28
    s_mul_i32 s32, s28, 40960
    s_mul_i32 s28, s98, 5120
    s_add_u32 s32, s32, s28
    s_and_b32 s28, s3, 1
    s_lshl_b32 s28, s28, 9
    s_add_u32 s32, s32, s28
    s_add_u32 s33, s32, 4096
    v_lshrrev_b32 v20, 5, v1
    v_and_b32 v22, 31, v1
    v_lshlrev_b32 v22, 4, v22
    v_lshl_add_u32 v52, v20, 10, v22
    v_lshl_add_u32 v53, v20, 30, v22
    s_lshl3_add_u32 s47, s99, s98
    s_add_u32 s47, s47, 512
    s_lshl_b32 s47, s47, 7
    s_cmp_eq_u32 s3, 0
    s_cselect_b32 s47, s47, 805306368
    s_mov_b32 exec_lo, 255
    s_mov_b32 exec_hi, 0
    s_mov_b32 s46, 0x40000
poll2:
    buffer_load_dword v5, v25, s[80:83], 0 offen sc1
    s_sub_u32 s46, s46, 1
    s_waitcnt vmcnt(0)
    v_cmp_ne_u32 vcc, v4, v5
    s_cbranch_scc1 pollx2
    s_cbranch_vccnz poll2
pollx2:
    s_mov_b64 exec, -1
    buffer_load_dwordx4 a[0:3], v23, s[16:19], s30 offen offset:0 sc1
    buffer_load_dwordx4 a[4:7], v23, s[16:19], s30 offen offset:1024 sc1
    buffer_load_dwordx4 a[8:11], v23, s[16:19], s30 offen offset:2048 sc1
    buffer_load_dwordx4 a[12:15], v23, s[16:19], s30 offen offset:3072 sc1
    buffer_load_dwordx4 a[16:19], v24, s[16:19], s30 offen offset:0 sc1
    s_add_u32 s30, s30, 40960
    buffer_load_dwordx4 a[20:23], v23, s[16:19], s30 offen offset:0 sc1
    buffer_load_dwordx4 a[24:27], v23, s[16:19], s30 offen offset:1024 sc1
    buffer_load_dwordx4 a[28:31], v23, s[16:19], s30 offen offset:2048 sc1
    buffer_load_dwordx4 a[32:35], v23, s[16:19], s30 offen offset:3072 sc1
    buffer_load_dwordx4 a[36:39], v24, s[16:19], s30 offen offset:0 sc1
    s_add_u32 s30, s30, 40960
    v_lshlrev_b32 v44, 16, v48
    v_and_b32 v45, 0xffff0000, v48
    v_lshlrev_b32 v46, 16, v49
    v_and_b32 v47, 0xffff0000, v49
    s_mov_b32 s44, 0xbdd2d3e8
    s_mov_b32 s45, s44
    v_mov_b32 v48, 0xc0135761
    v_mov_b32 v49, v48
    s_waitcnt vmcnt(9)
    v_mfma_f32_16x16x32_bf16 v[58:61], a[240:243], a[0:3], v[44:47]
    buffer_load_dwordx4 a[40:43], v23, s[16:19], s30 offen offset:0 sc1
    v_mfma_f32_16x16x32_bf16 v[78:81], a[244:247], a[0:3], 0
    v_mfma_f32_16x16x32_bf16 v[98:101], a[248:251], a[0:3], 0
    v_mfma_f32_16x16x32_bf16 v[118:121], a[252:255], a[0:3], 0
    s_waitcnt vmcnt(9)
    v_mfma_f32_16x16x32_bf16 v[62:65], a[240:243], a[4:7], v[44:47]
    buffer_load_dwordx4 a[44:47], v23, s[16:19], s30 offen offset:1024 sc1
    v_mfma_f32_16x16x32_bf16 v[82:85], a[244:247], a[4:7], 0
    v_mfma_f32_16x16x32_bf16 v[102:105], a[248:251], a[4:7], 0
    v_mfma_f32_16x16x32_bf16 v[122:125], a[252:255], a[4:7], 0
    s_waitcnt vmcnt(9)
    v_mfma_f32_16x16x32_bf16 v[66:69], a[240:243], a[8:11], v[44:47]
    buffer_load_dwordx4 a[0:3], v23, s[16:19], s30 offen offset:2048 sc1
    v_mfma_f32_16x16x32_bf16 v[86:89], a[244:247], a[8:11], 0
    v_mfma_f32_16x16x32_bf16 v[106:109], a[248:251], a[8:11], 0
    v_mfma_f32_16x16x32_bf16 v[126:129], a[252:255], a[8:11], 0
    s_waitcnt vmcnt(9)
    v_mfma_f32_16x16x32_bf16 v[70:73], a[240:243], a[12:15], v[44:47]
    buffer_load_dwordx4 a[4:7], v23, s[16:19], s30 offen offset:3072 sc1
    v_mfma_f32_16x16x32_bf16 v[90:93], a[244:247], a[12:15], 0
    v_mfma_f32_16x16x32_bf16 v[110:113], a[248:251], a[12:15], 0
    v_mfma_f32_16x16x32_bf16 v[130:133], a[252:255], a[12:15], 0
    s_waitcnt vmcnt(9)
    v_mfma_f32_16x16x32_bf16 v[74:77], a[240:243], a[16:19], v[44:47]
    buffer_load_dwordx4 a[8:11], v24, s[16:19], s30 offen offset:0 sc1
    v_mfma_f32_16x16x32_bf16 v[94:97], a[244:247], a[16:19], 0
    v_mfma_f32_16x16x32_bf16 v[114:117], a[248:251], a[16:19], 0
    s_add_u32 s30, s30, 40960
    v_mfma_f32_16x16x32_bf16 v[134:137], a[252:255], a[16:19], 0
    s_waitcnt vmcnt(9)
    v_mfma_f32_16x16x32_bf16 v[58:61], a[224:227], a[20:23], v[58:61]
    buffer_load_dwordx4 a[12:15], v23, s[16:19], s30 offen offset:0 sc1
    v_mfma_f32_16x16x32_bf16 v[78:81], a[228:231], a[20:23], v[78:81]
    v_mfma_f32_16x16x32_bf16 v[98:101], a[232:235], a[20:23], v[98:101]
    v_mfma_f32_16x16x32_bf16 v[118:121], a[236:239], a[20:23], v[118:121]
    s_waitcnt vmcnt(9)
    v_mfma_f32_16x16x32_bf16 v[62:65], a[224:227], a[24:27], v[62:65]
    buffer_load_dwordx4 a[16:19], v23, s[16:19], s30 offen offset:1024 sc1
    v_mfma_f32_16x16x32_bf16 v[82:85], a[228:231], a[24:27], v[82:85]
    ds_read_b64_tr_b16 a[240:241], v252 offset:16384
    v_mfma_f32_16x16x32_bf16 v[102:105], a[232:235], a[24:27], v[102:105]
    ds_read_b64_tr_b16 a[242:243], v252 offset:17408
    v_mfma_f32_16x16x32_bf16 v[122:125], a[236:239], a[24:27], v[122:125]
    s_waitcnt vmcnt(9)
    v_mfma_f32_16x16x32_bf16 v[66:69], a[224:227], a[28:31], v[66:69]
    buffer_load_dwordx4 a[20:23], v23, s[16:19], s30 offen offset:2048 sc1
    v_mfma_f32_16x16x32_bf16 v[86:89], a[228:231], a[28:31], v[86:89]
    ds_read_b64_tr_b16 a[244:245], v253 offset:16384
    v_mfma_f32_16x16x32_bf16 v[106:109], a[232:235], a[28:31], v[106:109]
    ds_read_b64_tr_b16 a[246:247], v253 offset:17408
    v_mfma_f32_16x16x32_bf16 v[126:129], a[236:239], a[28:31], v[126:129]
    s_waitcnt vmcnt(9)
    v_mfma_f32_16x16x32_bf16 v[70:73], a[224:227], a[32:35], v[70:73]
    buffer_load_dwordx4 a[24:27], v23, s[16:19], s30 offen offset:3072 sc1
    v_mfma_f32_16x16x32_bf16 v[90:93], a[228:231], a[32:35], v[90:93]
    ds_read_b64_tr_b16 a[248:249], v254 offset:16384
    v_mfma_f32_16x16x32_bf16 v[110:113], a[232:235], a[32:35], v[110:113]
    ds_read_b64_tr_b16 a[250:251], v254 offset:17408
    v_mfma_f32_16x16x32_bf16 v[130:133], a[236:239], a[32:35], v[130:133]
    s_waitcnt vmcnt(9)
    v_mfma_f32_16x16x32_bf16 v[74:77], a[224:227], a[36:39], v[74:77]
    buffer_load_dwordx4 a[28:31], v24, s[16:19], s30 offen offset:0 sc1
    v_mfma_f32_16x16x32_bf16 v[94:97], a[228:231], a[36:39], v[94:97]
    s_add_u32 s30, s30, 40960
    v_mfma_f32_16x16x32_bf16 v[114:117], a[232:235], a[36:39], v[114:117]
    ds_read_b64_tr_b16 a[252:253], v255 offset:16384
    v_mfma_f32_16x16x32_bf16 v[134:137], a[236:239], a[36:39], v[134:137]
    ds_read_b64_tr_b16 a[254:255], v255 offset:17408
    s_waitcnt vmcnt(9)
    v_mfma_f32_16x16x32_bf16 v[58:61], a[208:211], a[40:43], v[58:61]
    buffer_load_dwordx4 a[32:35], v23, s[16:19], s30 offen offset:0 sc1
    v_mfma_f32_16x16x32_bf16 v[78:81], a[212:215], a[40:43], v[78:81]
    v_mfma_f32_16x16x32_bf16 v[98:101], a[216:219], a[40:43], v[98:101]
    v_mfma_f32_16x16x32_bf16 v[118:121], a[220:223], a[40:43], v[118:121]
    s_waitcnt vmcnt(9)
    v_mfma_f32_16x16x32_bf16 v[62:65], a[208:211], a[44:47], v[62:65]
    buffer_load_dwordx4 a[36:39], v23, s[16:19], s30 offen offset:1024 sc1
    v_mfma_f32_16x16x32_bf16 v[82:85], a[212:215], a[44:47], v[82:85]
    ds_read_b64_tr_b16 a[224:225], v252 offset:49152
    v_mfma_f32_16x16x32_bf16 v[102:105], a[216:219], a[44:47], v[102:105]
    ds_read_b64_tr_b16 a[226:227], v252 offset:50176
    v_mfma_f32_16x16x32_bf16 v[122:125], a[220:223], a[44:47], v[122:125]
    s_waitcnt vmcnt(9)
    v_mfma_f32_16x16x32_bf16 v[66:69], a[208:211], a[0:3], v[66:69]
    buffer_load_dwordx4 a[40:43], v23, s[16:19], s30 offen offset:2048 sc1
    v_mfma_f32_16x16x32_bf16 v[86:89], a[212:215], a[0:3], v[86:89]
    ds_read_b64_tr_b16 a[228:229], v253 offset:49152
    v_mfma_f32_16x16x32_bf16 v[106:109], a[216:219], a[0:3], v[106:109]
    ds_read_b64_tr_b16 a[230:231], v253 offset:50176
    v_mfma_f32_16x16x32_bf16 v[126:129], a[220:223], a[0:3], v[126:129]
    s_waitcnt vmcnt(9)
    v_mfma_f32_16x16x32_bf16 v[70:73], a[208:211], a[4:7], v[70:73]
    buffer_load_dwordx4 a[44:47], v23, s[16:19], s30 offen offset:3072 sc1
    v_mfma_f32_16x16x32_bf16 v[90:93], a[212:215], a[4:7], v[90:93]
    ds_read_b64_tr_b16 a[232:233], v254 offset:49152
    v_mfma_f32_16x16x32_bf16 v[110:113], a[216:219], a[4:7], v[110:113]
    ds_read_b64_tr_b16 a[234:235], v254 offset:50176
    v_mfma_f32_16x16x32_bf16 v[130:133], a[220:223], a[4:7], v[130:133]
    s_waitcnt vmcnt(9)
    v_mfma_f32_16x16x32_bf16 v[74:77], a[208:211], a[8:11], v[74:77]
    buffer_load_dwordx4 a[0:3], v24, s[16:19], s30 offen offset:0 sc1
    v_mfma_f32_16x16x32_bf16 v[94:97], a[212:215], a[8:11], v[94:97]
    s_add_u32 s30, s30, 40960
    v_mfma_f32_16x16x32_bf16 v[114:117], a[216:219], a[8:11], v[114:117]
    ds_read_b64_tr_b16 a[236:237], v255 offset:49152
    v_mfma_f32_16x16x32_bf16 v[134:137], a[220:223], a[8:11], v[134:137]
    ds_read_b64_tr_b16 a[238:239], v255 offset:50176
    s_waitcnt vmcnt(9)
    v_mfma_f32_16x16x32_bf16 v[58:61], a[192:195], a[12:15], v[58:61]
    buffer_load_dwordx4 a[4:7], v23, s[16:19], s30 offen offset:0 sc1
    v_mfma_f32_16x16x32_bf16 v[78:81], a[196:199], a[12:15], v[78:81]
    v_mfma_f32_16x16x32_bf16 v[98:101], a[200:203], a[12:15], v[98:101]
    v_mfma_f32_16x16x32_bf16 v[118:121], a[204:207], a[12:15], v[118:121]
    s_waitcnt vmcnt(9)
    v_mfma_f32_16x16x32_bf16 v[62:65], a[192:195], a[16:19], v[62:65]
    buffer_load_dwordx4 a[8:11], v23, s[16:19], s30 offen offset:1024 sc1
    v_mfma_f32_16x16x32_bf16 v[82:85], a[196:199], a[16:19], v[82:85]
    ds_read_b64_tr_b16 a[208:209], v31 offset:0
    v_mfma_f32_16x16x32_bf16 v[102:105], a[200:203], a[16:19], v[102:105]
    ds_read_b64_tr_b16 a[210:211], v31 offset:1024
    v_mfma_f32_16x16x32_bf16 v[122:125], a[204:207], a[16:19], v[122:125]
    s_waitcnt vmcnt(9)
    v_mfma_f32_16x16x32_bf16 v[66:69], a[192:195], a[20:23], v[66:69]
    buffer_load_dwordx4 a[12:15], v23, s[16:19], s30 offen offset:2048 sc1
    v_mfma_f32_16x16x32_bf16 v[86:89], a[196:199], a[20:23], v[86:89]
    ds_read_b64_tr_b16 a[212:213], v32 offset:0
    v_mfma_f32_16x16x32_bf16 v[106:109], a[200:203], a[20:23], v[106:109]
    ds_read_b64_tr_b16 a[214:215], v32 offset:1024
    v_mfma_f32_16x16x32_bf16 v[126:129], a[204:207], a[20:23], v[126:129]
    s_waitcnt vmcnt(9)
    v_mfma_f32_16x16x32_bf16 v[70:73], a[192:195], a[24:27], v[70:73]
    buffer_load_dwordx4 a[16:19], v23, s[16:19], s30 offen offset:3072 sc1
    v_mfma_f32_16x16x32_bf16 v[90:93], a[196:199], a[24:27], v[90:93]
    ds_read_b64_tr_b16 a[216:217], v33 offset:0
    v_mfma_f32_16x16x32_bf16 v[110:113], a[200:203], a[24:27], v[110:113]
    ds_read_b64_tr_b16 a[218:219], v33 offset:1024
    v_mfma_f32_16x16x32_bf16 v[130:133], a[204:207], a[24:27], v[130:133]
    s_waitcnt vmcnt(9)
    v_mfma_f32_16x16x32_bf16 v[74:77], a[192:195], a[28:31], v[74:77]
    buffer_load_dwordx4 a[20:23], v24, s[16:19], s30 offen offset:0 sc1
    v_mfma_f32_16x16x32_bf16 v[94:97], a[196:199], a[28:31], v[94:97]
    s_add_u32 s30, s30, 40960
    v_mfma_f32_16x16x32_bf16 v[114:117], a[200:203], a[28:31], v[114:117]
    ds_read_b64_tr_b16 a[220:221], v34 offset:0
    v_mfma_f32_16x16x32_bf16 v[134:137], a[204:207], a[28:31], v[134:137]
    ds_read_b64_tr_b16 a[222:223], v34 offset:1024
    s_waitcnt vmcnt(9)
    v_mfma_f32_16x16x32_bf16 v[58:61], a[176:179], a[32:35], v[58:61]
    buffer_load_dwordx4 a[24:27], v23, s[16:19], s30 offen offset:0 sc1
    v_mfma_f32_16x16x32_bf16 v[78:81], a[180:183], a[32:35], v[78:81]
    v_mfma_f32_16x16x32_bf16 v[98:101], a[184:187], a[32:35], v[98:101]
    v_mfma_f32_16x16x32_bf16 v[118:121], a[188:191], a[32:35], v[118:121]
    s_waitcnt vmcnt(9)
    v_mfma_f32_16x16x32_bf16 v[62:65], a[176:179], a[36:39], v[62:65]
    buffer_load_dwordx4 a[28:31], v23, s[16:19], s30 offen offset:1024 sc1
    v_mfma_f32_16x16x32_bf16 v[82:85], a[180:183], a[36:39], v[82:85]
    ds_read_b64_tr_b16 a[192:193], v31 offset:16384
    v_mfma_f32_16x16x32_bf16 v[102:105], a[184:187], a[36:39], v[102:105]
    ds_read_b64_tr_b16 a[194:195], v31 offset:17408
    v_mfma_f32_16x16x32_bf16 v[122:125], a[188:191], a[36:39], v[122:125]
    s_waitcnt vmcnt(9)
    v_mfma_f32_16x16x32_bf16 v[66:69], a[176:179], a[40:43], v[66:69]
    buffer_load_dwordx4 a[32:35], v23, s[16:19], s30 offen offset:2048 sc1
    v_mfma_f32_16x16x32_bf16 v[86:89], a[180:183], a[40:43], v[86:89]
    ds_read_b64_tr_b16 a[196:197], v32 offset:16384
    v_mfma_f32_16x16x32_bf16 v[106:109], a[184:187], a[40:43], v[106:109]
    ds_read_b64_tr_b16 a[198:199], v32 offset:17408
    v_mfma_f32_16x16x32_bf16 v[126:129], a[188:191], a[40:43], v[126:129]
    s_waitcnt vmcnt(9)
    v_mfma_f32_16x16x32_bf16 v[70:73], a[176:179], a[44:47], v[70:73]
    buffer_load_dwordx4 a[36:39], v23, s[16:19], s30 offen offset:3072 sc1
    v_mfma_f32_16x16x32_bf16 v[90:93], a[180:183], a[44:47], v[90:93]
    ds_read_b64_tr_b16 a[200:201], v33 offset:16384
    v_mfma_f32_16x16x32_bf16 v[110:113], a[184:187], a[44:47], v[110:113]
    ds_read_b64_tr_b16 a[202:203], v33 offset:17408
    v_mfma_f32_16x16x32_bf16 v[130:133], a[188:191], a[44:47], v[130:133]
    s_waitcnt vmcnt(9)
    v_mfma_f32_16x16x32_bf16 v[74:77], a[176:179], a[0:3], v[74:77]
    buffer_load_dwordx4 a[40:43], v24, s[16:19], s30 offen offset:0 sc1
    v_mfma_f32_16x16x32_bf16 v[94:97], a[180:183], a[0:3], v[94:97]
    s_add_u32 s30, s30, 40960
    v_mfma_f32_16x16x32_bf16 v[114:117], a[184:187], a[0:3], v[114:117]
    ds_read_b64_tr_b16 a[204:205], v34 offset:16384
    v_mfma_f32_16x16x32_bf16 v[134:137], a[188:191], a[0:3], v[134:137]
    ds_read_b64_tr_b16 a[206:207], v34 offset:17408
    s_waitcnt vmcnt(9)
    v_mfma_f32_16x16x32_bf16 v[58:61], a[160:163], a[4:7], v[58:61]
    buffer_load_dwordx4 a[44:47], v23, s[16:19], s30 offen offset:0 sc1
    v_mfma_f32_16x16x32_bf16 v[78:81], a[164:167], a[4:7], v[78:81]
    v_mfma_f32_16x16x32_bf16 v[98:101], a[168:171], a[4:7], v[98:101]
    v_mfma_f32_16x16x32_bf16 v[118:121], a[172:175], a[4:7], v[118:121]
    s_waitcnt vmcnt(9)
    v_mfma_f32_16x16x32_bf16 v[62:65], a[160:163], a[8:11], v[62:65]
    buffer_load_dwordx4 a[0:3], v23, s[16:19], s30 offen offset:1024 sc1
    v_mfma_f32_16x16x32_bf16 v[82:85], a[164:167], a[8:11], v[82:85]
    ds_read_b64_tr_b16 a[176:177], v31 offset:32768
    v_mfma_f32_16x16x32_bf16 v[102:105], a[168:171], a[8:11], v[102:105]
    ds_read_b64_tr_b16 a[178:179], v31 offset:33792
    v_mfma_f32_16x16x32_bf16 v[122:125], a[172:175], a[8:11], v[122:125]
    s_waitcnt vmcnt(9)
    v_mfma_f32_16x16x32_bf16 v[66:69], a[160:163], a[12:15], v[66:69]
    buffer_load_dwordx4 a[4:7], v23, s[16:19], s30 offen offset:2048 sc1
    v_mfma_f32_16x16x32_bf16 v[86:89], a[164:167], a[12:15], v[86:89]
    ds_read_b64_tr_b16 a[180:181], v32 offset:32768
    v_mfma_f32_16x16x32_bf16 v[106:109], a[168:171], a[12:15], v[106:109]
    ds_read_b64_tr_b16 a[182:183], v32 offset:33792
    v_mfma_f32_16x16x32_bf16 v[126:129], a[172:175], a[12:15], v[126:129]
    s_waitcnt vmcnt(9)
    v_mfma_f32_16x16x32_bf16 v[70:73], a[160:163], a[16:19], v[70:73]
    buffer_load_dwordx4 a[8:11], v23, s[16:19], s30 offen offset:3072 sc1
    v_mfma_f32_16x16x32_bf16 v[90:93], a[164:167], a[16:19], v[90:93]
    ds_read_b64_tr_b16 a[184:185], v33 offset:32768
    v_mfma_f32_16x16x32_bf16 v[110:113], a[168:171], a[16:19], v[110:113]
    ds_read_b64_tr_b16 a[186:187], v33 offset:33792
    v_mfma_f32_16x16x32_bf16 v[130:133], a[172:175], a[16:19], v[130:133]
    s_waitcnt vmcnt(9)
    v_mfma_f32_16x16x32_bf16 v[74:77], a[160:163], a[20:23], v[74:77]
    buffer_load_dwordx4 a[12:15], v24, s[16:19], s30 offen offset:0 sc1
    v_mfma_f32_16x16x32_bf16 v[94:97], a[164:167], a[20:23], v[94:97]
    s_add_u32 s30, s30, 40960
    v_mfma_f32_16x16x32_bf16 v[114:117], a[168:171], a[20:23], v[114:117]
    ds_read_b64_tr_b16 a[188:189], v34 offset:32768
    v_mfma_f32_16x16x32_bf16 v[134:137], a[172:175], a[20:23], v[134:137]
    ds_read_b64_tr_b16 a[190:191], v34 offset:33792
    s_waitcnt vmcnt(9)
    v_mfma_f32_16x16x32_bf16 v[58:61], a[144:147], a[24:27], v[58:61]
    buffer_load_dwordx4 a[16:19], v23, s[16:19], s30 offen offset:0 sc1
    v_mfma_f32_16x16x32_bf16 v[78:81], a[148:151], a[24:27], v[78:81]
    v_mfma_f32_16x16x32_bf16 v[98:101], a[152:155], a[24:27], v[98:101]
    v_mfma_f32_16x16x32_bf16 v[118:121], a[156:159], a[24:27], v[118:121]
    s_waitcnt vmcnt(9)
    v_mfma_f32_16x16x32_bf16 v[62:65], a[144:147], a[28:31], v[62:65]
    buffer_load_dwordx4 a[20:23], v23, s[16:19], s30 offen offset:1024 sc1
    v_mfma_f32_16x16x32_bf16 v[82:85], a[148:151], a[28:31], v[82:85]
    v_mfma_f32_16x16x32_bf16 v[102:105], a[152:155], a[28:31], v[102:105]
    v_mfma_f32_16x16x32_bf16 v[122:125], a[156:159], a[28:31], v[122:125]
    s_waitcnt vmcnt(9)
    v_mfma_f32_16x16x32_bf16 v[66:69], a[144:147], a[32:35], v[66:69]
    buffer_load_dwordx4 a[24:27], v23, s[16:19], s30 offen offset:2048 sc1
    v_mfma_f32_16x16x32_bf16 v[86:89], a[148:151], a[32:35], v[86:89]
    v_mfma_f32_16x16x32_bf16 v[106:109], a[152:155], a[32:35], v[106:109]
    v_mfma_f32_16x16x32_bf16 v[126:129], a[156:159], a[32:35], v[126:129]
    s_waitcnt vmcnt(9)
    v_mfma_f32_16x16x32_bf16 v[70:73], a[144:147], a[36:39], v[70:73]
    buffer_load_dwordx4 a[28:31], v23, s[16:19], s30 offen offset:3072 sc1
    v_mfma_f32_16x16x32_bf16 v[90:93], a[148:151], a[36:39], v[90:93]
    v_mfma_f32_16x16x32_bf16 v[110:113], a[152:155], a[36:39], v[110:113]
    v_mfma_f32_16x16x32_bf16 v[130:133], a[156:159], a[36:39], v[130:133]
    s_waitcnt vmcnt(9)
    v_mfma_f32_16x16x32_bf16 v[74:77], a[144:147], a[40:43], v[74:77]
    buffer_load_dwordx4 a[32:35], v24, s[16:19], s30 offen offset:0 sc1
    v_mfma_f32_16x16x32_bf16 v[94:97], a[148:151], a[40:43], v[94:97]
    v_mfma_f32_16x16x32_bf16 v[114:117], a[152:155], a[40:43], v[114:117]
    s_add_u32 s30, s30, 40960
    v_mfma_f32_16x16x32_bf16 v[134:137], a[156:159], a[40:43], v[134:137]
    s_waitcnt vmcnt(9)
    v_mfma_f32_16x16x32_bf16 v[58:61], a[128:131], a[44:47], v[58:61]
    buffer_load_dwordx4 a[36:39], v23, s[16:19], s30 offen offset:0 sc1
    v_mfma_f32_16x16x32_bf16 v[78:81], a[132:135], a[44:47], v[78:81]
    v_mfma_f32_16x16x32_bf16 v[98:101], a[136:139], a[44:47], v[98:101]
    v_mfma_f32_16x16x32_bf16 v[118:121], a[140:143], a[44:47], v[118:121]
    s_waitcnt vmcnt(9)
    v_mfma_f32_16x16x32_bf16 v[62:65], a[128:131], a[0:3], v[62:65]
    buffer_load_dwordx4 a[40:43], v23, s[16:19], s30 offen offset:1024 sc1
    v_mfma_f32_16x16x32_bf16 v[82:85], a[132:135], a[0:3], v[82:85]
    v_mfma_f32_16x16x32_bf16 v[102:105], a[136:139], a[0:3], v[102:105]
    v_mfma_f32_16x16x32_bf16 v[122:125], a[140:143], a[0:3], v[122:125]
    s_waitcnt vmcnt(9)
    v_mfma_f32_16x16x32_bf16 v[66:69], a[128:131], a[4:7], v[66:69]
    buffer_load_dwordx4 a[44:47], v23, s[16:19], s30 offen offset:2048 sc1
    v_mfma_f32_16x16x32_bf16 v[86:89], a[132:135], a[4:7], v[86:89]
    v_mfma_f32_16x16x32_bf16 v[106:109], a[136:139], a[4:7], v[106:109]
    v_mfma_f32_16x16x32_bf16 v[126:129], a[140:143], a[4:7], v[126:129]
    s_waitcnt vmcnt(9)
    v_mfma_f32_16x16x32_bf16 v[70:73], a[128:131], a[8:11], v[70:73]
    buffer_load_dwordx4 a[0:3], v23, s[16:19], s30 offen offset:3072 sc1
    v_mfma_f32_16x16x32_bf16 v[90:93], a[132:135], a[8:11], v[90:93]
    v_mfma_f32_16x16x32_bf16 v[110:113], a[136:139], a[8:11], v[110:113]
    v_mfma_f32_16x16x32_bf16 v[130:133], a[140:143], a[8:11], v[130:133]
    s_waitcnt vmcnt(9)
    v_mfma_f32_16x16x32_bf16 v[74:77], a[128:131], a[12:15], v[74:77]
    buffer_load_dwordx4 a[4:7], v24, s[16:19], s30 offen offset:0 sc1
    v_mfma_f32_16x16x32_bf16 v[94:97], a[132:135], a[12:15], v[94:97]
    v_mfma_f32_16x16x32_bf16 v[114:117], a[136:139], a[12:15], v[114:117]
    s_add_u32 s30, s30, 40960
    v_mfma_f32_16x16x32_bf16 v[134:137], a[140:143], a[12:15], v[134:137]
    s_waitcnt vmcnt(9)
    v_mfma_f32_16x16x32_bf16 v[58:61], a[112:115], a[16:19], v[58:61]
    buffer_load_dwordx4 a[8:11], v23, s[16:19], s30 offen offset:0 sc1
    v_mfma_f32_16x16x32_bf16 v[78:81], a[116:119], a[16:19], v[78:81]
    v_mfma_f32_16x16x32_bf16 v[98:101], a[120:123], a[16:19], v[98:101]
    v_mfma_f32_16x16x32_bf16 v[118:121], a[124:127], a[16:19], v[118:121]
    s_waitcnt vmcnt(9)
    v_mfma_f32_16x16x32_bf16 v[62:65], a[112:115], a[20:23], v[62:65]
    buffer_load_dwordx4 a[12:15], v23, s[16:19], s30 offen offset:1024 sc1
    v_mfma_f32_16x16x32_bf16 v[82:85], a[116:119], a[20:23], v[82:85]
    v_mfma_f32_16x16x32_bf16 v[102:105], a[120:123], a[20:23], v[102:105]
    v_mfma_f32_16x16x32_bf16 v[122:125], a[124:127], a[20:23], v[122:125]
    s_waitcnt vmcnt(9)
    v_mfma_f32_16x16x32_bf16 v[66:69], a[112:115], a[24:27], v[66:69]
    buffer_load_dwordx4 a[16:19], v23, s[16:19], s30 offen offset:2048 sc1
    v_mfma_f32_16x16x32_bf16 v[86:89], a[116:119], a[24:27], v[86:89]
    v_mfma_f32_16x16x32_bf16 v[106:109], a[120:123], a[24:27], v[106:109]
    v_mfma_f32_16x16x32_bf16 v[126:129], a[124:127], a[24:27], v[126:129]
    s_waitcnt vmcnt(9)
    v_mfma_f32_16x16x32_bf16 v[70:73], a[112:115], a[28:31], v[70:73]
    buffer_load_dwordx4 a[20:23], v23, s[16:19], s30 offen offset:3072 sc1
    v_mfma_f32_16x16x32_bf16 v[90:93], a[116:119], a[28:31], v[90:93]
    v_mfma_f32_16x16x32_bf16 v[110:113], a[120:123], a[28:31], v[110:113]
    v_mfma_f32_16x16x32_bf16 v[130:133], a[124:127], a[28:31], v[130:133]
    s_waitcnt vmcnt(9)
    v_mfma_f32_16x16x32_bf16 v[74:77], a[112:115], a[32:35], v[74:77]
    buffer_load_dwordx4 a[24:27], v24, s[16:19], s30 offen offset:0 sc1
    v_mfma_f32_16x16x32_bf16 v[94:97], a[116:119], a[32:35], v[94:97]
    v_mfma_f32_16x16x32_bf16 v[114:117], a[120:123], a[32:35], v[114:117]
    s_add_u32 s30, s30, 40960
    v_mfma_f32_16x16x32_bf16 v[134:137], a[124:127], a[32:35], v[134:137]
    s_waitcnt vmcnt(9)
    v_mfma_f32_16x16x32_bf16 v[58:61], a[96:99], a[36:39], v[58:61]
    buffer_load_dwordx4 a[28:31], v23, s[16:19], s30 offen offset:0 sc1
    v_mfma_f32_16x16x32_bf16 v[78:81], a[100:103], a[36:39], v[78:81]
    v_mfma_f32_16x16x32_bf16 v[98:101], a[104:107], a[36:39], v[98:101]
    v_mfma_f32_16x16x32_bf16 v[118:121], a[108:111], a[36:39], v[118:121]
    s_waitcnt vmcnt(9)
    v_mfma_f32_16x16x32_bf16 v[62:65], a[96:99], a[40:43], v[62:65]
    buffer_load_dwordx4 a[32:35], v23, s[16:19], s30 offen offset:1024 sc1
    v_mfma_f32_16x16x32_bf16 v[82:85], a[100:103], a[40:43], v[82:85]
    v_mfma_f32_16x16x32_bf16 v[102:105], a[104:107], a[40:43], v[102:105]
    v_mfma_f32_16x16x32_bf16 v[122:125], a[108:111], a[40:43], v[122:125]
    s_waitcnt vmcnt(9)
    v_mfma_f32_16x16x32_bf16 v[66:69], a[96:99], a[44:47], v[66:69]
    buffer_load_dwordx4 a[36:39], v23, s[16:19], s30 offen offset:2048 sc1
    v_mfma_f32_16x16x32_bf16 v[86:89], a[100:103], a[44:47], v[86:89]
    v_mfma_f32_16x16x32_bf16 v[106:109], a[104:107], a[44:47], v[106:109]
    v_mfma_f32_16x16x32_bf16 v[126:129], a[108:111], a[44:47], v[126:129]
    s_waitcnt vmcnt(9)
    v_mfma_f32_16x16x32_bf16 v[70:73], a[96:99], a[0:3], v[70:73]
    buffer_load_dwordx4 a[40:43], v23, s[16:19], s30 offen offset:3072 sc1
    v_mfma_f32_16x16x32_bf16 v[90:93], a[100:103], a[0:3], v[90:93]
    v_mfma_f32_16x16x32_bf16 v[110:113], a[104:107], a[0:3], v[110:113]
    v_mfma_f32_16x16x32_bf16 v[130:133], a[108:111], a[0:3], v[130:133]
    s_waitcnt vmcnt(9)
    v_mfma_f32_16x16x32_bf16 v[74:77], a[96:99], a[4:7], v[74:77]
    buffer_load_dwordx4 a[44:47], v24, s[16:19], s30 offen offset:0 sc1
    v_mfma_f32_16x16x32_bf16 v[94:97], a[100:103], a[4:7], v[94:97]
    v_mfma_f32_16x16x32_bf16 v[114:117], a[104:107], a[4:7], v[114:117]
    s_add_u32 s30, s30, 40960
    v_mfma_f32_16x16x32_bf16 v[134:137], a[108:111], a[4:7], v[134:137]
    s_waitcnt vmcnt(9)
    v_mfma_f32_16x16x32_bf16 v[58:61], a[80:83], a[8:11], v[58:61]
    buffer_load_dwordx4 a[0:3], v23, s[16:19], s30 offen offset:0 sc1
    v_mfma_f32_16x16x32_bf16 v[78:81], a[84:87], a[8:11], v[78:81]
    v_mfma_f32_16x16x32_bf16 v[98:101], a[88:91], a[8:11], v[98:101]
    v_mfma_f32_16x16x32_bf16 v[118:121], a[92:95], a[8:11], v[118:121]
    s_waitcnt vmcnt(9)
    v_mfma_f32_16x16x32_bf16 v[62:65], a[80:83], a[12:15], v[62:65]
    buffer_load_dwordx4 a[4:7], v23, s[16:19], s30 offen offset:1024 sc1
    v_mfma_f32_16x16x32_bf16 v[82:85], a[84:87], a[12:15], v[82:85]
    v_mfma_f32_16x16x32_bf16 v[102:105], a[88:91], a[12:15], v[102:105]
    v_mfma_f32_16x16x32_bf16 v[122:125], a[92:95], a[12:15], v[122:125]
    s_waitcnt vmcnt(9)
    v_mfma_f32_16x16x32_bf16 v[66:69], a[80:83], a[16:19], v[66:69]
    buffer_load_dwordx4 a[8:11], v23, s[16:19], s30 offen offset:2048 sc1
    v_mfma_f32_16x16x32_bf16 v[86:89], a[84:87], a[16:19], v[86:89]
    v_mfma_f32_16x16x32_bf16 v[106:109], a[88:91], a[16:19], v[106:109]
    v_mfma_f32_16x16x32_bf16 v[126:129], a[92:95], a[16:19], v[126:129]
    s_waitcnt vmcnt(9)
    v_mfma_f32_16x16x32_bf16 v[70:73], a[80:83], a[20:23], v[70:73]
    buffer_load_dwordx4 a[12:15], v23, s[16:19], s30 offen offset:3072 sc1
    v_mfma_f32_16x16x32_bf16 v[90:93], a[84:87], a[20:23], v[90:93]
    v_mfma_f32_16x16x32_bf16 v[110:113], a[88:91], a[20:23], v[110:113]
    v_mfma_f32_16x16x32_bf16 v[130:133], a[92:95], a[20:23], v[130:133]
    s_waitcnt vmcnt(9)
    v_mfma_f32_16x16x32_bf16 v[74:77], a[80:83], a[24:27], v[74:77]
    buffer_load_dwordx4 a[16:19], v24, s[16:19], s30 offen offset:0 sc1
    v_mfma_f32_16x16x32_bf16 v[94:97], a[84:87], a[24:27], v[94:97]
    v_mfma_f32_16x16x32_bf16 v[114:117], a[88:91], a[24:27], v[114:117]
    s_add_u32 s30, s30, 40960
    v_mfma_f32_16x16x32_bf16 v[134:137], a[92:95], a[24:27], v[134:137]
    s_waitcnt vmcnt(9) lgkmcnt(15)
    v_mfma_f32_16x16x32_bf16 v[58:61], v[210:213], a[28:31], v[58:61]
    buffer_load_dwordx4 a[20:23], v23, s[16:19], s30 offen offset:0 sc1
    v_mfma_f32_16x16x32_bf16 v[78:81], v[214:217], a[28:31], v[78:81]
    v_mfma_f32_16x16x32_bf16 v[98:101], v[218:221], a[28:31], v[98:101]
    v_mfma_f32_16x16x32_bf16 v[118:121], v[222:225], a[28:31], v[118:121]
    s_waitcnt vmcnt(9)
    v_mfma_f32_16x16x32_bf16 v[62:65], v[210:213], a[32:35], v[62:65]
    buffer_load_dwordx4 a[24:27], v23, s[16:19], s30 offen offset:1024 sc1
    v_mfma_f32_16x16x32_bf16 v[82:85], v[214:217], a[32:35], v[82:85]
    v_mfma_f32_16x16x32_bf16 v[102:105], v[218:221], a[32:35], v[102:105]
    v_mfma_f32_16x16x32_bf16 v[122:125], v[222:225], a[32:35], v[122:125]
    s_waitcnt vmcnt(9)
    v_mfma_f32_16x16x32_bf16 v[66:69], v[210:213], a[36:39], v[66:69]
    buffer_load_dwordx4 a[28:31], v23, s[16:19], s30 offen offset:2048 sc1
    v_mfma_f32_16x16x32_bf16 v[86:89], v[214:217], a[36:39], v[86:89]
    v_mfma_f32_16x16x32_bf16 v[106:109], v[218:221], a[36:39], v[106:109]
    v_mfma_f32_16x16x32_bf16 v[126:129], v[222:225], a[36:39], v[126:129]
    s_waitcnt vmcnt(9)
    v_mfma_f32_16x16x32_bf16 v[70:73], v[210:213], a[40:43], v[70:73]
    buffer_load_dwordx4 a[32:35], v23, s[16:19], s30 offen offset:3072 sc1
    v_mfma_f32_16x16x32_bf16 v[90:93], v[214:217], a[40:43], v[90:93]
    v_mfma_f32_16x16x32_bf16 v[110:113], v[218:221], a[40:43], v[110:113]
    v_mfma_f32_16x16x32_bf16 v[130:133], v[222:225], a[40:43], v[130:133]
    s_waitcnt vmcnt(9)
    v_mfma_f32_16x16x32_bf16 v[74:77], v[210:213], a[44:47], v[74:77]
    buffer_load_dwordx4 a[36:39], v24, s[16:19], s30 offen offset:0 sc1
    v_mfma_f32_16x16x32_bf16 v[94:97], v[214:217], a[44:47], v[94:97]
    v_mfma_f32_16x16x32_bf16 v[114:117], v[218:221], a[44:47], v[114:117]
    s_add_u32 s30, s30, 40960
    v_mfma_f32_16x16x32_bf16 v[134:137], v[222:225], a[44:47], v[134:137]
    s_waitcnt vmcnt(9)
    v_mfma_f32_16x16x32_bf16 v[58:61], v[226:229], a[0:3], v[58:61]
    buffer_load_dwordx4 a[40:43], v23, s[16:19], s30 offen offset:0 sc1
    v_mfma_f32_16x16x32_bf16 v[78:81], v[230:233], a[0:3], v[78:81]
    v_mfma_f32_16x16x32_bf16 v[98:101], v[234:237], a[0:3], v[98:101]
    v_mfma_f32_16x16x32_bf16 v[118:121], v[238:241], a[0:3], v[118:121]
    s_waitcnt vmcnt(9)
    v_mfma_f32_16x16x32_bf16 v[62:65], v[226:229], a[4:7], v[62:65]
    buffer_load_dwordx4 a[44:47], v23, s[16:19], s30 offen offset:1024 sc1
    v_mfma_f32_16x16x32_bf16 v[82:85], v[230:233], a[4:7], v[82:85]
    v_mfma_f32_16x16x32_bf16 v[102:105], v[234:237], a[4:7], v[102:105]
    v_mfma_f32_16x16x32_bf16 v[122:125], v[238:241], a[4:7], v[122:125]
    s_waitcnt vmcnt(9)
    v_mfma_f32_16x16x32_bf16 v[66:69], v[226:229], a[8:11], v[66:69]
    buffer_load_dwordx4 a[0:3], v23, s[16:19], s30 offen offset:2048 sc1
    v_mfma_f32_16x16x32_bf16 v[86:89], v[230:233], a[8:11], v[86:89]
    v_mfma_f32_16x16x32_bf16 v[106:109], v[234:237], a[8:11], v[106:109]
    v_mfma_f32_16x16x32_bf16 v[126:129], v[238:241], a[8:11], v[126:129]
    s_waitcnt vmcnt(9)
    v_mfma_f32_16x16x32_bf16 v[70:73], v[226:229], a[12:15], v[70:73]
    buffer_load_dwordx4 a[4:7], v23, s[16:19], s30 offen offset:3072 sc1
    v_mfma_f32_16x16x32_bf16 v[90:93], v[230:233], a[12:15], v[90:93]
    v_mfma_f32_16x16x32_bf16 v[110:113], v[234:237], a[12:15], v[110:113]
    v_mfma_f32_16x16x32_bf16 v[130:133], v[238:241], a[12:15], v[130:133]
    s_waitcnt vmcnt(9)
    v_mfma_f32_16x16x32_bf16 v[74:77], v[226:229], a[16:19], v[74:77]
    buffer_load_dwordx4 a[8:11], v24, s[16:19], s30 offen offset:0 sc1
    v_mfma_f32_16x16x32_bf16 v[94:97], v[230:233], a[16:19], v[94:97]
    v_mfma_f32_16x16x32_bf16 v[114:117], v[234:237], a[16:19], v[114:117]
    s_add_u32 s30, s30, 40960
    v_mfma_f32_16x16x32_bf16 v[134:137], v[238:241], a[16:19], v[134:137]
    s_waitcnt vmcnt(9)
    v_mfma_f32_16x16x32_bf16 v[58:61], a[240:243], a[20:23], v[58:61]
    buffer_load_dwordx4 a[12:15], v23, s[16:19], s30 offen offset:0 sc1
    v_mfma_f32_16x16x32_bf16 v[78:81], a[244:247], a[20:23], v[78:81]
    v_mfma_f32_16x16x32_bf16 v[98:101], a[248:251], a[20:23], v[98:101]
    v_mfma_f32_16x16x32_bf16 v[118:121], a[252:255], a[20:23], v[118:121]
    s_waitcnt vmcnt(9)
    v_mfma_f32_16x16x32_bf16 v[62:65], a[240:243], a[24:27], v[62:65]
    buffer_load_dwordx4 a[16:19], v23, s[16:19], s30 offen offset:1024 sc1
    v_mfma_f32_16x16x32_bf16 v[82:85], a[244:247], a[24:27], v[82:85]
    v_mfma_f32_16x16x32_bf16 v[102:105], a[248:251], a[24:27], v[102:105]
    v_mfma_f32_16x16x32_bf16 v[122:125], a[252:255], a[24:27], v[122:125]
    s_waitcnt vmcnt(9)
    v_mfma_f32_16x16x32_bf16 v[66:69], a[240:243], a[28:31], v[66:69]
    buffer_load_dwordx4 a[20:23], v23, s[16:19], s30 offen offset:2048 sc1
    v_mfma_f32_16x16x32_bf16 v[86:89], a[244:247], a[28:31], v[86:89]
    v_mfma_f32_16x16x32_bf16 v[106:109], a[248:251], a[28:31], v[106:109]
    v_mfma_f32_16x16x32_bf16 v[126:129], a[252:255], a[28:31], v[126:129]
    s_waitcnt vmcnt(9)
    v_mfma_f32_16x16x32_bf16 v[70:73], a[240:243], a[32:35], v[70:73]
    buffer_load_dwordx4 a[24:27], v23, s[16:19], s30 offen offset:3072 sc1
    v_mfma_f32_16x16x32_bf16 v[90:93], a[244:247], a[32:35], v[90:93]
    v_mfma_f32_16x16x32_bf16 v[110:113], a[248:251], a[32:35], v[110:113]
    v_mfma_f32_16x16x32_bf16 v[130:133], a[252:255], a[32:35], v[130:133]
    s_waitcnt vmcnt(9)
    v_mfma_f32_16x16x32_bf16 v[74:77], a[240:243], a[36:39], v[74:77]
    buffer_load_dwordx4 a[28:31], v24, s[16:19], s30 offen offset:0 sc1
    v_mfma_f32_16x16x32_bf16 v[94:97], a[244:247], a[36:39], v[94:97]
    v_mfma_f32_16x16x32_bf16 v[114:117], a[248:251], a[36:39], v[114:117]
    s_add_u32 s30, s30, 40960
    v_mfma_f32_16x16x32_bf16 v[134:137], a[252:255], a[36:39], v[134:137]
    s_waitcnt vmcnt(9)
    v_mfma_f32_16x16x32_bf16 v[58:61], a[224:227], a[40:43], v[58:61]
    s_add_u32 m0, s93, 114688
    v_mfma_f32_16x16x32_bf16 v[78:81], a[228:231], a[40:43], v[78:81]
    v_mfma_f32_16x16x32_bf16 v[98:101], a[232:235], a[40:43], v[98:101]
    v_mfma_f32_16x16x32_bf16 v[118:121], a[236:239], a[40:43], v[118:121]
    s_waitcnt vmcnt(8)
    v_mfma_f32_16x16x32_bf16 v[62:65], a[224:227], a[44:47], v[62:65]
    buffer_load_dwordx4 v27, s[20:23], s31 offen offset:0 lds
    v_mfma_f32_16x16x32_bf16 v[82:85], a[228:231], a[44:47], v[82:85]
    v_mfma_f32_16x16x32_bf16 v[102:105], a[232:235], a[44:47], v[102:105]
    v_mfma_f32_16x16x32_bf16 v[122:125], a[236:239], a[44:47], v[122:125]
    s_waitcnt vmcnt(8)
    v_mfma_f32_16x16x32_bf16 v[66:69], a[224:227], a[0:3], v[66:69]
    buffer_load_dwordx4 v28, s[20:23], s31 offen offset:1024 lds
    v_mfma_f32_16x16x32_bf16 v[86:89], a[228:231], a[0:3], v[86:89]
    v_mfma_f32_16x16x32_bf16 v[106:109], a[232:235], a[0:3], v[106:109]
    v_mfma_f32_16x16x32_bf16 v[126:129], a[236:239], a[0:3], v[126:129]
    s_waitcnt vmcnt(8)
    v_mfma_f32_16x16x32_bf16 v[70:73], a[224:227], a[4:7], v[70:73]
    buffer_load_dwordx4 v29, s[20:23], s31 offen offset:2048 lds
    v_mfma_f32_16x16x32_bf16 v[90:93], a[228:231], a[4:7], v[90:93]
    v_mfma_f32_16x16x32_bf16 v[110:113], a[232:235], a[4:7], v[110:113]
    v_mfma_f32_16x16x32_bf16 v[130:133], a[236:239], a[4:7], v[130:133]
    s_waitcnt vmcnt(8)
    v_mfma_f32_16x16x32_bf16 v[74:77], a[224:227], a[8:11], v[74:77]
    buffer_load_dwordx4 v30, s[20:23], s31 offen offset:3072 lds
    v_mfma_f32_16x16x32_bf16 v[94:97], a[228:231], a[8:11], v[94:97]
    v_mfma_f32_16x16x32_bf16 v[114:117], a[232:235], a[8:11], v[114:117]
    s_add_u32 s31, s31, 131072
    s_cmp_eq_u32 s31, 1835008
    s_cselect_b32 s31, 0, s31
    v_mfma_f32_16x16x32_bf16 v[134:137], a[236:239], a[8:11], v[134:137]
    s_waitcnt vmcnt(8)
    v_mfma_f32_16x16x32_bf16 v[78:81], a[212:215], a[12:15], v[78:81]
    s_add_u32 m0, s93, 131072
    s_nop 0
    buffer_load_dwordx4 v27, s[20:23], s31 offen offset:0 lds
    v_mfma_f32_16x16x32_bf16 v[98:101], a[216:219], a[12:15], v[98:101]
    buffer_load_dwordx4 v28, s[20:23], s31 offen offset:1024 lds
    buffer_load_dwordx4 v29, s[20:23], s31 offen offset:2048 lds
    v_mfma_f32_16x16x32_bf16 v[118:121], a[220:223], a[12:15], v[118:121]
    buffer_load_dwordx4 v30, s[20:23], s31 offen offset:3072 lds
    s_add_u32 s31, s31, 131072
    s_cmp_eq_u32 s31, 1835008
    s_cselect_b32 s31, 0, s31
    s_waitcnt vmcnt(11)
    v_mfma_f32_16x16x32_bf16 v[82:85], a[212:215], a[16:19], v[82:85]
    ds_write_b128 v39, v[78:81] offset:0
    v_mfma_f32_16x16x32_bf16 v[102:105], a[216:219], a[16:19], v[102:105]
    ds_write_b128 v39, v[98:101] offset:17408
    v_mfma_f32_16x16x32_bf16 v[122:125], a[220:223], a[16:19], v[122:125]
    ds_write_b128 v39, v[118:121] offset:34816
    s_waitcnt vmcnt(10)
    v_mfma_f32_16x16x32_bf16 v[86:89], a[212:215], a[20:23], v[86:89]
    s_nop 0
    ds_write_b128 v39, v[82:85] offset:1024
    v_mfma_f32_16x16x32_bf16 v[106:109], a[216:219], a[20:23], v[106:109]
    ds_write_b128 v39, v[102:105] offset:18432
    v_mfma_f32_16x16x32_bf16 v[126:129], a[220:223], a[20:23], v[126:129]
    ds_write_b128 v39, v[122:125] offset:35840
    s_waitcnt vmcnt(9)
    v_mfma_f32_16x16x32_bf16 v[90:93], a[212:215], a[24:27], v[90:93]
    ds_write_b128 v39, v[86:89] offset:2048
    v_mfma_f32_16x16x32_bf16 v[110:113], a[216:219], a[24:27], v[110:113]
    s_nop 0
    ds_write_b128 v39, v[106:109] offset:19456
    v_mfma_f32_16x16x32_bf16 v[130:133], a[220:223], a[24:27], v[130:133]
    ds_write_b128 v39, v[126:129] offset:49152
    s_waitcnt vmcnt(8)
    v_mfma_f32_16x16x32_bf16 v[94:97], a[212:215], a[28:31], v[94:97]
    ds_write_b128 v39, v[90:93] offset:3072
    v_mfma_f32_16x16x32_bf16 v[114:117], a[216:219], a[28:31], v[114:117]
    ds_write_b128 v39, v[110:113] offset:32768
    v_mfma_f32_16x16x32_bf16 v[134:137], a[220:223], a[28:31], v[134:137]
    s_nop 0
    ds_write_b128 v39, v[130:133] offset:50176
    v_mfma_f32_16x16x32_bf16 v[58:61], a[208:211], a[12:15], v[58:61]
    s_nop 0
    ds_write_b128 v39, v[94:97] offset:16384
    v_mfma_f32_16x16x32_bf16 v[62:65], a[208:211], a[16:19], v[62:65]
    ds_write_b128 v39, v[114:117] offset:33792
    v_mfma_f32_16x16x32_bf16 v[66:69], a[208:211], a[20:23], v[66:69]
    ds_write_b128 v39, v[134:137] offset:51200
    v_mfma_f32_16x16x32_bf16 v[70:73], a[208:211], a[24:27], v[70:73]
    v_mfma_f32_16x16x32_bf16 v[74:77], a[208:211], a[28:31], v[74:77]
    s_waitcnt lgkmcnt(0)
    s_barrier
    ds_read_b128 v[138:141], v40 offset:0
    ds_read_b128 v[158:161], v41 offset:17408
    ds_read_b128 v[178:181], v42 offset:34816
    ds_read_b128 v[142:145], v40 offset:1024
    ds_read_b128 v[162:165], v41 offset:18432
    ds_read_b128 v[182:185], v42 offset:35840
    ds_read_b128 v[146:149], v40 offset:2048
    ds_read_b128 v[166:169], v41 offset:19456
    ds_read_b128 v[186:189], v42 offset:49152
    ds_read_b128 v[150:153], v40 offset:3072
    ds_read_b128 v[170:173], v41 offset:32768
    ds_read_b128 v[190:193], v42 offset:50176
    ds_read_b128 v[154:157], v40 offset:16384
    ds_read_b128 v[174:177], v41 offset:33792
    ds_read_b128 v[194:197], v42 offset:51200
    s_add_u32 m0, s93, 147456
    s_nop 0
    buffer_load_dwordx4 v27, s[20:23], s31 offen offset:0 lds
    buffer_load_dwordx4 v28, s[20:23], s31 offen offset:1024 lds
    buffer_load_dwordx4 v29, s[20:23], s31 offen offset:2048 lds
    buffer_load_dwordx4 v30, s[20:23], s31 offen offset:3072 lds
    s_add_u32 s31, s31, 131072
    s_cmp_eq_u32 s31, 1835008
    s_cselect_b32 s31, 0, s31
    s_waitcnt lgkmcnt(14)
    v_pk_add_f32 v[58:59], v[58:59], v[138:139]
    s_waitcnt lgkmcnt(12)
    v_pk_add_f32 v[158:159], v[158:159], v[178:179]
    v_pk_add_f32 v[60:61], v[60:61], v[140:141]
    v_pk_add_f32 v[160:161], v[160:161], v[180:181]
    v_pk_add_f32 v[58:59], v[58:59], v[158:159]
    v_pk_add_f32 v[60:61], v[60:61], v[160:161]
    v_pk_mul_f32 v[138:139], v[58:59], v[58:59]
    v_pk_mul_f32 v[140:141], v[60:61], v[60:61]
    v_pk_fma_f32 v[138:139], v[138:139], s[44:45], v[48:49]
    v_pk_fma_f32 v[140:141], v[140:141], s[44:45], v[48:49]
    v_pk_mul_f32 v[138:139], v[138:139], v[58:59]
    v_pk_mul_f32 v[140:141], v[140:141], v[60:61]
    v_exp_f32 v138, v138
    v_exp_f32 v139, v139
    v_exp_f32 v140, v140
    v_exp_f32 v141, v141
    v_pk_add_f32 v[138:139], v[138:139], 1.0 op_sel_hi:[1,0]
    v_pk_add_f32 v[140:141], v[140:141], 1.0 op_sel_hi:[1,0]
    v_rcp_f32 v138, v138
    v_rcp_f32 v139, v139
    v_rcp_f32 v140, v140
    v_rcp_f32 v141, v141
    v_pk_mul_f32 v[138:139], v[138:139], v[58:59]
    v_pk_mul_f32 v[140:141], v[140:141], v[60:61]
    v_cvt_pk_bf16_f32 v198, v138, v139
    v_cvt_pk_bf16_f32 v199, v140, v141
    s_waitcnt lgkmcnt(11)
    v_pk_add_f32 v[62:63], v[62:63], v[142:143]
    s_waitcnt lgkmcnt(9)
    v_pk_add_f32 v[162:163], v[162:163], v[182:183]
    v_pk_add_f32 v[64:65], v[64:65], v[144:145]
    v_pk_add_f32 v[164:165], v[164:165], v[184:185]
    v_pk_add_f32 v[62:63], v[62:63], v[162:163]
    v_pk_add_f32 v[64:65], v[64:65], v[164:165]
    s_add_u32 m0, s93, 0
    s_nop 0
    buffer_load_dwordx4 v27, s[20:23], s31 offen offset:0 lds
    buffer_load_dwordx4 v28, s[20:23], s31 offen offset:1024 lds
    buffer_load_dwordx4 v29, s[20:23], s31 offen offset:2048 lds
    buffer_load_dwordx4 v30, s[20:23], s31 offen offset:3072 lds
    s_add_u32 s31, s31, 131072
    s_cmp_eq_u32 s31, 1835008
    s_cselect_b32 s31, 0, s31
    v_pk_mul_f32 v[142:143], v[62:63], v[62:63]
    v_pk_mul_f32 v[144:145], v[64:65], v[64:65]
    v_pk_fma_f32 v[142:143], v[142:143], s[44:45], v[48:49]
    v_pk_fma_f32 v[144:145], v[144:145], s[44:45], v[48:49]
    v_pk_mul_f32 v[142:143], v[142:143], v[62:63]
    v_pk_mul_f32 v[144:145], v[144:145], v[64:65]
    v_exp_f32 v142, v142
    v_exp_f32 v143, v143
    v_exp_f32 v144, v144
    v_exp_f32 v145, v145
    v_pk_add_f32 v[142:143], v[142:143], 1.0 op_sel_hi:[1,0]
    v_pk_add_f32 v[144:145], v[144:145], 1.0 op_sel_hi:[1,0]
    v_rcp_f32 v142, v142
    v_rcp_f32 v143, v143
    v_rcp_f32 v144, v144
    v_rcp_f32 v145, v145
    v_pk_mul_f32 v[142:143], v[142:143], v[62:63]
    v_pk_mul_f32 v[144:145], v[144:145], v[64:65]
    v_cvt_pk_bf16_f32 v200, v142, v143
    v_cvt_pk_bf16_f32 v201, v144, v145
    s_waitcnt lgkmcnt(8)
    v_pk_add_f32 v[66:67], v[66:67], v[146:147]
    v_permlane32_swap_b32 v198, v200
    v_permlane32_swap_b32 v199, v201
    s_waitcnt lgkmcnt(6)
    v_pk_add_f32 v[166:167], v[166:167], v[186:187]
    buffer_store_dwordx4 v[198:201], v52, s[8:11], s32 offen offset:0 sc1
    v_pk_add_f32 v[68:69], v[68:69], v[148:149]
    v_pk_add_f32 v[168:169], v[168:169], v[188:189]
    v_pk_add_f32 v[66:67], v[66:67], v[166:167]
    v_pk_add_f32 v[68:69], v[68:69], v[168:169]
    v_pk_mul_f32 v[146:147], v[66:67], v[66:67]
    v_pk_mul_f32 v[148:149], v[68:69], v[68:69]
    v_pk_fma_f32 v[146:147], v[146:147], s[44:45], v[48:49]
    v_pk_fma_f32 v[148:149], v[148:149], s[44:45], v[48:49]
    v_pk_mul_f32 v[146:147], v[146:147], v[66:67]
    v_pk_mul_f32 v[148:149], v[148:149], v[68:69]
    v_exp_f32 v146, v146
    v_exp_f32 v147, v147
    v_exp_f32 v148, v148
    v_exp_f32 v149, v149
    v_pk_add_f32 v[146:147], v[146:147], 1.0 op_sel_hi:[1,0]
    v_pk_add_f32 v[148:149], v[148:149], 1.0 op_sel_hi:[1,0]
    v_rcp_f32 v146, v146
    v_rcp_f32 v147, v147
    v_rcp_f32 v148, v148
    v_rcp_f32 v149, v149
    v_pk_mul_f32 v[146:147], v[146:147], v[66:67]
    v_pk_mul_f32 v[148:149], v[148:149], v[68:69]
    v_cvt_pk_bf16_f32 v202, v146, v147
    v_cvt_pk_bf16_f32 v203, v148, v149
    s_waitcnt lgkmcnt(5)
    v_pk_add_f32 v[70:71], v[70:71], v[150:151]
    s_waitcnt lgkmcnt(3)
    v_pk_add_f32 v[170:171], v[170:171], v[190:191]
    v_pk_add_f32 v[72:73], v[72:73], v[152:153]
    v_pk_add_f32 v[172:173], v[172:173], v[192:193]
    v_pk_add_f32 v[70:71], v[70:71], v[170:171]
    v_pk_add_f32 v[72:73], v[72:73], v[172:173]
    v_pk_mul_f32 v[150:151], v[70:71], v[70:71]
    v_pk_mul_f32 v[152:153], v[72:73], v[72:73]
    v_pk_fma_f32 v[150:151], v[150:151], s[44:45], v[48:49]
    v_pk_fma_f32 v[152:153], v[152:153], s[44:45], v[48:49]
    v_pk_mul_f32 v[150:151], v[150:151], v[70:71]
    v_pk_mul_f32 v[152:153], v[152:153], v[72:73]
    v_exp_f32 v150, v150
    v_exp_f32 v151, v151
    v_exp_f32 v152, v152
    v_exp_f32 v153, v153
    v_pk_add_f32 v[150:151], v[150:151], 1.0 op_sel_hi:[1,0]
    v_pk_add_f32 v[152:153], v[152:153], 1.0 op_sel_hi:[1,0]
    v_rcp_f32 v150, v150
    v_rcp_f32 v151, v151
    v_rcp_f32 v152, v152
    v_rcp_f32 v153, v153
    v_pk_mul_f32 v[150:151], v[150:151], v[70:71]
    v_pk_mul_f32 v[152:153], v[152:153], v[72:73]
    v_cvt_pk_bf16_f32 v204, v150, v151
    v_cvt_pk_bf16_f32 v205, v152, v153
    s_waitcnt lgkmcnt(2)
    v_pk_add_f32 v[74:75], v[74:75], v[154:155]
    v_permlane32_swap_b32 v202, v204
    v_permlane32_swap_b32 v203, v205
    s_waitcnt lgkmcnt(0)
    v_pk_add_f32 v[174:175], v[174:175], v[194:195]
    buffer_store_dwordx4 v[202:205], v52, s[8:11], s32 offen offset:2048 sc1
    v_pk_add_f32 v[76:77], v[76:77], v[156:157]
    v_pk_add_f32 v[176:177], v[176:177], v[196:197]
    v_pk_add_f32 v[74:75], v[74:75], v[174:175]
    v_pk_add_f32 v[76:77], v[76:77], v[176:177]
    v_pk_mul_f32 v[154:155], v[74:75], v[74:75]
    v_pk_mul_f32 v[156:157], v[76:77], v[76:77]
    v_pk_fma_f32 v[154:155], v[154:155], s[44:45], v[48:49]
    v_pk_fma_f32 v[156:157], v[156:157], s[44:45], v[48:49]
    v_pk_mul_f32 v[154:155], v[154:155], v[74:75]
    v_pk_mul_f32 v[156:157], v[156:157], v[76:77]
    v_exp_f32 v154, v154
    v_exp_f32 v155, v155
    v_exp_f32 v156, v156
    v_exp_f32 v157, v157
    v_pk_add_f32 v[154:155], v[154:155], 1.0 op_sel_hi:[1,0]
    v_pk_add_f32 v[156:157], v[156:157], 1.0 op_sel_hi:[1,0]
    v_rcp_f32 v154, v154
    v_rcp_f32 v155, v155
    v_rcp_f32 v156, v156
    v_rcp_f32 v157, v157
    v_pk_mul_f32 v[154:155], v[154:155], v[74:75]
    v_pk_mul_f32 v[156:157], v[156:157], v[76:77]
    v_cvt_pk_bf16_f32 v206, v154, v155
    v_cvt_pk_bf16_f32 v207, v156, v157
    s_nop 0
    v_permlane32_swap_b32 v206, v208
    v_permlane32_swap_b32 v207, v209
    buffer_store_dwordx4 v[206:209], v53, s[8:11], s33 offen sc1
    s_add_u32 m0, s93, 16384
    s_nop 0
    buffer_load_dwordx4 v27, s[20:23], s31 offen offset:0 lds
    buffer_load_dwordx4 v28, s[20:23], s31 offen offset:1024 lds
    buffer_load_dwordx4 v29, s[20:23], s31 offen offset:2048 lds
    buffer_load_dwordx4 v30, s[20:23], s31 offen offset:3072 lds
    s_add_u32 s31, s31, 131072
    s_cmp_eq_u32 s31, 1835008
    s_cselect_b32 s31, 0, s31
    s_add_u32 m0, s93, 98304
    s_nop 0
    buffer_load_dwordx4 v27, s[20:23], s31 offen offset:0 lds
    buffer_load_dwordx4 v28, s[20:23], s31 offen offset:1024 lds
    buffer_load_dwordx4 v29, s[20:23], s31 offen offset:2048 lds
    buffer_load_dwordx4 v30, s[20:23], s31 offen offset:3072 lds
    s_add_u32 s31, s31, 131072
    s_cmp_eq_u32 s31, 1835008
    s_cselect_b32 s31, 0, s31
E_join:
    s_lshl_b32 s28, s94, 7
    s_lshl_b32 s29, s3, 5
    s_add_u32 s28, s28, s29
    v_and_b32 v20, 15, v1
    v_lshlrev_b32 v26, 1, v20
    buffer_load_ushort v48, v26, s[24:27], s28 offen
    s_mul_i32 s28, s3, 573440
    s_mul_i32 s29, s95, 5120
    s_add_u32 s28, s28, s29
    v_add_u32 v23, s28, v2
    v_add_u32 v24, 4096, v23
    s_mul_i32 s28, s3, 7
    v_add_u32 v25, s28, v1
    v_min_u32 v25, 26, v25
    s_add_u32 s28, s95, 512
    s_lshl_b32 s28, s28, 7
    v_lshl_add_u32 v25, v25, 10, s28
    v_lshlrev_b32 v22, 2, v21
    v_sub_u32 v20, v20, v22
    v_mov_b32 v22, 0x3f80
    v_cmp_eq_u32 vcc, 0, v20
    s_nop 1
    v_cndmask_b32 v50, 0, v22, vcc
    v_cmp_eq_u32 vcc, 1, v20
    s_nop 1
    v_cndmask_b32_e64 v50, v50, 1.0, vcc
    v_cmp_eq_u32 vcc, 2, v20
    s_nop 1
    v_cndmask_b32 v51, 0, v22, vcc
    v_cmp_eq_u32 vcc, 3, v20
    s_nop 1
    v_cndmask_b32_e64 v51, v51, 1.0, vcc
    s_mul_i32 s35, s95, 160
    s_and_b32 s29, s35, 32
    s_sub_u32 s35, s35, s29
    s_lshl2_add_u32 s28, s94, s3
    s_mul_i32 s28, s28, 20480
    s_add_u32 s35, s35, s28
    v_add_u32 v56, s93, v2
    s_add_u32 s28, s93, s29
    v_mul_u32_u24 v55, 96, v26
    v_lshl_add_u32 v55, v21, 3, v55
    v_add_u32 v55, s28, v55
    s_lshr_b32 s29, s29, 4
    v_add_u32 v20, 0, v1
    v_mul_u32_u24 v22, 5462, v20
    v_lshrrev_b32 v22, 16, v22
    v_mul_u32_u24 v52, 1088, v22
    v_lshl_add_u32 v52, v20, 4, v52
    v_mul_u32_u24 v22, 12, v22
    v_sub_u32 v20, v20, v22
    v_subrev_u32 v20, s29, v20
    v_cmp_gt_u32 vcc, 10, v20
    v_mov_b32 v22, 0x40000000
    s_nop 0
    v_cndmask_b32 v52, v22, v52, vcc
    v_add_u32 v20, 64, v1
    v_mul_u32_u24 v22, 5462, v20
    v_lshrrev_b32 v22, 16, v22
    v_mul_u32_u24 v53, 1088, v22
    v_lshl_add_u32 v53, v20, 4, v53
    v_mul_u32_u24 v22, 12, v22
    v_sub_u32 v20, v20, v22
    v_subrev_u32 v20, s29, v20
    v_cmp_gt_u32 vcc, 10, v20
    v_mov_b32 v22, 0x40000000
    s_nop 0
    v_cndmask_b32 v53, v22, v53, vcc
    v_add_u32 v20, 128, v1
    v_mul_u32_u24 v22, 5462, v20
    v_lshrrev_b32 v22, 16, v22
    v_mul_u32_u24 v54, 1088, v22
    v_lshl_add_u32 v54, v20, 4, v54
    v_mul_u32_u24 v22, 12, v22
    v_sub_u32 v20, v20, v22
    v_subrev_u32 v20, s29, v20
    v_cmp_gt_u32 vcc, 10, v20
    v_mov_b32 v22, 0x40000000
    s_nop 0
    v_cndmask_b32 v54, v22, v54, vcc
    s_waitcnt vmcnt(9)
    s_barrier
    s_mov_b64 exec, 1
    buffer_store_dword v4, off, s[80:83], s47 sc1
    s_mov_b64 exec, -1
    s_add_u32 m0, s93, 32768
    s_nop 0
    buffer_load_dwordx4 v27, s[20:23], s31 offen offset:0 lds
    buffer_load_dwordx4 v28, s[20:23], s31 offen offset:1024 lds
    buffer_load_dwordx4 v29, s[20:23], s31 offen offset:2048 lds
    buffer_load_dwordx4 v30, s[20:23], s31 offen offset:3072 lds
    s_add_u32 s31, s31, 131072
    s_cmp_eq_u32 s31, 1835008
    s_cselect_b32 s31, 0, s31
    s_add_u32 m0, s93, 49152
    s_nop 0
    buffer_load_dwordx4 v27, s[20:23], s31 offen offset:0 lds
    buffer_load_dwordx4 v28, s[20:23], s31 offen offset:1024 lds
    buffer_load_dwordx4 v29, s[20:23], s31 offen offset:2048 lds
    buffer_load_dwordx4 v30, s[20:23], s31 offen offset:3072 lds
    s_add_u32 s31, s31, 131072
    s_cmp_eq_u32 s31, 1835008
    s_cselect_b32 s31, 0, s31
    s_add_u32 m0, s93, 65536
    s_nop 0
    buffer_load_dwordx4 v27, s[20:23], s31 offen offset:0 lds
    buffer_load_dwordx4 v28, s[20:23], s31 offen offset:1024 lds
    buffer_load_dwordx4 v29, s[20:23], s31 offen offset:2048 lds
    buffer_load_dwordx4 v30, s[20:23], s31 offen offset:3072 lds
    s_add_u32 s31, s31, 131072
    s_cmp_eq_u32 s31, 1835008
    s_cselect_b32 s31, 0, s31
    s_add_u32 m0, s93, 81920
    s_nop 0
    buffer_load_dwordx4 v27, s[20:23], s31 offen offset:0 lds
    buffer_load_dwordx4 v28, s[20:23], s31 offen offset:1024 lds
    buffer_load_dwordx4 v29, s[20:23], s31 offen offset:2048 lds
    buffer_load_dwordx4 v30, s[20:23], s31 offen offset:3072 lds
    s_add_u32 s31, s31, 131072
    s_cmp_eq_u32 s31, 1835008
    s_cselect_b32 s31, 0, s31
    ds_read_b64_tr_b16 a[160:161], v31 offset:49152
    ds_read_b64_tr_b16 a[162:163], v31 offset:50176
    ds_read_b64_tr_b16 a[164:165], v32 offset:49152
    ds_read_b64_tr_b16 a[166:167], v32 offset:50176
    ds_read_b64_tr_b16 a[168:169], v33 offset:49152
    ds_read_b64_tr_b16 a[170:171], v33 offset:50176
    ds_read_b64_tr_b16 a[172:173], v34 offset:49152
    ds_read_b64_tr_b16 a[174:175], v34 offset:50176
    ds_read_b64_tr_b16 a[144:145], v35 offset:0
    ds_read_b64_tr_b16 a[146:147], v35 offset:1024
    ds_read_b64_tr_b16 a[148:149], v36 offset:0
    ds_read_b64_tr_b16 a[150:151], v36 offset:1024
    ds_read_b64_tr_b16 a[152:153], v37 offset:0
    ds_read_b64_tr_b16 a[154:155], v37 offset:1024
    ds_read_b64_tr_b16 a[156:157], v38 offset:0
    ds_read_b64_tr_b16 a[158:159], v38 offset:1024
    s_waitcnt lgkmcnt(8)
    s_add_u32 m0, s93, 114688
    s_nop 0
    buffer_load_dwordx4 v27, s[20:23], s31 offen offset:0 lds
    buffer_load_dwordx4 v28, s[20:23], s31 offen offset:1024 lds
    buffer_load_dwordx4 v29, s[20:23], s31 offen offset:2048 lds
    buffer_load_dwordx4 v30, s[20:23], s31 offen offset:3072 lds
    s_add_u32 s31, s31, 131072
    s_cmp_eq_u32 s31, 1835008
    s_cselect_b32 s31, 0, s31
    s_waitcnt lgkmcnt(0)
    s_add_u32 m0, s93, 131072
    s_nop 0
    buffer_load_dwordx4 v27, s[20:23], s31 offen offset:0 lds
    buffer_load_dwordx4 v28, s[20:23], s31 offen offset:1024 lds
    buffer_load_dwordx4 v29, s[20:23], s31 offen offset:2048 lds
    buffer_load_dwordx4 v30, s[20:23], s31 offen offset:3072 lds
    s_add_u32 s31, s31, 131072
    s_cmp_eq_u32 s31, 1835008
    s_cselect_b32 s31, 0, s31
    s_waitcnt vmcnt(25)
    v_lshlrev_b32 v44, 16, v48
    v_mov_b32 v45, v44
    v_mov_b32 v46, v44
    v_mov_b32 v47, v44
    s_nop 1
    v_mfma_f32_16x16x16_bf16 v[58:61], v[10:11], v[50:51], v[44:47]
    v_mfma_f32_16x16x16_bf16 v[62:65], v[12:13], v[50:51], v[44:47]
    v_mfma_f32_16x16x16_bf16 v[66:69], v[14:15], v[50:51], v[44:47]
    v_mfma_f32_16x16x16_bf16 v[70:73], v[16:17], v[50:51], v[44:47]
    v_mfma_f32_16x16x16_bf16 v[74:77], v[18:19], v[50:51], v[44:47]
    s_mov_b32 exec_lo, 127
    s_mov_b32 exec_hi, 0
    s_mov_b32 s46, 0x40000
poll3:
    buffer_load_dword v5, v25, s[80:83], 0 offen sc1
    s_sub_u32 s46, s46, 1
    s_waitcnt vmcnt(0)
    v_cmp_ne_u32 vcc, v4, v5
    s_cbranch_scc1 pollx3
    s_cbranch_vccnz poll3
pollx3:
    s_mov_b64 exec, -1
    buffer_load_dwordx4 a[0:3], v23, s[8:11], s34 offen offset:0 sc1
    buffer_load_dwordx4 a[4:7], v23, s[8:11], s34 offen offset:1024 sc1
    buffer_load_dwordx4 a[8:11], v23, s[8:11], s34 offen offset:2048 sc1
    buffer_load_dwordx4 a[12:15], v23, s[8:11], s34 offen offset:3072 sc1
    buffer_load_dwordx4 a[16:19], v24, s[8:11], s34 offen offset:0 sc1
    s_add_u32 s34, s34, 40960
    buffer_load_dwordx4 a[20:23], v23, s[8:11], s34 offen offset:0 sc1
    buffer_load_dwordx4 a[24:27], v23, s[8:11], s34 offen offset:1024 sc1
    buffer_load_dwordx4 a[28:31], v23, s[8:11], s34 offen offset:2048 sc1
    buffer_load_dwordx4 a[32:35], v23, s[8:11], s34 offen offset:3072 sc1
    buffer_load_dwordx4 a[36:39], v24, s[8:11], s34 offen offset:0 sc1
    s_add_u32 s34, s34, 40960
    s_waitcnt vmcnt(9)
    v_mfma_f32_16x16x32_bf16 v[58:61], a[0:3], a[192:195], v[58:61]
    buffer_load_dwordx4 a[40:43], v23, s[8:11], s34 offen offset:0 sc1
    v_mfma_f32_16x16x32_bf16 v[78:81], a[0:3], a[196:199], 0
    v_mfma_f32_16x16x32_bf16 v[98:101], a[0:3], a[200:203], 0
    v_mfma_f32_16x16x32_bf16 v[118:121], a[0:3], a[204:207], 0
    s_waitcnt vmcnt(9)
    v_mfma_f32_16x16x32_bf16 v[62:65], a[4:7], a[192:195], v[62:65]
    buffer_load_dwordx4 a[44:47], v23, s[8:11], s34 offen offset:1024 sc1
    v_mfma_f32_16x16x32_bf16 v[82:85], a[4:7], a[196:199], 0
    ds_read_b64_tr_b16 a[128:129], v35 offset:16384
    v_mfma_f32_16x16x32_bf16 v[102:105], a[4:7], a[200:203], 0
    ds_read_b64_tr_b16 a[130:131], v35 offset:17408
    v_mfma_f32_16x16x32_bf16 v[122:125], a[4:7], a[204:207], 0
    s_waitcnt vmcnt(9)
    v_mfma_f32_16x16x32_bf16 v[66:69], a[8:11], a[192:195], v[66:69]
    buffer_load_dwordx4 a[0:3], v23, s[8:11], s34 offen offset:2048 sc1
    v_mfma_f32_16x16x32_bf16 v[86:89], a[8:11], a[196:199], 0
    ds_read_b64_tr_b16 a[132:133], v36 offset:16384
    v_mfma_f32_16x16x32_bf16 v[106:109], a[8:11], a[200:203], 0
    ds_read_b64_tr_b16 a[134:135], v36 offset:17408
    v_mfma_f32_16x16x32_bf16 v[126:129], a[8:11], a[204:207], 0
    s_waitcnt vmcnt(9)
    v_mfma_f32_16x16x32_bf16 v[70:73], a[12:15], a[192:195], v[70:73]
    buffer_load_dwordx4 a[4:7], v23, s[8:11], s34 offen offset:3072 sc1
    v_mfma_f32_16x16x32_bf16 v[90:93], a[12:15], a[196:199], 0
    ds_read_b64_tr_b16 a[136:137], v37 offset:16384
    v_mfma_f32_16x16x32_bf16 v[110:113], a[12:15], a[200:203], 0
    ds_read_b64_tr_b16 a[138:139], v37 offset:17408
    v_mfma_f32_16x16x32_bf16 v[130:133], a[12:15], a[204:207], 0
    s_waitcnt vmcnt(9)
    v_mfma_f32_16x16x32_bf16 v[74:77], a[16:19], a[192:195], v[74:77]
    buffer_load_dwordx4 a[8:11], v24, s[8:11], s34 offen offset:0 sc1
    v_mfma_f32_16x16x32_bf16 v[94:97], a[16:19], a[196:199], 0
    s_add_u32 s34, s34, 40960
    v_mfma_f32_16x16x32_bf16 v[114:117], a[16:19], a[200:203], 0
    ds_read_b64_tr_b16 a[140:141], v38 offset:16384
    v_mfma_f32_16x16x32_bf16 v[134:137], a[16:19], a[204:207], 0
    ds_read_b64_tr_b16 a[142:143], v38 offset:17408
    s_waitcnt vmcnt(9)
    v_mfma_f32_16x16x32_bf16 v[58:61], a[20:23], a[176:179], v[58:61]
    buffer_load_dwordx4 a[12:15], v23, s[8:11], s34 offen offset:0 sc1
    v_mfma_f32_16x16x32_bf16 v[78:81], a[20:23], a[180:183], v[78:81]
    v_mfma_f32_16x16x32_bf16 v[98:101], a[20:23], a[184:187], v[98:101]
    v_mfma_f32_16x16x32_bf16 v[118:121], a[20:23], a[188:191], v[118:121]
    s_waitcnt vmcnt(9)
    v_mfma_f32_16x16x32_bf16 v[62:65], a[24:27], a[176:179], v[62:65]
    buffer_load_dwordx4 a[16:19], v23, s[8:11], s34 offen offset:1024 sc1
    v_mfma_f32_16x16x32_bf16 v[82:85], a[24:27], a[180:183], v[82:85]
    ds_read_b64_tr_b16 a[112:113], v252 offset:0
    v_mfma_f32_16x16x32_bf16 v[102:105], a[24:27], a[184:187], v[102:105]
    ds_read_b64_tr_b16 a[114:115], v252 offset:1024
    v_mfma_f32_16x16x32_bf16 v[122:125], a[24:27], a[188:191], v[122:125]
    s_waitcnt vmcnt(9)
    v_mfma_f32_16x16x32_bf16 v[66:69], a[28:31], a[176:179], v[66:69]
    buffer_load_dwordx4 a[20:23], v23, s[8:11], s34 offen offset:2048 sc1
    v_mfma_f32_16x16x32_bf16 v[86:89], a[28:31], a[180:183], v[86:89]
    ds_read_b64_tr_b16 a[116:117], v253 offset:0
    v_mfma_f32_16x16x32_bf16 v[106:109], a[28:31], a[184:187], v[106:109]
    ds_read_b64_tr_b16 a[118:119], v253 offset:1024
    v_mfma_f32_16x16x32_bf16 v[126:129], a[28:31], a[188:191], v[126:129]
    s_waitcnt vmcnt(9)
    v_mfma_f32_16x16x32_bf16 v[70:73], a[32:35], a[176:179], v[70:73]
    buffer_load_dwordx4 a[24:27], v23, s[8:11], s34 offen offset:3072 sc1
    v_mfma_f32_16x16x32_bf16 v[90:93], a[32:35], a[180:183], v[90:93]
    ds_read_b64_tr_b16 a[120:121], v254 offset:0
    v_mfma_f32_16x16x32_bf16 v[110:113], a[32:35], a[184:187], v[110:113]
    ds_read_b64_tr_b16 a[122:123], v254 offset:1024
    v_mfma_f32_16x16x32_bf16 v[130:133], a[32:35], a[188:191], v[130:133]
    s_waitcnt vmcnt(9)
    v_mfma_f32_16x16x32_bf16 v[74:77], a[36:39], a[176:179], v[74:77]
    buffer_load_dwordx4 a[28:31], v24, s[8:11], s34 offen offset:0 sc1
    v_mfma_f32_16x16x32_bf16 v[94:97], a[36:39], a[180:183], v[94:97]
    s_add_u32 s34, s34, 40960
    v_mfma_f32_16x16x32_bf16 v[114:117], a[36:39], a[184:187], v[114:117]
    ds_read_b64_tr_b16 a[124:125], v255 offset:0
    v_mfma_f32_16x16x32_bf16 v[134:137], a[36:39], a[188:191], v[134:137]
    ds_read_b64_tr_b16 a[126:127], v255 offset:1024
    s_waitcnt vmcnt(9)
    v_mfma_f32_16x16x32_bf16 v[58:61], a[40:43], a[160:163], v[58:61]
    buffer_load_dwordx4 a[32:35], v23, s[8:11], s34 offen offset:0 sc1
    v_mfma_f32_16x16x32_bf16 v[78:81], a[40:43], a[164:167], v[78:81]
    v_mfma_f32_16x16x32_bf16 v[98:101], a[40:43], a[168:171], v[98:101]
    v_mfma_f32_16x16x32_bf16 v[118:121], a[40:43], a[172:175], v[118:121]
    s_waitcnt vmcnt(9)
    v_mfma_f32_16x16x32_bf16 v[62:65], a[44:47], a[160:163], v[62:65]
    buffer_load_dwordx4 a[36:39], v23, s[8:11], s34 offen offset:1024 sc1
    v_mfma_f32_16x16x32_bf16 v[82:85], a[44:47], a[164:167], v[82:85]
    ds_read_b64_tr_b16 a[96:97], v252 offset:16384
    v_mfma_f32_16x16x32_bf16 v[102:105], a[44:47], a[168:171], v[102:105]
    ds_read_b64_tr_b16 a[98:99], v252 offset:17408
    v_mfma_f32_16x16x32_bf16 v[122:125], a[44:47], a[172:175], v[122:125]
    s_waitcnt vmcnt(9)
    v_mfma_f32_16x16x32_bf16 v[66:69], a[0:3], a[160:163], v[66:69]
    buffer_load_dwordx4 a[40:43], v23, s[8:11], s34 offen offset:2048 sc1
    v_mfma_f32_16x16x32_bf16 v[86:89], a[0:3], a[164:167], v[86:89]
    ds_read_b64_tr_b16 a[100:101], v253 offset:16384
    v_mfma_f32_16x16x32_bf16 v[106:109], a[0:3], a[168:171], v[106:109]
    ds_read_b64_tr_b16 a[102:103], v253 offset:17408
    v_mfma_f32_16x16x32_bf16 v[126:129], a[0:3], a[172:175], v[126:129]
    s_waitcnt vmcnt(9)
    v_mfma_f32_16x16x32_bf16 v[70:73], a[4:7], a[160:163], v[70:73]
    buffer_load_dwordx4 a[44:47], v23, s[8:11], s34 offen offset:3072 sc1
    v_mfma_f32_16x16x32_bf16 v[90:93], a[4:7], a[164:167], v[90:93]
    ds_read_b64_tr_b16 a[104:105], v254 offset:16384
    v_mfma_f32_16x16x32_bf16 v[110:113], a[4:7], a[168:171], v[110:113]
    ds_read_b64_tr_b16 a[106:107], v254 offset:17408
    v_mfma_f32_16x16x32_bf16 v[130:133], a[4:7], a[172:175], v[130:133]
    s_waitcnt vmcnt(9)
    v_mfma_f32_16x16x32_bf16 v[74:77], a[8:11], a[160:163], v[74:77]
    buffer_load_dwordx4 a[0:3], v24, s[8:11], s34 offen offset:0 sc1
    v_mfma_f32_16x16x32_bf16 v[94:97], a[8:11], a[164:167], v[94:97]
    s_add_u32 s34, s34, 40960
    v_mfma_f32_16x16x32_bf16 v[114:117], a[8:11], a[168:171], v[114:117]
    ds_read_b64_tr_b16 a[108:109], v255 offset:16384
    v_mfma_f32_16x16x32_bf16 v[134:137], a[8:11], a[172:175], v[134:137]
    ds_read_b64_tr_b16 a[110:111], v255 offset:17408
    s_waitcnt vmcnt(9)
    v_mfma_f32_16x16x32_bf16 v[58:61], a[12:15], a[144:147], v[58:61]
    buffer_load_dwordx4 a[4:7], v23, s[8:11], s34 offen offset:0 sc1
    v_mfma_f32_16x16x32_bf16 v[78:81], a[12:15], a[148:151], v[78:81]
    v_mfma_f32_16x16x32_bf16 v[98:101], a[12:15], a[152:155], v[98:101]
    v_mfma_f32_16x16x32_bf16 v[118:121], a[12:15], a[156:159], v[118:121]
    s_waitcnt vmcnt(9)
    v_mfma_f32_16x16x32_bf16 v[62:65], a[16:19], a[144:147], v[62:65]
    buffer_load_dwordx4 a[8:11], v23, s[8:11], s34 offen offset:1024 sc1
    v_mfma_f32_16x16x32_bf16 v[82:85], a[16:19], a[148:151], v[82:85]
    ds_read_b64_tr_b16 a[80:81], v31 offset:32768
    v_mfma_f32_16x16x32_bf16 v[102:105], a[16:19], a[152:155], v[102:105]
    ds_read_b64_tr_b16 a[82:83], v31 offset:33792
    v_mfma_f32_16x16x32_bf16 v[122:125], a[16:19], a[156:159], v[122:125]
    s_waitcnt vmcnt(9)
    v_mfma_f32_16x16x32_bf16 v[66:69], a[20:23], a[144:147], v[66:69]
    buffer_load_dwordx4 a[12:15], v23, s[8:11], s34 offen offset:2048 sc1
    v_mfma_f32_16x16x32_bf16 v[86:89], a[20:23], a[148:151], v[86:89]
    ds_read_b64_tr_b16 a[84:85], v32 offset:32768
    v_mfma_f32_16x16x32_bf16 v[106:109], a[20:23], a[152:155], v[106:109]
    ds_read_b64_tr_b16 a[86:87], v32 offset:33792
    v_mfma_f32_16x16x32_bf16 v[126:129], a[20:23], a[156:159], v[126:129]
    s_waitcnt vmcnt(9)
    v_mfma_f32_16x16x32_bf16 v[70:73], a[24:27], a[144:147], v[70:73]
    buffer_load_dwordx4 a[16:19], v23, s[8:11], s34 offen offset:3072 sc1
    v_mfma_f32_16x16x32_bf16 v[90:93], a[24:27], a[148:151], v[90:93]
    ds_read_b64_tr_b16 a[88:89], v33 offset:32768
    v_mfma_f32_16x16x32_bf16 v[110:113], a[24:27], a[152:155], v[110:113]
    ds_read_b64_tr_b16 a[90:91], v33 offset:33792
    v_mfma_f32_16x16x32_bf16 v[130:133], a[24:27], a[156:159], v[130:133]
    s_waitcnt vmcnt(9)
    v_mfma_f32_16x16x32_bf16 v[74:77], a[28:31], a[144:147], v[74:77]
    buffer_load_dwordx4 a[20:23], v24, s[8:11], s34 offen offset:0 sc1
    v_mfma_f32_16x16x32_bf16 v[94:97], a[28:31], a[148:151], v[94:97]
    s_add_u32 s34, s34, 40960
    v_mfma_f32_16x16x32_bf16 v[114:117], a[28:31], a[152:155], v[114:117]
    ds_read_b64_tr_b16 a[92:93], v34 offset:32768
    v_mfma_f32_16x16x32_bf16 v[134:137], a[28:31], a[156:159], v[134:137]
    ds_read_b64_tr_b16 a[94:95], v34 offset:33792
    s_waitcnt vmcnt(9) lgkmcnt(15)
    v_mfma_f32_16x16x32_bf16 v[58:61], a[32:35], a[128:131], v[58:61]
    buffer_load_dwordx4 a[24:27], v23, s[8:11], s34 offen offset:0 sc1
    v_mfma_f32_16x16x32_bf16 v[78:81], a[32:35], a[132:135], v[78:81]
    v_mfma_f32_16x16x32_bf16 v[98:101], a[32:35], a[136:139], v[98:101]
    v_mfma_f32_16x16x32_bf16 v[118:121], a[32:35], a[140:143], v[118:121]
    s_waitcnt vmcnt(9)
    v_mfma_f32_16x16x32_bf16 v[62:65], a[36:39], a[128:131], v[62:65]
    buffer_load_dwordx4 a[28:31], v23, s[8:11], s34 offen offset:1024 sc1
    v_mfma_f32_16x16x32_bf16 v[82:85], a[36:39], a[132:135], v[82:85]
    ds_read_b64_tr_b16 v[210:211], v252 offset:32768
    v_mfma_f32_16x16x32_bf16 v[102:105], a[36:39], a[136:139], v[102:105]
    ds_read_b64_tr_b16 v[212:213], v252 offset:33792
    v_mfma_f32_16x16x32_bf16 v[122:125], a[36:39], a[140:143], v[122:125]
    s_waitcnt vmcnt(9)
    v_mfma_f32_16x16x32_bf16 v[66:69], a[40:43], a[128:131], v[66:69]
    buffer_load_dwordx4 a[32:35], v23, s[8:11], s34 offen offset:2048 sc1
    v_mfma_f32_16x16x32_bf16 v[86:89], a[40:43], a[132:135], v[86:89]
    ds_read_b64_tr_b16 v[214:215], v253 offset:32768
    v_mfma_f32_16x16x32_bf16 v[106:109], a[40:43], a[136:139], v[106:109]
    ds_read_b64_tr_b16 v[216:217], v253 offset:33792
    v_mfma_f32_16x16x32_bf16 v[126:129], a[40:43], a[140:143], v[126:129]
    s_waitcnt vmcnt(9)
    v_mfma_f32_16x16x32_bf16 v[70:73], a[44:47], a[128:131], v[70:73]
    buffer_load_dwordx4 a[36:39], v23, s[8:11], s34 offen offset:3072 sc1
    v_mfma_f32_16x16x32_bf16 v[90:93], a[44:47], a[132:135], v[90:93]
    ds_read_b64_tr_b16 v[218:219], v254 offset:32768
    v_mfma_f32_16x16x32_bf16 v[110:113], a[44:47], a[136:139], v[110:113]
    ds_read_b64_tr_b16 v[220:221], v254 offset:33792
    v_mfma_f32_16x16x32_bf16 v[130:133], a[44:47], a[140:143], v[130:133]
    s_waitcnt vmcnt(9)
    v_mfma_f32_16x16x32_bf16 v[74:77], a[0:3], a[128:131], v[74:77]
    buffer_load_dwordx4 a[40:43], v24, s[8:11], s34 offen offset:0 sc1
    v_mfma_f32_16x16x32_bf16 v[94:97], a[0:3], a[132:135], v[94:97]
    s_add_u32 s34, s34, 40960
    v_mfma_f32_16x16x32_bf16 v[114:117], a[0:3], a[136:139], v[114:117]
    ds_read_b64_tr_b16 v[222:223], v255 offset:32768
    v_mfma_f32_16x16x32_bf16 v[134:137], a[0:3], a[140:143], v[134:137]
    ds_read_b64_tr_b16 v[224:225], v255 offset:33792
    s_waitcnt vmcnt(9)
    v_mfma_f32_16x16x32_bf16 v[58:61], a[4:7], a[112:115], v[58:61]
    buffer_load_dwordx4 a[44:47], v23, s[8:11], s34 offen offset:0 sc1
    v_mfma_f32_16x16x32_bf16 v[78:81], a[4:7], a[116:119], v[78:81]
    v_mfma_f32_16x16x32_bf16 v[98:101], a[4:7], a[120:123], v[98:101]
    v_mfma_f32_16x16x32_bf16 v[118:121], a[4:7], a[124:127], v[118:121]
    s_waitcnt vmcnt(9)
    v_mfma_f32_16x16x32_bf16 v[62:65], a[8:11], a[112:115], v[62:65]
    buffer_load_dwordx4 a[0:3], v23, s[8:11], s34 offen offset:1024 sc1
    v_mfma_f32_16x16x32_bf16 v[82:85], a[8:11], a[116:119], v[82:85]
    ds_read_b64_tr_b16 v[226:227], v252 offset:49152
    v_mfma_f32_16x16x32_bf16 v[102:105], a[8:11], a[120:123], v[102:105]
    ds_read_b64_tr_b16 v[228:229], v252 offset:50176
    v_mfma_f32_16x16x32_bf16 v[122:125], a[8:11], a[124:127], v[122:125]
    s_waitcnt vmcnt(9)
    v_mfma_f32_16x16x32_bf16 v[66:69], a[12:15], a[112:115], v[66:69]
    buffer_load_dwordx4 a[4:7], v23, s[8:11], s34 offen offset:2048 sc1
    v_mfma_f32_16x16x32_bf16 v[86:89], a[12:15], a[116:119], v[86:89]
    ds_read_b64_tr_b16 v[230:231], v253 offset:49152
    v_mfma_f32_16x16x32_bf16 v[106:109], a[12:15], a[120:123], v[106:109]
    ds_read_b64_tr_b16 v[232:233], v253 offset:50176
    v_mfma_f32_16x16x32_bf16 v[126:129], a[12:15], a[124:127], v[126:129]
    s_waitcnt vmcnt(9)
    v_mfma_f32_16x16x32_bf16 v[70:73], a[16:19], a[112:115], v[70:73]
    buffer_load_dwordx4 a[8:11], v23, s[8:11], s34 offen offset:3072 sc1
    v_mfma_f32_16x16x32_bf16 v[90:93], a[16:19], a[116:119], v[90:93]
    ds_read_b64_tr_b16 v[234:235], v254 offset:49152
    v_mfma_f32_16x16x32_bf16 v[110:113], a[16:19], a[120:123], v[110:113]
    ds_read_b64_tr_b16 v[236:237], v254 offset:50176
    v_mfma_f32_16x16x32_bf16 v[130:133], a[16:19], a[124:127], v[130:133]
    s_waitcnt vmcnt(9)
    v_mfma_f32_16x16x32_bf16 v[74:77], a[20:23], a[112:115], v[74:77]
    buffer_load_dwordx4 a[12:15], v24, s[8:11], s34 offen offset:0 sc1
    v_mfma_f32_16x16x32_bf16 v[94:97], a[20:23], a[116:119], v[94:97]
    s_add_u32 s34, s34, 40960
    v_mfma_f32_16x16x32_bf16 v[114:117], a[20:23], a[120:123], v[114:117]
    ds_read_b64_tr_b16 v[238:239], v255 offset:49152
    v_mfma_f32_16x16x32_bf16 v[134:137], a[20:23], a[124:127], v[134:137]
    ds_read_b64_tr_b16 v[240:241], v255 offset:50176
    s_waitcnt vmcnt(9) lgkmcnt(15)
    v_mfma_f32_16x16x32_bf16 v[58:61], a[24:27], a[96:99], v[58:61]
    buffer_load_dwordx4 a[16:19], v23, s[8:11], s34 offen offset:0 sc1
    v_mfma_f32_16x16x32_bf16 v[78:81], a[24:27], a[100:103], v[78:81]
    v_mfma_f32_16x16x32_bf16 v[98:101], a[24:27], a[104:107], v[98:101]
    v_mfma_f32_16x16x32_bf16 v[118:121], a[24:27], a[108:111], v[118:121]
    s_waitcnt vmcnt(9)
    v_mfma_f32_16x16x32_bf16 v[62:65], a[28:31], a[96:99], v[62:65]
    buffer_load_dwordx4 a[20:23], v23, s[8:11], s34 offen offset:1024 sc1
    v_mfma_f32_16x16x32_bf16 v[82:85], a[28:31], a[100:103], v[82:85]
    ds_read_b64_tr_b16 a[240:241], v31 offset:0
    v_mfma_f32_16x16x32_bf16 v[102:105], a[28:31], a[104:107], v[102:105]
    ds_read_b64_tr_b16 a[242:243], v31 offset:1024
    v_mfma_f32_16x16x32_bf16 v[122:125], a[28:31], a[108:111], v[122:125]
    s_waitcnt vmcnt(9)
    v_mfma_f32_16x16x32_bf16 v[66:69], a[32:35], a[96:99], v[66:69]
    buffer_load_dwordx4 a[24:27], v23, s[8:11], s34 offen offset:2048 sc1
    v_mfma_f32_16x16x32_bf16 v[86:89], a[32:35], a[100:103], v[86:89]
    ds_read_b64_tr_b16 a[244:245], v32 offset:0
    v_mfma_f32_16x16x32_bf16 v[106:109], a[32:35], a[104:107], v[106:109]
    ds_read_b64_tr_b16 a[246:247], v32 offset:1024
    v_mfma_f32_16x16x32_bf16 v[126:129], a[32:35], a[108:111], v[126:129]
    s_waitcnt vmcnt(9)
    v_mfma_f32_16x16x32_bf16 v[70:73], a[36:39], a[96:99], v[70:73]
    buffer_load_dwordx4 a[28:31], v23, s[8:11], s34 offen offset:3072 sc1
    v_mfma_f32_16x16x32_bf16 v[90:93], a[36:39], a[100:103], v[90:93]
    ds_read_b64_tr_b16 a[248:249], v33 offset:0
    v_mfma_f32_16x16x32_bf16 v[110:113], a[36:39], a[104:107], v[110:113]
    ds_read_b64_tr_b16 a[250:251], v33 offset:1024
    v_mfma_f32_16x16x32_bf16 v[130:133], a[36:39], a[108:111], v[130:133]
    s_waitcnt vmcnt(9)
    v_mfma_f32_16x16x32_bf16 v[74:77], a[40:43], a[96:99], v[74:77]
    buffer_load_dwordx4 a[32:35], v24, s[8:11], s34 offen offset:0 sc1
    v_mfma_f32_16x16x32_bf16 v[94:97], a[40:43], a[100:103], v[94:97]
    s_add_u32 s34, s34, 40960
    v_mfma_f32_16x16x32_bf16 v[114:117], a[40:43], a[104:107], v[114:117]
    ds_read_b64_tr_b16 a[252:253], v34 offset:0
    v_mfma_f32_16x16x32_bf16 v[134:137], a[40:43], a[108:111], v[134:137]
    ds_read_b64_tr_b16 a[254:255], v34 offset:1024
    s_waitcnt vmcnt(9)
    v_mfma_f32_16x16x32_bf16 v[58:61], a[44:47], a[80:83], v[58:61]
    buffer_load_dwordx4 a[36:39], v23, s[8:11], s34 offen offset:0 sc1
    v_mfma_f32_16x16x32_bf16 v[78:81], a[44:47], a[84:87], v[78:81]
    v_mfma_f32_16x16x32_bf16 v[98:101], a[44:47], a[88:91], v[98:101]
    v_mfma_f32_16x16x32_bf16 v[118:121], a[44:47], a[92:95], v[118:121]
    s_waitcnt vmcnt(9)
    v_mfma_f32_16x16x32_bf16 v[62:65], a[0:3], a[80:83], v[62:65]
    buffer_load_dwordx4 a[40:43], v23, s[8:11], s34 offen offset:1024 sc1
    v_mfma_f32_16x16x32_bf16 v[82:85], a[0:3], a[84:87], v[82:85]
    ds_read_b64_tr_b16 a[224:225], v31 offset:16384
    v_mfma_f32_16x16x32_bf16 v[102:105], a[0:3], a[88:91], v[102:105]
    ds_read_b64_tr_b16 a[226:227], v31 offset:17408
    v_mfma_f32_16x16x32_bf16 v[122:125], a[0:3], a[92:95], v[122:125]
    s_waitcnt vmcnt(9)
    v_mfma_f32_16x16x32_bf16 v[66:69], a[4:7], a[80:83], v[66:69]
    buffer_load_dwordx4 a[44:47], v23, s[8:11], s34 offen offset:2048 sc1
    v_mfma_f32_16x16x32_bf16 v[86:89], a[4:7], a[84:87], v[86:89]
    ds_read_b64_tr_b16 a[228:229], v32 offset:16384
    v_mfma_f32_16x16x32_bf16 v[106:109], a[4:7], a[88:91], v[106:109]
    ds_read_b64_tr_b16 a[230:231], v32 offset:17408
    v_mfma_f32_16x16x32_bf16 v[126:129], a[4:7], a[92:95], v[126:129]
    s_waitcnt vmcnt(9)
    v_mfma_f32_16x16x32_bf16 v[70:73], a[8:11], a[80:83], v[70:73]
    buffer_load_dwordx4 a[0:3], v23, s[8:11], s34 offen offset:3072 sc1
    v_mfma_f32_16x16x32_bf16 v[90:93], a[8:11], a[84:87], v[90:93]
    ds_read_b64_tr_b16 a[232:233], v33 offset:16384
    v_mfma_f32_16x16x32_bf16 v[110:113], a[8:11], a[88:91], v[110:113]
    ds_read_b64_tr_b16 a[234:235], v33 offset:17408
    v_mfma_f32_16x16x32_bf16 v[130:133], a[8:11], a[92:95], v[130:133]
    s_waitcnt vmcnt(9)
    v_mfma_f32_16x16x32_bf16 v[74:77], a[12:15], a[80:83], v[74:77]
    buffer_load_dwordx4 a[4:7], v24, s[8:11], s34 offen offset:0 sc1
    v_mfma_f32_16x16x32_bf16 v[94:97], a[12:15], a[84:87], v[94:97]
    s_add_u32 s34, s34, 40960
    v_mfma_f32_16x16x32_bf16 v[114:117], a[12:15], a[88:91], v[114:117]
    ds_read_b64_tr_b16 a[236:237], v34 offset:16384
    v_mfma_f32_16x16x32_bf16 v[134:137], a[12:15], a[92:95], v[134:137]
    ds_read_b64_tr_b16 a[238:239], v34 offset:17408
    s_waitcnt vmcnt(9) lgkmcnt(15)
    v_mfma_f32_16x16x32_bf16 v[58:61], a[16:19], v[210:213], v[58:61]
    buffer_load_dwordx4 a[8:11], v23, s[8:11], s34 offen offset:0 sc1
    v_mfma_f32_16x16x32_bf16 v[78:81], a[16:19], v[214:217], v[78:81]
    v_mfma_f32_16x16x32_bf16 v[98:101], a[16:19], v[218:221], v[98:101]
    v_mfma_f32_16x16x32_bf16 v[118:121], a[16:19], v[222:225], v[118:121]
    s_waitcnt vmcnt(9)
    v_mfma_f32_16x16x32_bf16 v[62:65], a[20:23], v[210:213], v[62:65]
    buffer_load_dwordx4 a[12:15], v23, s[8:11], s34 offen offset:1024 sc1
    v_mfma_f32_16x16x32_bf16 v[82:85], a[20:23], v[214:217], v[82:85]
    ds_read_b64_tr_b16 a[208:209], v31 offset:49152
    v_mfma_f32_16x16x32_bf16 v[102:105], a[20:23], v[218:221], v[102:105]
    ds_read_b64_tr_b16 a[210:211], v31 offset:50176
    v_mfma_f32_16x16x32_bf16 v[122:125], a[20:23], v[222:225], v[122:125]
    s_waitcnt vmcnt(9)
    v_mfma_f32_16x16x32_bf16 v[66:69], a[24:27], v[210:213], v[66:69]
    buffer_load_dwordx4 a[16:19], v23, s[8:11], s34 offen offset:2048 sc1
    v_mfma_f32_16x16x32_bf16 v[86:89], a[24:27], v[214:217], v[86:89]
    ds_read_b64_tr_b16 a[212:213], v32 offset:49152
    v_mfma_f32_16x16x32_bf16 v[106:109], a[24:27], v[218:221], v[106:109]
    ds_read_b64_tr_b16 a[214:215], v32 offset:50176
    v_mfma_f32_16x16x32_bf16 v[126:129], a[24:27], v[222:225], v[126:129]
    s_waitcnt vmcnt(9)
    v_mfma_f32_16x16x32_bf16 v[70:73], a[28:31], v[210:213], v[70:73]
    buffer_load_dwordx4 a[20:23], v23, s[8:11], s34 offen offset:3072 sc1
    v_mfma_f32_16x16x32_bf16 v[90:93], a[28:31], v[214:217], v[90:93]
    ds_read_b64_tr_b16 a[216:217], v33 offset:49152
    v_mfma_f32_16x16x32_bf16 v[110:113], a[28:31], v[218:221], v[110:113]
    ds_read_b64_tr_b16 a[218:219], v33 offset:50176
    v_mfma_f32_16x16x32_bf16 v[130:133], a[28:31], v[222:225], v[130:133]
    s_waitcnt vmcnt(9)
    v_mfma_f32_16x16x32_bf16 v[74:77], a[32:35], v[210:213], v[74:77]
    buffer_load_dwordx4 a[24:27], v24, s[8:11], s34 offen offset:0 sc1
    v_mfma_f32_16x16x32_bf16 v[94:97], a[32:35], v[214:217], v[94:97]
    s_add_u32 s34, s34, 40960
    v_mfma_f32_16x16x32_bf16 v[114:117], a[32:35], v[218:221], v[114:117]
    ds_read_b64_tr_b16 a[220:221], v34 offset:49152
    v_mfma_f32_16x16x32_bf16 v[134:137], a[32:35], v[222:225], v[134:137]
    ds_read_b64_tr_b16 a[222:223], v34 offset:50176
    s_waitcnt vmcnt(9)
    v_mfma_f32_16x16x32_bf16 v[58:61], a[36:39], v[226:229], v[58:61]
    buffer_load_dwordx4 a[28:31], v23, s[8:11], s34 offen offset:0 sc1
    v_mfma_f32_16x16x32_bf16 v[78:81], a[36:39], v[230:233], v[78:81]
    v_mfma_f32_16x16x32_bf16 v[98:101], a[36:39], v[234:237], v[98:101]
    v_mfma_f32_16x16x32_bf16 v[118:121], a[36:39], v[238:241], v[118:121]
    s_waitcnt vmcnt(9)
    v_mfma_f32_16x16x32_bf16 v[62:65], a[40:43], v[226:229], v[62:65]
    buffer_load_dwordx4 a[32:35], v23, s[8:11], s34 offen offset:1024 sc1
    v_mfma_f32_16x16x32_bf16 v[82:85], a[40:43], v[230:233], v[82:85]
    ds_read_b64_tr_b16 a[192:193], v35 offset:0
    v_mfma_f32_16x16x32_bf16 v[102:105], a[40:43], v[234:237], v[102:105]
    ds_read_b64_tr_b16 a[194:195], v35 offset:1024
    v_mfma_f32_16x16x32_bf16 v[122:125], a[40:43], v[238:241], v[122:125]
    s_waitcnt vmcnt(9)
    v_mfma_f32_16x16x32_bf16 v[66:69], a[44:47], v[226:229], v[66:69]
    buffer_load_dwordx4 a[36:39], v23, s[8:11], s34 offen offset:2048 sc1
    v_mfma_f32_16x16x32_bf16 v[86:89], a[44:47], v[230:233], v[86:89]
    ds_read_b64_tr_b16 a[196:197], v36 offset:0
    v_mfma_f32_16x16x32_bf16 v[106:109], a[44:47], v[234:237], v[106:109]
    ds_read_b64_tr_b16 a[198:199], v36 offset:1024
    v_mfma_f32_16x16x32_bf16 v[126:129], a[44:47], v[238:241], v[126:129]
    s_waitcnt vmcnt(9)
    v_mfma_f32_16x16x32_bf16 v[70:73], a[0:3], v[226:229], v[70:73]
    buffer_load_dwordx4 a[40:43], v23, s[8:11], s34 offen offset:3072 sc1
    v_mfma_f32_16x16x32_bf16 v[90:93], a[0:3], v[230:233], v[90:93]
    ds_read_b64_tr_b16 a[200:201], v37 offset:0
    v_mfma_f32_16x16x32_bf16 v[110:113], a[0:3], v[234:237], v[110:113]
    ds_read_b64_tr_b16 a[202:203], v37 offset:1024
    v_mfma_f32_16x16x32_bf16 v[130:133], a[0:3], v[238:241], v[130:133]
    s_waitcnt vmcnt(9)
    v_mfma_f32_16x16x32_bf16 v[74:77], a[4:7], v[226:229], v[74:77]
    buffer_load_dwordx4 a[44:47], v24, s[8:11], s34 offen offset:0 sc1
    v_mfma_f32_16x16x32_bf16 v[94:97], a[4:7], v[230:233], v[94:97]
    s_add_u32 s34, s34, 40960
    v_mfma_f32_16x16x32_bf16 v[114:117], a[4:7], v[234:237], v[114:117]
    ds_read_b64_tr_b16 a[204:205], v38 offset:0
    v_mfma_f32_16x16x32_bf16 v[134:137], a[4:7], v[238:241], v[134:137]
    ds_read_b64_tr_b16 a[206:207], v38 offset:1024
    s_waitcnt vmcnt(9) lgkmcnt(15)
    v_mfma_f32_16x16x32_bf16 v[58:61], a[8:11], a[240:243], v[58:61]
    buffer_load_dwordx4 a[0:3], v23, s[8:11], s34 offen offset:0 sc1
    v_mfma_f32_16x16x32_bf16 v[78:81], a[8:11], a[244:247], v[78:81]
    v_mfma_f32_16x16x32_bf16 v[98:101], a[8:11], a[248:251], v[98:101]
    v_mfma_f32_16x16x32_bf16 v[118:121], a[8:11], a[252:255], v[118:121]
    s_waitcnt vmcnt(9)
    v_mfma_f32_16x16x32_bf16 v[62:65], a[12:15], a[240:243], v[62:65]
    buffer_load_dwordx4 a[4:7], v23, s[8:11], s34 offen offset:1024 sc1
    v_mfma_f32_16x16x32_bf16 v[82:85], a[12:15], a[244:247], v[82:85]
    v_mfma_f32_16x16x32_bf16 v[102:105], a[12:15], a[248:251], v[102:105]
    v_mfma_f32_16x16x32_bf16 v[122:125], a[12:15], a[252:255], v[122:125]
    s_waitcnt vmcnt(9)
    v_mfma_f32_16x16x32_bf16 v[66:69], a[16:19], a[240:243], v[66:69]
    buffer_load_dwordx4 a[8:11], v23, s[8:11], s34 offen offset:2048 sc1
    v_mfma_f32_16x16x32_bf16 v[86:89], a[16:19], a[244:247], v[86:89]
    v_mfma_f32_16x16x32_bf16 v[106:109], a[16:19], a[248:251], v[106:109]
    v_mfma_f32_16x16x32_bf16 v[126:129], a[16:19], a[252:255], v[126:129]
    s_waitcnt vmcnt(9)
    v_mfma_f32_16x16x32_bf16 v[70:73], a[20:23], a[240:243], v[70:73]
    buffer_load_dwordx4 a[12:15], v23, s[8:11], s34 offen offset:3072 sc1
    v_mfma_f32_16x16x32_bf16 v[90:93], a[20:23], a[244:247], v[90:93]
    v_mfma_f32_16x16x32_bf16 v[110:113], a[20:23], a[248:251], v[110:113]
    v_mfma_f32_16x16x32_bf16 v[130:133], a[20:23], a[252:255], v[130:133]
    s_waitcnt vmcnt(9)
    v_mfma_f32_16x16x32_bf16 v[74:77], a[24:27], a[240:243], v[74:77]
    buffer_load_dwordx4 a[16:19], v24, s[8:11], s34 offen offset:0 sc1
    v_mfma_f32_16x16x32_bf16 v[94:97], a[24:27], a[244:247], v[94:97]
    v_mfma_f32_16x16x32_bf16 v[114:117], a[24:27], a[248:251], v[114:117]
    s_add_u32 s34, s34, 40960
    v_mfma_f32_16x16x32_bf16 v[134:137], a[24:27], a[252:255], v[134:137]
    s_waitcnt vmcnt(9)
    v_mfma_f32_16x16x32_bf16 v[58:61], a[28:31], a[224:227], v[58:61]
    buffer_load_dwordx4 a[20:23], v23, s[8:11], s34 offen offset:0 sc1
    v_mfma_f32_16x16x32_bf16 v[78:81], a[28:31], a[228:231], v[78:81]
    v_mfma_f32_16x16x32_bf16 v[98:101], a[28:31], a[232:235], v[98:101]
    v_mfma_f32_16x16x32_bf16 v[118:121], a[28:31], a[236:239], v[118:121]
    s_waitcnt vmcnt(9)
    v_mfma_f32_16x16x32_bf16 v[62:65], a[32:35], a[224:227], v[62:65]
    buffer_load_dwordx4 a[24:27], v23, s[8:11], s34 offen offset:1024 sc1
    v_mfma_f32_16x16x32_bf16 v[82:85], a[32:35], a[228:231], v[82:85]
    v_mfma_f32_16x16x32_bf16 v[102:105], a[32:35], a[232:235], v[102:105]
    v_mfma_f32_16x16x32_bf16 v[122:125], a[32:35], a[236:239], v[122:125]
    s_waitcnt vmcnt(9)
    v_mfma_f32_16x16x32_bf16 v[66:69], a[36:39], a[224:227], v[66:69]
    buffer_load_dwordx4 a[28:31], v23, s[8:11], s34 offen offset:2048 sc1
    v_mfma_f32_16x16x32_bf16 v[86:89], a[36:39], a[228:231], v[86:89]
    v_mfma_f32_16x16x32_bf16 v[106:109], a[36:39], a[232:235], v[106:109]
    v_mfma_f32_16x16x32_bf16 v[126:129], a[36:39], a[236:239], v[126:129]
    s_waitcnt vmcnt(9)
    v_mfma_f32_16x16x32_bf16 v[70:73], a[40:43], a[224:227], v[70:73]
    buffer_load_dwordx4 a[32:35], v23, s[8:11], s34 offen offset:3072 sc1
    v_mfma_f32_16x16x32_bf16 v[90:93], a[40:43], a[228:231], v[90:93]
    v_mfma_f32_16x16x32_bf16 v[110:113], a[40:43], a[232:235], v[110:113]
    v_mfma_f32_16x16x32_bf16 v[130:133], a[40:43], a[236:239], v[130:133]
    s_waitcnt vmcnt(9)
    v_mfma_f32_16x16x32_bf16 v[74:77], a[44:47], a[224:227], v[74:77]
    buffer_load_dwordx4 a[36:39], v24, s[8:11], s34 offen offset:0 sc1
    v_mfma_f32_16x16x32_bf16 v[94:97], a[44:47], a[228:231], v[94:97]
    v_mfma_f32_16x16x32_bf16 v[114:117], a[44:47], a[232:235], v[114:117]
    s_add_u32 s34, s34, 40960
    v_mfma_f32_16x16x32_bf16 v[134:137], a[44:47], a[236:239], v[134:137]
    s_waitcnt vmcnt(9) lgkmcnt(14)
    v_mfma_f32_16x16x32_bf16 v[58:61], a[0:3], a[208:211], v[58:61]
    s_waitcnt lgkmcnt(12)
    v_mfma_f32_16x16x32_bf16 v[78:81], a[0:3], a[212:215], v[78:81]
    s_waitcnt lgkmcnt(10)
    v_mfma_f32_16x16x32_bf16 v[98:101], a[0:3], a[216:219], v[98:101]
    s_waitcnt lgkmcnt(8)
    v_mfma_f32_16x16x32_bf16 v[118:121], a[0:3], a[220:223], v[118:121]
    s_waitcnt vmcnt(8)
    v_mfma_f32_16x16x32_bf16 v[62:65], a[4:7], a[208:211], v[62:65]
    v_mfma_f32_16x16x32_bf16 v[82:85], a[4:7], a[212:215], v[82:85]
    v_mfma_f32_16x16x32_bf16 v[102:105], a[4:7], a[216:219], v[102:105]
    v_mfma_f32_16x16x32_bf16 v[122:125], a[4:7], a[220:223], v[122:125]
    s_waitcnt vmcnt(7)
    v_mfma_f32_16x16x32_bf16 v[66:69], a[8:11], a[208:211], v[66:69]
    v_mfma_f32_16x16x32_bf16 v[86:89], a[8:11], a[212:215], v[86:89]
    v_mfma_f32_16x16x32_bf16 v[106:109], a[8:11], a[216:219], v[106:109]
    v_mfma_f32_16x16x32_bf16 v[126:129], a[8:11], a[220:223], v[126:129]
    s_waitcnt vmcnt(6)
    v_mfma_f32_16x16x32_bf16 v[70:73], a[12:15], a[208:211], v[70:73]
    v_mfma_f32_16x16x32_bf16 v[90:93], a[12:15], a[212:215], v[90:93]
    v_mfma_f32_16x16x32_bf16 v[110:113], a[12:15], a[216:219], v[110:113]
    v_mfma_f32_16x16x32_bf16 v[130:133], a[12:15], a[220:223], v[130:133]
    s_waitcnt vmcnt(5)
    v_mfma_f32_16x16x32_bf16 v[74:77], a[16:19], a[208:211], v[74:77]
    v_mfma_f32_16x16x32_bf16 v[94:97], a[16:19], a[212:215], v[94:97]
    v_mfma_f32_16x16x32_bf16 v[114:117], a[16:19], a[216:219], v[114:117]
    v_mfma_f32_16x16x32_bf16 v[134:137], a[16:19], a[220:223], v[134:137]
    s_waitcnt vmcnt(4) lgkmcnt(4)
    v_mfma_f32_16x16x32_bf16 v[78:81], a[20:23], a[196:199], v[78:81]
    s_waitcnt lgkmcnt(2)
    v_mfma_f32_16x16x32_bf16 v[98:101], a[20:23], a[200:203], v[98:101]
    s_waitcnt lgkmcnt(0)
    v_mfma_f32_16x16x32_bf16 v[118:121], a[20:23], a[204:207], v[118:121]
    s_waitcnt vmcnt(3)
    v_mfma_f32_16x16x32_bf16 v[82:85], a[24:27], a[196:199], v[82:85]
    s_nop 1
    ds_write_b128 v39, v[78:81] offset:0
    v_mfma_f32_16x16x32_bf16 v[102:105], a[24:27], a[200:203], v[102:105]
    ds_write_b128 v39, v[98:101] offset:17408
    v_mfma_f32_16x16x32_bf16 v[122:125], a[24:27], a[204:207], v[122:125]
    ds_write_b128 v39, v[118:121] offset:34816
    s_waitcnt vmcnt(2)
    v_mfma_f32_16x16x32_bf16 v[86:89], a[28:31], a[196:199], v[86:89]
    ds_write_b128 v39, v[82:85] offset:1024
    v_mfma_f32_16x16x32_bf16 v[106:109], a[28:31], a[200:203], v[106:109]
    s_nop 0
    ds_write_b128 v39, v[102:105] offset:18432
    v_mfma_f32_16x16x32_bf16 v[126:129], a[28:31], a[204:207], v[126:129]
    ds_write_b128 v39, v[122:125] offset:35840
    s_waitcnt vmcnt(1)
    v_mfma_f32_16x16x32_bf16 v[90:93], a[32:35], a[196:199], v[90:93]
    ds_write_b128 v39, v[86:89] offset:2048
    v_mfma_f32_16x16x32_bf16 v[110:113], a[32:35], a[200:203], v[110:113]
    ds_write_b128 v39, v[106:109] offset:19456
    v_mfma_f32_16x16x32_bf16 v[130:133], a[32:35], a[204:207], v[130:133]
    s_nop 0
    ds_write_b128 v39, v[126:129] offset:49152
    s_waitcnt vmcnt(0)
    v_mfma_f32_16x16x32_bf16 v[94:97], a[36:39], a[196:199], v[94:97]
    ds_write_b128 v39, v[90:93] offset:3072
    v_mfma_f32_16x16x32_bf16 v[114:117], a[36:39], a[200:203], v[114:117]
    ds_write_b128 v39, v[110:113] offset:32768
    v_mfma_f32_16x16x32_bf16 v[134:137], a[36:39], a[204:207], v[134:137]
    ds_write_b128 v39, v[130:133] offset:50176
    v_mfma_f32_16x16x32_bf16 v[58:61], a[20:23], a[192:195], v[58:61]
    s_nop 1
    ds_write_b128 v39, v[94:97] offset:16384
    v_mfma_f32_16x16x32_bf16 v[62:65], a[24:27], a[192:195], v[62:65]
    ds_write_b128 v39, v[114:117] offset:33792
    v_mfma_f32_16x16x32_bf16 v[66:69], a[28:31], a[192:195], v[66:69]
    ds_write_b128 v39, v[134:137] offset:51200
    v_mfma_f32_16x16x32_bf16 v[70:73], a[32:35], a[192:195], v[70:73]
    v_mfma_f32_16x16x32_bf16 v[74:77], a[36:39], a[192:195], v[74:77]
    s_waitcnt lgkmcnt(0)
    s_barrier
    ds_read_b128 v[138:141], v40 offset:0
    ds_read_b128 v[158:161], v41 offset:17408
    ds_read_b128 v[178:181], v42 offset:34816
    ds_read_b128 v[142:145], v40 offset:1024
    ds_read_b128 v[162:165], v41 offset:18432
    ds_read_b128 v[182:185], v42 offset:35840
    ds_read_b128 v[146:149], v40 offset:2048
    ds_read_b128 v[166:169], v41 offset:19456
    ds_read_b128 v[186:189], v42 offset:49152
    ds_read_b128 v[150:153], v40 offset:3072
    ds_read_b128 v[170:173], v41 offset:32768
    ds_read_b128 v[190:193], v42 offset:50176
    ds_read_b128 v[154:157], v40 offset:16384
    ds_read_b128 v[174:177], v41 offset:33792
    ds_read_b128 v[194:197], v42 offset:51200
    s_waitcnt lgkmcnt(14)
    v_pk_add_f32 v[58:59], v[58:59], v[138:139]
    v_pk_add_f32 v[60:61], v[60:61], v[140:141]
    s_waitcnt lgkmcnt(12)
    v_pk_add_f32 v[158:159], v[158:159], v[178:179]
    v_pk_add_f32 v[160:161], v[160:161], v[180:181]
    v_pk_add_f32 v[58:59], v[58:59], v[158:159]
    v_pk_add_f32 v[60:61], v[60:61], v[160:161]
    v_cvt_pk_bf16_f32 v198, v58, v59
    v_cvt_pk_bf16_f32 v199, v60, v61
    s_waitcnt lgkmcnt(11)
    v_pk_add_f32 v[62:63], v[62:63], v[142:143]
    ds_write_b64 v55, v[198:199] offset:0
    s_waitcnt lgkmcnt(10)
    v_pk_add_f32 v[162:163], v[162:163], v[182:183]
    v_pk_add_f32 v[64:65], v[64:65], v[144:145]
    v_pk_add_f32 v[164:165], v[164:165], v[184:185]
    v_pk_add_f32 v[62:63], v[62:63], v[162:163]
    v_pk_add_f32 v[64:65], v[64:65], v[164:165]
    v_cvt_pk_bf16_f32 v200, v62, v63
    v_cvt_pk_bf16_f32 v201, v64, v65
    s_waitcnt lgkmcnt(9)
    v_pk_add_f32 v[66:67], v[66:67], v[146:147]
    ds_write_b64 v55, v[200:201] offset:32
    s_waitcnt lgkmcnt(8)
    v_pk_add_f32 v[166:167], v[166:167], v[186:187]
    v_pk_add_f32 v[68:69], v[68:69], v[148:149]
    v_pk_add_f32 v[168:169], v[168:169], v[188:189]
    v_pk_add_f32 v[66:67], v[66:67], v[166:167]
    v_pk_add_f32 v[68:69], v[68:69], v[168:169]
    v_cvt_pk_bf16_f32 v202, v66, v67
    v_cvt_pk_bf16_f32 v203, v68, v69
    s_waitcnt lgkmcnt(7)
    v_pk_add_f32 v[70:71], v[70:71], v[150:151]
    ds_write_b64 v55, v[202:203] offset:64
    s_waitcnt lgkmcnt(6)
    v_pk_add_f32 v[170:171], v[170:171], v[190:191]
    v_pk_add_f32 v[72:73], v[72:73], v[152:153]
    v_pk_add_f32 v[172:173], v[172:173], v[192:193]
    v_pk_add_f32 v[70:71], v[70:71], v[170:171]
    v_pk_add_f32 v[72:73], v[72:73], v[172:173]
    v_cvt_pk_bf16_f32 v204, v70, v71
    v_cvt_pk_bf16_f32 v205, v72, v73
    s_waitcnt lgkmcnt(5)
    v_pk_add_f32 v[74:75], v[74:75], v[154:155]
    ds_write_b64 v55, v[204:205] offset:96
    s_waitcnt lgkmcnt(4)
    v_pk_add_f32 v[174:175], v[174:175], v[194:195]
    v_pk_add_f32 v[76:77], v[76:77], v[156:157]
    v_pk_add_f32 v[176:177], v[176:177], v[196:197]
    v_pk_add_f32 v[74:75], v[74:75], v[174:175]
    v_pk_add_f32 v[76:77], v[76:77], v[176:177]
    v_cvt_pk_bf16_f32 v206, v74, v75
    v_cvt_pk_bf16_f32 v207, v76, v77
    ds_write_b64 v55, v[206:207] offset:128
    ds_read_b128 v[138:141], v56 offset:0
    ds_read_b128 v[142:145], v56 offset:1024
    ds_read_b128 v[146:149], v56 offset:2048
    s_waitcnt lgkmcnt(2)
    buffer_store_dwordx4 v[138:141], v52, s[12:15], s35 offen
    s_waitcnt lgkmcnt(1)
    buffer_store_dwordx4 v[142:145], v53, s[12:15], s35 offen
    s_waitcnt lgkmcnt(0)
    buffer_store_dwordx4 v[146:149], v54, s[12:15], s35 offen
K_exit:
    s_endpgm
D_skip:
    v_lshrrev_b32 v20, 2, v1
    v_and_b32 v22, 3, v1
    v_lshlrev_b32 v22, 7, v22
    v_lshl_add_u32 v20, v20, 12, v22
    s_lshr_b32 s28, s94, 2
    s_lshl_b32 s28, s28, 9
    v_add_u32 v20, s28, v20
    s_sub_u32 s32, s85, 27
    s_lshl2_add_u32 s32, s32, s3
    s_add_u32 s32, s32, 16
    s_lshr_b32 s28, s32, 3
    s_lshl_b32 s28, s28, 1
    s_and_b32 s29, s32, 1
    s_add_u32 s28, s28, s29
    s_bfe_u32 s29, s32, 0x20001
    s_mul_i32 s29, s29, 28
    s_add_u32 s28, s28, s29
    s_lshl_b32 s28, s28, 16
    v_add_u32 v22, s28, v20
    buffer_load_dword v250, v22, s[20:23], 0 offen
    s_add_u32 s32, s32, 20
    s_lshr_b32 s28, s32, 3
    s_lshl_b32 s28, s28, 1
    s_and_b32 s29, s32, 1
    s_add_u32 s28, s28, s29
    s_bfe_u32 s29, s32, 0x20001
    s_mul_i32 s29, s29, 28
    s_add_u32 s28, s28, s29
    s_lshl_b32 s28, s28, 16
    v_add_u32 v22, s28, v20
    buffer_load_dword v250, v22, s[20:23], 0 offen
    s_add_u32 s32, s32, 20
    s_lshr_b32 s28, s32, 3
    s_lshl_b32 s28, s28, 1
    s_and_b32 s29, s32, 1
    s_add_u32 s28, s28, s29
    s_bfe_u32 s29, s32, 0x20001
    s_mul_i32 s29, s29, 28
    s_add_u32 s28, s28, s29
    s_lshl_b32 s28, s28, 16
    v_add_u32 v22, s28, v20
    buffer_load_dword v250, v22, s[20:23], 0 offen
    s_add_u32 s32, s32, 20
    s_lshr_b32 s28, s32, 3
    s_lshl_b32 s28, s28, 1
    s_and_b32 s29, s32, 1
    s_add_u32 s28, s28, s29
    s_bfe_u32 s29, s32, 0x20001
    s_mul_i32 s29, s29, 28
    s_add_u32 s28, s28, s29
    s_lshl_b32 s28, s28, 16
    v_add_u32 v22, s28, v20
    buffer_load_dword v250, v22, s[20:23], 0 offen
    s_add_u32 s32, s32, 20
    s_lshr_b32 s28, s32, 3
    s_lshl_b32 s28, s28, 1
    s_and_b32 s29, s32, 1
    s_add_u32 s28, s28, s29
    s_bfe_u32 s29, s32, 0x20001
    s_mul_i32 s29, s29, 28
    s_add_u32 s28, s28, s29
    s_lshl_b32 s28, s28, 16
    v_add_u32 v22, s28, v20
    buffer_load_dword v250, v22, s[20:23], 0 offen
    s_add_u32 s32, s32, 20
    s_waitcnt vmcnt(0)
    s_add_u32 m0, s93, 81920
    s_nop 0
    buffer_load_dwordx4 v27, s[20:23], s31 offen offset:0 lds
    buffer_load_dwordx4 v28, s[20:23], s31 offen offset:1024 lds
    buffer_load_dwordx4 v29, s[20:23], s31 offen offset:2048 lds
    buffer_load_dwordx4 v30, s[20:23], s31 offen offset:3072 lds
    s_add_u32 s31, s31, 131072
    s_cmp_eq_u32 s31, 1835008
    s_cselect_b32 s31, 0, s31
    s_add_u32 m0, s93, 98304
    s_nop 0
    buffer_load_dwordx4 v27, s[20:23], s31 offen offset:0 lds
    buffer_load_dwordx4 v28, s[20:23], s31 offen offset:1024 lds
    buffer_load_dwordx4 v29, s[20:23], s31 offen offset:2048 lds
    buffer_load_dwordx4 v30, s[20:23], s31 offen offset:3072 lds
    s_add_u32 s31, s31, 131072
    s_cmp_eq_u32 s31, 1835008
    s_cselect_b32 s31, 0, s31
    s_waitcnt vmcnt(4)
    ds_read_b64_tr_b16 a[192:193], v31 offset:16384
    ds_read_b64_tr_b16 a[194:195], v31 offset:17408
    ds_read_b64_tr_b16 a[196:197], v32 offset:16384
    ds_read_b64_tr_b16 a[198:199], v32 offset:17408
    ds_read_b64_tr_b16 a[200:201], v33 offset:16384
    ds_read_b64_tr_b16 a[202:203], v33 offset:17408
    ds_read_b64_tr_b16 a[204:205], v34 offset:16384
    ds_read_b64_tr_b16 a[206:207], v34 offset:17408
    s_waitcnt vmcnt(0)
    ds_read_b64_tr_b16 a[176:177], v31 offset:32768
    ds_read_b64_tr_b16 a[178:179], v31 offset:33792
    ds_read_b64_tr_b16 a[180:181], v32 offset:32768
    ds_read_b64_tr_b16 a[182:183], v32 offset:33792
    ds_read_b64_tr_b16 a[184:185], v33 offset:32768
    ds_read_b64_tr_b16 a[186:187], v33 offset:33792
    ds_read_b64_tr_b16 a[188:189], v34 offset:32768
    ds_read_b64_tr_b16 a[190:191], v34 offset:33792
    s_add_u32 m0, s93, 114688
    s_nop 0
    buffer_load_dwordx4 v27, s[20:23], s31 offen offset:0 lds
    buffer_load_dwordx4 v28, s[20:23], s31 offen offset:1024 lds
    buffer_load_dwordx4 v29, s[20:23], s31 offen offset:2048 lds
    buffer_load_dwordx4 v30, s[20:23], s31 offen offset:3072 lds
    s_add_u32 s31, s31, 131072
    s_cmp_eq_u32 s31, 1835008
    s_cselect_b32 s31, 0, s31
    s_add_u32 m0, s93, 131072
    s_nop 0
    buffer_load_dwordx4 v27, s[20:23], s31 offen offset:0 lds
    buffer_load_dwordx4 v28, s[20:23], s31 offen offset:1024 lds
    buffer_load_dwordx4 v29, s[20:23], s31 offen offset:2048 lds
    buffer_load_dwordx4 v30, s[20:23], s31 offen offset:3072 lds
    s_add_u32 s31, s31, 131072
    s_cmp_eq_u32 s31, 1835008
    s_cselect_b32 s31, 0, s31
    s_add_u32 m0, s93, 147456
    s_nop 0
    buffer_load_dwordx4 v27, s[20:23], s31 offen offset:0 lds
    buffer_load_dwordx4 v28, s[20:23], s31 offen offset:1024 lds
    buffer_load_dwordx4 v29, s[20:23], s31 offen offset:2048 lds
    buffer_load_dwordx4 v30, s[20:23], s31 offen offset:3072 lds
    s_add_u32 s31, s31, 131072
    s_cmp_eq_u32 s31, 1835008
    s_cselect_b32 s31, 0, s31
    s_add_u32 m0, s93, 0
    s_nop 0
    buffer_load_dwordx4 v27, s[20:23], s31 offen offset:0 lds
    buffer_load_dwordx4 v28, s[20:23], s31 offen offset:1024 lds
    buffer_load_dwordx4 v29, s[20:23], s31 offen offset:2048 lds
    buffer_load_dwordx4 v30, s[20:23], s31 offen offset:3072 lds
    s_add_u32 s31, s31, 131072
    s_cmp_eq_u32 s31, 1835008
    s_cselect_b32 s31, 0, s31
    s_add_u32 m0, s93, 16384
    s_nop 0
    buffer_load_dwordx4 v27, s[20:23], s31 offen offset:0 lds
    buffer_load_dwordx4 v28, s[20:23], s31 offen offset:1024 lds
    buffer_load_dwordx4 v29, s[20:23], s31 offen offset:2048 lds
    buffer_load_dwordx4 v30, s[20:23], s31 offen offset:3072 lds
    s_add_u32 s31, s31, 131072
    s_cmp_eq_u32 s31, 1835008
    s_cselect_b32 s31, 0, s31
    s_waitcnt lgkmcnt(0)
    s_add_u32 m0, s93, 98304
    s_nop 0
    buffer_load_dwordx4 v27, s[20:23], s31 offen offset:0 lds
    buffer_load_dwordx4 v28, s[20:23], s31 offen offset:1024 lds
    buffer_load_dwordx4 v29, s[20:23], s31 offen offset:2048 lds
    buffer_load_dwordx4 v30, s[20:23], s31 offen offset:3072 lds
    s_add_u32 s31, s31, 131072
    s_cmp_eq_u32 s31, 1835008
    s_cselect_b32 s31, 0, s31
    s_mov_b32 s47, 805306368
    s_waitcnt vmcnt(0)
    s_branch E_join
.section .rodata,"a"
.p2align 6
.amdhsa_kernel sequential_preLN__sliding_block__mixer_token_mlp__prompt_kernel
  .amdhsa_next_free_vgpr 512
  .amdhsa_next_free_sgpr 102
  .amdhsa_accum_offset 256
  .amdhsa_group_segment_fixed_size 0
  .amdhsa_kernarg_size 88
  .amdhsa_user_sgpr_count 2
  .amdhsa_user_sgpr_kernarg_segment_ptr 1
  .amdhsa_system_sgpr_workgroup_id_x 1
  .amdhsa_float_denorm_mode_32 3
.end_amdhsa_kernel
```
